```python
import torch

def _softmax(x, axis=-1):
    return torch.softmax(x, dim=axis)
def _gelu(x):
    return torch.nn.functional.gelu(x, approximate="tanh")
def _silu(x):
    return torch.nn.functional.silu(x)
def _sigmoid(x):
    return torch.sigmoid(x)
def _layernorm(x, axis=-1, eps=1e-5):
    m = x.mean(dim=axis, keepdim=True)
    v = x.var(dim=axis, keepdim=True, unbiased=False)
    return (x - m) / torch.sqrt(v + eps)
def _scatter_add(tgt, idx, src, axis=0):
    return tgt.clone().index_add_(axis, idx, src)
def _segment_sum(src, seg, n):
    out = torch.zeros((n,) + src.shape[1:], dtype=src.dtype)
    return out.index_add_(0, seg, src)
def _pad(x, pw):
    flat = tuple(v for pair in reversed(pw) for v in pair)
    return torch.nn.functional.pad(x, flat)

kernel_name = 'sequential_preLN__sliding_block__mixer_s_mlp__prompt'

def setup_inputs():

    _w = (lambda a: (lambda t: t.to(torch.bfloat16) if t.is_floating_point() else t)(torch.as_tensor(a)))
    def _A_setup():
        B, S, D = 1, 2048, 448
        return {
            "x": _w((lambda *s: torch.randn(*s, dtype=torch.bfloat16) * 0.05)(B, S, D)),
            "wqkv": _w((lambda *s: torch.randn(*s, dtype=torch.bfloat16) * 0.05)(D, 3 * D)),
            "wo": _w((lambda *s: torch.randn(*s, dtype=torch.bfloat16) * 0.05)(D, D)),
        }
    _A_in = _A_setup()

    def _B_setup():
        B, S, D, F = 1, 2048, 448, 1792
        return {
            "x":  _w((lambda *s: torch.randn(*s, dtype=torch.bfloat16) * 0.05)(B, S, D)),
            "w1": _w((lambda *s: torch.randn(*s, dtype=torch.bfloat16) * 3.2)(D, D) * (D ** -0.5)),
            "w2": _w((lambda *s: torch.randn(*s, dtype=torch.bfloat16) * 3.2)(D, D) * (D ** -0.5)),
            "w3": _w((lambda *s: torch.randn(*s, dtype=torch.bfloat16) * 3.2)(D, F) * (D ** -0.5)),
            "w4": _w((lambda *s: torch.randn(*s, dtype=torch.bfloat16) * 3.2)(F, D) * (F ** -0.5)),
        }
    _B_in = _B_setup()

    return {
        "A_x": _A_in["x"],
        "A_wqkv": _A_in["wqkv"],
        "A_wo": _A_in["wo"],
        "B_x": _B_in["x"],
        "B_w1": _B_in["w1"],
        "B_w2": _B_in["w2"],
        "B_w3": _B_in["w3"],
        "B_w4": _B_in["w4"],
    }

def reference(A_x, A_wqkv, A_wo, B_x, B_w1, B_w2, B_w3, B_w4):
    def _A_ref(x, wqkv, wo):
        B, S, D = x.shape
        H = 16; Dh = D // H; W = 256
        qkv = (lambda x, *d: x.permute(*d))((x @ wqkv).reshape(B, S, 3, H, Dh), 2, 0, 3, 1, 4)
        q, k, v = qkv[0], qkv[1], qkv[2]
        scores = torch.einsum("bhqd,bhkd->bhqk", q, k) * (Dh ** -0.5)
        idx = torch.arange(S)
        mask = (idx[:, None] - idx[None, :] >= 0) & (idx[:, None] - idx[None, :] < W)
        scores = torch.where(mask[None, None], scores, -1e9)
        p = _softmax(scores, axis=-1)
        o = torch.einsum("bhqk,bhkd->bhqd", p, v)
        return (lambda x, *d: x.permute(*d))(o, 0, 2, 1, 3).reshape(B, S, D) @ wo

    def _B_ref(x, w1, w2, w3, w4):
        B, S, D = x.shape
        h = _gelu(_layernorm(x, axis=-1) @ w1)
        c = D // 4
        g0 = _pad(h[:, :, 0*c:1*c], ((0, 0), (1, 0), (0, 0)))[:, :S, :]
        g1 = _pad(h[:, :, 1*c:2*c], ((0, 0), (0, 1), (0, 0)))[:, 1:, :]
        g2 = _pad(h[:, :, 2*c:3*c], ((0, 0), (2, 0), (0, 0)))[:, :S, :]
        g3 = _pad(h[:, :, 3*c:   ], ((0, 0), (0, 2), (0, 0)))[:, 2:, :]
        hs = torch.concatenate([g0, g1, g2, g3], axis=-1) @ w2
        x1 = x + hs
        h2 = _gelu(_layernorm(x1, axis=-1) @ w3) @ w4
        return x1 + h2

    x = A_x
    h = x + _A_ref(_layernorm(x, axis=-1), A_wqkv, A_wo)
    h2 = h + _B_ref(_layernorm(h, axis=-1), B_w1, B_w2, B_w3, B_w4)
    return h2
```

```asm
; @launch grid=(256,1,1) block=(512,1,1) lds=163840
.amdgcn_target "amdgcn-amd-amdhsa--gfx950"
.text
.globl sequential_preLN__sliding_block__mixer_s_mlp__prompt_kernel
.p2align 8
.type sequential_preLN__sliding_block__mixer_s_mlp__prompt_kernel,@function
sequential_preLN__sliding_block__mixer_s_mlp__prompt_kernel:
    s_cmp_ge_u32 s2, 0x100
    s_cbranch_scc1 L_end
    s_load_dwordx16 s[36:51], s[0:1], 0
    s_load_dwordx4 s[52:55], s[0:1], 64
    s_load_dwordx2 s[56:57], s[0:1], 80
    v_lshrrev_b32 v240, 6, v0
    v_and_b32 v0, 63, v0
    v_readfirstlane_b32 s72, v240
    s_and_b32 s68, s2, 7
    s_lshr_b32 s69, s2, 3
    s_mul_i32 s70, s69, 37
    s_lshr_b32 s70, s70, 8
    s_mul_i32 s80, s70, 7
    s_sub_u32 s71, s69, s80
    s_lshr_b32 s80, s80, 1
    s_lshl_b32 s78, s71, 7
    s_and_b32 s73, s72, 3
    s_lshl_b32 s76, s70, 2
    s_add_u32 s76, s76, s73
    s_lshl_b32 s74, s68, 21
    v_lshrrev_b32 v2, 4, v0
    s_cmp_ge_u32 s69, 28
    s_cbranch_scc1 L_spare
    s_cmp_ge_u32 s72, 4
    s_cbranch_scc1 L_aload
    v_lshrrev_b32 v244, 3, v0
    v_and_b32 v246, 7, v0
    v_xor_b32 v245, v2, v246
    v_mul_u32_u24 v244, 0x380, v244
    v_lshl_add_u32 v246, v245, 4, v244
    v_xor_b32 v245, 4, v245
    v_lshl_add_u32 v247, v245, 4, v244
    s_lshl_b32 s84, s68, 4
    s_add_u32 s84, s84, s76
    s_mul_i32 s85, s84, 0x3800
    s_mul_i32 s89, s73, 0x3800
    s_add_u32 s89, s89, 0x15000
    s_mov_b32 s79, s71
    s_mov_b32 s97, 7
    s_waitcnt lgkmcnt(0)
    s_mov_b32 s4, s36
    s_and_b32 s5, s37, 0xffff
    s_mov_b32 s6, 0x1c0000
    s_mov_b32 s7, 0x20000
L_xdma:
    s_lshl_b32 s84, s79, 11
    s_add_u32 m0, s84, s89
    s_lshl_b32 s84, s79, 7
    s_add_u32 s84, s84, s85
    s_add_u32 s88, s84, 0x1800
    buffer_load_dwordx4 v246, s[4:7], s84 offen lds
    buffer_load_dwordx4 v247, s[4:7], s88 offen offset:1024 lds
    s_add_u32 s79, s79, 1
    s_cmp_eq_u32 s79, 7
    s_cmov_b32 s79, 0
    s_sub_u32 s97, s97, 1
    s_cmp_lg_u32 s97, 0
    s_cbranch_scc1 L_xdma
    v_mov_b32 v48, 0
    v_lshlrev_b32 v49, 2, v0
    v_add_u32 v49, 0x27510, v49
    ds_write_b32 v49, v48
    v_add_u32 v49, 0xfffffbf0, v49
    ds_write_b32 v49, v48
    ds_write_b32 v49, v48 offset:256
    s_barrier
    s_mov_b32 s60, s56
    s_and_b32 s61, s57, 0xffff
    s_mov_b32 s62, 0x1085000
    s_mov_b32 s63, 0x20000
    s_mov_b32 s24, s48
    s_and_b32 s25, s49, 0xffff
    s_mov_b32 s26, 0x188000
    s_mov_b32 s27, 0x20000
    s_mov_b32 s28, s50
    s_and_b32 s29, s51, 0xffff
    s_mov_b32 s30, 0x188000
    s_mov_b32 s31, 0x20000
    s_mov_b32 s32, s52
    s_and_b32 s33, s53, 0xffff
    s_mov_b32 s34, 0x1c0000
    s_mov_b32 s35, 0x20000
    v_and_b32 v1, 15, v0
    v_lshlrev_b32 v3, 4, v0
    s_mov_b32 s82, 0xffff0000
    s_mov_b32 s83, 0xffff0000
    s_mov_b32 s77, 0
    v_mov_b32 v16, 0x3f803f80
    v_mov_b32 v17, 0x3f803f80
    v_mov_b32 v18, 0x3f803f80
    v_mov_b32 v19, 0x3f803f80
    s_lshr_b32 s84, s70, 1
    s_mul_i32 s95, s84, 14
    s_sub_u32 s95, s69, s95
    v_bfe_u32 v240, v0, 2, 2
    v_and_b32 v241, 1, v2
    v_lshl_add_u32 v242, v241, 2, v240
    v_lshrrev_b32 v243, 1, v2
    v_lshl_add_u32 v242, v243, 4, v242
    v_lshrrev_b32 v240, 1, v240
    v_lshl_or_b32 v240, v241, 2, v240
    v_and_b32 v241, 3, v0
    v_xor_b32 v240, v240, v241
    v_lshlrev_b32 v240, 4, v240
    v_lshl_add_u32 v240, v242, 7, v240
    v_and_b32 v241, 1, v241
    v_lshl_or_b32 v7, v241, 3, v240
    v_xor_b32 v8, 8, v7
    v_xor_b32 v9, 64, v7
    v_xor_b32 v10, 64, v8
    v_lshrrev_b32 v244, 1, v1
    v_xor_b32 v244, v244, v2
    v_lshlrev_b32 v244, 4, v244
    v_lshl_add_u32 v244, v1, 7, v244
    v_add_u32 v244, s89, v244
    v_xor_b32 v245, 64, v244
    s_lshl_b32 s84, s71, 11
    v_add_u32 v246, s84, v244
    v_add_u32 v247, s84, v245
    s_mul_i32 s54, s76, 0x3800
    s_add_u32 s54, s54, s74
    s_lshl_b32 s84, s71, 11
    s_add_u32 s55, s54, s84
    s_mul_i32 s58, s76, 0x800
    s_add_u32 s58, s58, s74
    s_add_u32 s58, s58, 0xe9000
    s_lshl_b32 s84, s71, 8
    s_add_u32 s56, s58, s84
    s_lshl_b32 s84, s71, 2
    s_mul_i32 s57, s76, 0x80
    s_add_u32 s57, s57, s74
    s_add_u32 s57, s57, 0xe7800
    s_add_u32 s57, s57, s84
    s_and_b32 s92, s69, 15
    s_lshr_b32 s84, s69, 4
    s_lshl_b32 s84, s84, 3
    s_lshl_b32 s93, s68, 4
    s_add_u32 s93, s93, s84
    s_mul_i32 s94, s92, 7
    s_lshr_b32 s94, s94, 1
    s_lshl_b32 s84, s73, 1
    s_add_u32 s96, s93, s84
    s_and_b32 s84, s92, 1
    s_cmp_eq_u32 s84, 1
    s_cselect_b32 s85, 0, 9
    s_cselect_b32 s88, 9, 3
    v_mov_b32 v248, -1
    v_cmp_ne_u32 vcc, s85, v2
    s_nop 1
    v_cndmask_b32 v28, 0, v248, vcc
    v_cmp_ne_u32 vcc, s88, v2
    s_nop 1
    v_cndmask_b32 v29, 0, v248, vcc
    s_lshl_b32 s84, s73, 11
    s_add_u32 s85, s84, 0x7000
    v_add_u32 v32, s85, v3
    v_and_b32 v248, 3, v0
    v_lshrrev_b32 v249, 2, v0
    v_and_b32 v250, 2, v248
    v_lshlrev_b32 v250, 2, v250
    v_xor_b32 v249, v249, v250
    v_lshlrev_b32 v249, 4, v249
    v_lshl_add_u32 v249, v248, 8, v249
    v_and_b32 v248, 1, v248
    v_lshl_or_b32 v249, v248, 3, v249
    s_add_u32 s85, s84, 0xe000
    v_add_u32 v33, s85, v249
    v_xor_b32 v34, 8, v33
    s_add_u32 s85, s84, 0x23000
    v_add_u32 v30, s85, v3
    v_mov_b32 v31, 0x27500
    v_lshlrev_b32 v248, 2, v2
    v_add_u32 v249, 0, v248
    v_cmp_gt_u32 s[36:37], v249, v1
    v_add_u32 v249, 1, v248
    v_cmp_gt_u32 s[38:39], v249, v1
    v_add_u32 v249, 2, v248
    v_cmp_gt_u32 s[50:51], v249, v1
    v_add_u32 v249, 3, v248
    v_cmp_gt_u32 s[52:53], v249, v1
    s_and_b32 s85, s96, 15
    s_lshl_b32 s84, s94, 8
    s_mul_i32 s44, s85, 0x3800
    s_add_u32 s44, s44, s74
    s_add_u32 s44, s44, s84
    s_lshl_b32 s84, s92, 2
    s_mul_i32 s59, s85, 0x80
    s_add_u32 s59, s59, s74
    s_add_u32 s59, s59, 0xe7000
    s_add_u32 s59, s59, s84
    s_bitcmp1_b32 s92, 0
    s_cselect_b32 s42, 0xffff, 0
    s_cselect_b32 s43, 0, 0xffff0000
    s_cselect_b32 s46, 8, 0
    s_mov_b32 s48, 0xffff
    s_mov_b32 s49, 0
    s_not_b64 s[40:41], s[42:43]
    s_add_u32 s46, s46, s44
    s_add_u32 s45, s44, 0x3800
    s_add_u32 s47, s46, 0x3800
    s_waitcnt vmcnt(0)
    ds_read_b128 v[64:67], v244 offset:0
    ds_read_b128 v[68:71], v245 offset:0
    ds_read_b128 v[72:75], v244 offset:2048
    ds_read_b128 v[76:79], v245 offset:2048
    ds_read_b128 v[80:83], v244 offset:4096
    ds_read_b128 v[84:87], v245 offset:4096
    ds_read_b128 v[88:91], v244 offset:6144
    ds_read_b128 v[92:95], v245 offset:6144
    ds_read_b128 v[96:99], v244 offset:8192
    ds_read_b128 v[100:103], v245 offset:8192
    ds_read_b128 v[104:107], v244 offset:10240
    ds_read_b128 v[108:111], v245 offset:10240
    ds_read_b128 v[112:115], v244 offset:12288
    ds_read_b128 v[116:119], v245 offset:12288
    ds_read_b128 v[20:23], v246
    ds_read_b128 v[24:27], v247
    v_mov_b32 v242, 0
    v_mov_b32 v243, 0
    s_waitcnt lgkmcnt(15)
    v_dot2c_f32_bf16 v242, v64, v16
    v_dot2c_f32_bf16 v243, v64, v64
    v_dot2c_f32_bf16 v242, v65, v16
    v_dot2c_f32_bf16 v243, v65, v65
    v_dot2c_f32_bf16 v242, v66, v16
    v_dot2c_f32_bf16 v243, v66, v66
    v_dot2c_f32_bf16 v242, v67, v16
    v_dot2c_f32_bf16 v243, v67, v67
    s_waitcnt lgkmcnt(14)
    v_dot2c_f32_bf16 v242, v68, v16
    v_dot2c_f32_bf16 v243, v68, v68
    v_dot2c_f32_bf16 v242, v69, v16
    v_dot2c_f32_bf16 v243, v69, v69
    v_dot2c_f32_bf16 v242, v70, v16
    v_dot2c_f32_bf16 v243, v70, v70
    v_dot2c_f32_bf16 v242, v71, v16
    v_dot2c_f32_bf16 v243, v71, v71
    s_waitcnt lgkmcnt(13)
    v_dot2c_f32_bf16 v242, v72, v16
    v_dot2c_f32_bf16 v243, v72, v72
    v_dot2c_f32_bf16 v242, v73, v16
    v_dot2c_f32_bf16 v243, v73, v73
    v_dot2c_f32_bf16 v242, v74, v16
    v_dot2c_f32_bf16 v243, v74, v74
    v_dot2c_f32_bf16 v242, v75, v16
    v_dot2c_f32_bf16 v243, v75, v75
    s_waitcnt lgkmcnt(12)
    v_dot2c_f32_bf16 v242, v76, v16
    v_dot2c_f32_bf16 v243, v76, v76
    v_dot2c_f32_bf16 v242, v77, v16
    v_dot2c_f32_bf16 v243, v77, v77
    v_dot2c_f32_bf16 v242, v78, v16
    v_dot2c_f32_bf16 v243, v78, v78
    v_dot2c_f32_bf16 v242, v79, v16
    v_dot2c_f32_bf16 v243, v79, v79
    s_waitcnt lgkmcnt(11)
    v_dot2c_f32_bf16 v242, v80, v16
    v_dot2c_f32_bf16 v243, v80, v80
    v_dot2c_f32_bf16 v242, v81, v16
    v_dot2c_f32_bf16 v243, v81, v81
    v_dot2c_f32_bf16 v242, v82, v16
    v_dot2c_f32_bf16 v243, v82, v82
    v_dot2c_f32_bf16 v242, v83, v16
    v_dot2c_f32_bf16 v243, v83, v83
    s_waitcnt lgkmcnt(10)
    v_dot2c_f32_bf16 v242, v84, v16
    v_dot2c_f32_bf16 v243, v84, v84
    v_dot2c_f32_bf16 v242, v85, v16
    v_dot2c_f32_bf16 v243, v85, v85
    v_dot2c_f32_bf16 v242, v86, v16
    v_dot2c_f32_bf16 v243, v86, v86
    v_dot2c_f32_bf16 v242, v87, v16
    v_dot2c_f32_bf16 v243, v87, v87
    s_waitcnt lgkmcnt(9)
    v_dot2c_f32_bf16 v242, v88, v16
    v_dot2c_f32_bf16 v243, v88, v88
    v_dot2c_f32_bf16 v242, v89, v16
    v_dot2c_f32_bf16 v243, v89, v89
    v_dot2c_f32_bf16 v242, v90, v16
    v_dot2c_f32_bf16 v243, v90, v90
    v_dot2c_f32_bf16 v242, v91, v16
    v_dot2c_f32_bf16 v243, v91, v91
    s_waitcnt lgkmcnt(8)
    v_dot2c_f32_bf16 v242, v92, v16
    v_dot2c_f32_bf16 v243, v92, v92
    v_dot2c_f32_bf16 v242, v93, v16
    v_dot2c_f32_bf16 v243, v93, v93
    v_dot2c_f32_bf16 v242, v94, v16
    v_dot2c_f32_bf16 v243, v94, v94
    v_dot2c_f32_bf16 v242, v95, v16
    v_dot2c_f32_bf16 v243, v95, v95
    s_waitcnt lgkmcnt(7)
    v_dot2c_f32_bf16 v242, v96, v16
    v_dot2c_f32_bf16 v243, v96, v96
    v_dot2c_f32_bf16 v242, v97, v16
    v_dot2c_f32_bf16 v243, v97, v97
    v_dot2c_f32_bf16 v242, v98, v16
    v_dot2c_f32_bf16 v243, v98, v98
    v_dot2c_f32_bf16 v242, v99, v16
    v_dot2c_f32_bf16 v243, v99, v99
    s_waitcnt lgkmcnt(6)
    v_dot2c_f32_bf16 v242, v100, v16
    v_dot2c_f32_bf16 v243, v100, v100
    v_dot2c_f32_bf16 v242, v101, v16
    v_dot2c_f32_bf16 v243, v101, v101
    v_dot2c_f32_bf16 v242, v102, v16
    v_dot2c_f32_bf16 v243, v102, v102
    v_dot2c_f32_bf16 v242, v103, v16
    v_dot2c_f32_bf16 v243, v103, v103
    s_waitcnt lgkmcnt(5)
    v_dot2c_f32_bf16 v242, v104, v16
    v_dot2c_f32_bf16 v243, v104, v104
    v_dot2c_f32_bf16 v242, v105, v16
    v_dot2c_f32_bf16 v243, v105, v105
    v_dot2c_f32_bf16 v242, v106, v16
    v_dot2c_f32_bf16 v243, v106, v106
    v_dot2c_f32_bf16 v242, v107, v16
    v_dot2c_f32_bf16 v243, v107, v107
    s_waitcnt lgkmcnt(4)
    v_dot2c_f32_bf16 v242, v108, v16
    v_dot2c_f32_bf16 v243, v108, v108
    v_dot2c_f32_bf16 v242, v109, v16
    v_dot2c_f32_bf16 v243, v109, v109
    v_dot2c_f32_bf16 v242, v110, v16
    v_dot2c_f32_bf16 v243, v110, v110
    v_dot2c_f32_bf16 v242, v111, v16
    v_dot2c_f32_bf16 v243, v111, v111
    s_waitcnt lgkmcnt(3)
    v_dot2c_f32_bf16 v242, v112, v16
    v_dot2c_f32_bf16 v243, v112, v112
    v_dot2c_f32_bf16 v242, v113, v16
    v_dot2c_f32_bf16 v243, v113, v113
    v_dot2c_f32_bf16 v242, v114, v16
    v_dot2c_f32_bf16 v243, v114, v114
    v_dot2c_f32_bf16 v242, v115, v16
    v_dot2c_f32_bf16 v243, v115, v115
    s_waitcnt lgkmcnt(2)
    v_dot2c_f32_bf16 v242, v116, v16
    v_dot2c_f32_bf16 v243, v116, v116
    v_dot2c_f32_bf16 v242, v117, v16
    v_dot2c_f32_bf16 v243, v117, v117
    v_dot2c_f32_bf16 v242, v118, v16
    v_dot2c_f32_bf16 v243, v118, v118
    v_dot2c_f32_bf16 v242, v119, v16
    v_dot2c_f32_bf16 v243, v119, v119
    s_nop 2
    v_permlane32_swap_b32 v242, v243
    v_add_f32 v242, v242, v243
    v_mov_b32 v243, v242
    s_nop 1
    v_permlane16_swap_b32 v242, v243
    v_add_f32 v242, v242, v243
    v_mov_b32 v243, v242
    s_nop 1
    v_permlane32_swap_b32 v242, v243
    v_mul_f32 v246, 0x3b124925, v242
    v_mul_f32 v247, 0x3b124925, v243
    v_fma_f32 v247, -v246, v246, v247
    v_max_f32 v247, 0, v247
    v_add_f32 v248, 0x3727c5ac, v247
    v_rsq_f32 v248, v248
    s_nop 0
    v_mul_f32 v246, v246, v248
    v_sub_f32 v246, 0, v246
    v_lshlrev_b32 v250, 16, v64
    v_and_b32 v251, 0xffff0000, v64
    v_pk_fma_f32 v[250:251], v[250:251], v[248:249], v[246:247] op_sel_hi:[1,0,0]
    v_lshlrev_b32 v252, 16, v65
    v_and_b32 v253, 0xffff0000, v65
    v_pk_fma_f32 v[252:253], v[252:253], v[248:249], v[246:247] op_sel_hi:[1,0,0]
    v_cvt_pk_bf16_f32 v64, v250, v251
    v_lshlrev_b32 v250, 16, v66
    v_and_b32 v251, 0xffff0000, v66
    v_pk_fma_f32 v[250:251], v[250:251], v[248:249], v[246:247] op_sel_hi:[1,0,0]
    v_cvt_pk_bf16_f32 v65, v252, v253
    v_lshlrev_b32 v252, 16, v67
    v_and_b32 v253, 0xffff0000, v67
    v_pk_fma_f32 v[252:253], v[252:253], v[248:249], v[246:247] op_sel_hi:[1,0,0]
    v_cvt_pk_bf16_f32 v66, v250, v251
    v_lshlrev_b32 v250, 16, v68
    v_and_b32 v251, 0xffff0000, v68
    v_pk_fma_f32 v[250:251], v[250:251], v[248:249], v[246:247] op_sel_hi:[1,0,0]
    v_cvt_pk_bf16_f32 v67, v252, v253
    v_lshlrev_b32 v252, 16, v69
    v_and_b32 v253, 0xffff0000, v69
    v_pk_fma_f32 v[252:253], v[252:253], v[248:249], v[246:247] op_sel_hi:[1,0,0]
    v_cvt_pk_bf16_f32 v68, v250, v251
    v_lshlrev_b32 v250, 16, v70
    v_and_b32 v251, 0xffff0000, v70
    v_pk_fma_f32 v[250:251], v[250:251], v[248:249], v[246:247] op_sel_hi:[1,0,0]
    v_cvt_pk_bf16_f32 v69, v252, v253
    v_lshlrev_b32 v252, 16, v71
    v_and_b32 v253, 0xffff0000, v71
    v_pk_fma_f32 v[252:253], v[252:253], v[248:249], v[246:247] op_sel_hi:[1,0,0]
    v_cvt_pk_bf16_f32 v70, v250, v251
    v_lshlrev_b32 v250, 16, v72
    v_and_b32 v251, 0xffff0000, v72
    v_pk_fma_f32 v[250:251], v[250:251], v[248:249], v[246:247] op_sel_hi:[1,0,0]
    v_cvt_pk_bf16_f32 v71, v252, v253
    v_lshlrev_b32 v252, 16, v73
    v_and_b32 v253, 0xffff0000, v73
    v_pk_fma_f32 v[252:253], v[252:253], v[248:249], v[246:247] op_sel_hi:[1,0,0]
    v_cvt_pk_bf16_f32 v72, v250, v251
    v_lshlrev_b32 v250, 16, v74
    v_and_b32 v251, 0xffff0000, v74
    v_pk_fma_f32 v[250:251], v[250:251], v[248:249], v[246:247] op_sel_hi:[1,0,0]
    v_cvt_pk_bf16_f32 v73, v252, v253
    v_lshlrev_b32 v252, 16, v75
    v_and_b32 v253, 0xffff0000, v75
    v_pk_fma_f32 v[252:253], v[252:253], v[248:249], v[246:247] op_sel_hi:[1,0,0]
    v_cvt_pk_bf16_f32 v74, v250, v251
    v_lshlrev_b32 v250, 16, v76
    v_and_b32 v251, 0xffff0000, v76
    v_pk_fma_f32 v[250:251], v[250:251], v[248:249], v[246:247] op_sel_hi:[1,0,0]
    v_cvt_pk_bf16_f32 v75, v252, v253
    v_lshlrev_b32 v252, 16, v77
    v_and_b32 v253, 0xffff0000, v77
    v_pk_fma_f32 v[252:253], v[252:253], v[248:249], v[246:247] op_sel_hi:[1,0,0]
    v_cvt_pk_bf16_f32 v76, v250, v251
    v_lshlrev_b32 v250, 16, v78
    v_and_b32 v251, 0xffff0000, v78
    v_pk_fma_f32 v[250:251], v[250:251], v[248:249], v[246:247] op_sel_hi:[1,0,0]
    v_cvt_pk_bf16_f32 v77, v252, v253
    v_lshlrev_b32 v252, 16, v79
    v_and_b32 v253, 0xffff0000, v79
    v_pk_fma_f32 v[252:253], v[252:253], v[248:249], v[246:247] op_sel_hi:[1,0,0]
    v_cvt_pk_bf16_f32 v78, v250, v251
    v_lshlrev_b32 v250, 16, v80
    v_and_b32 v251, 0xffff0000, v80
    v_pk_fma_f32 v[250:251], v[250:251], v[248:249], v[246:247] op_sel_hi:[1,0,0]
    v_cvt_pk_bf16_f32 v79, v252, v253
    v_lshlrev_b32 v252, 16, v81
    v_and_b32 v253, 0xffff0000, v81
    v_pk_fma_f32 v[252:253], v[252:253], v[248:249], v[246:247] op_sel_hi:[1,0,0]
    v_cvt_pk_bf16_f32 v80, v250, v251
    v_lshlrev_b32 v250, 16, v82
    v_and_b32 v251, 0xffff0000, v82
    v_pk_fma_f32 v[250:251], v[250:251], v[248:249], v[246:247] op_sel_hi:[1,0,0]
    v_cvt_pk_bf16_f32 v81, v252, v253
    v_lshlrev_b32 v252, 16, v83
    v_and_b32 v253, 0xffff0000, v83
    v_pk_fma_f32 v[252:253], v[252:253], v[248:249], v[246:247] op_sel_hi:[1,0,0]
    v_cvt_pk_bf16_f32 v82, v250, v251
    v_lshlrev_b32 v250, 16, v84
    v_and_b32 v251, 0xffff0000, v84
    v_pk_fma_f32 v[250:251], v[250:251], v[248:249], v[246:247] op_sel_hi:[1,0,0]
    v_cvt_pk_bf16_f32 v83, v252, v253
    v_lshlrev_b32 v252, 16, v85
    v_and_b32 v253, 0xffff0000, v85
    v_pk_fma_f32 v[252:253], v[252:253], v[248:249], v[246:247] op_sel_hi:[1,0,0]
    v_cvt_pk_bf16_f32 v84, v250, v251
    v_lshlrev_b32 v250, 16, v86
    v_and_b32 v251, 0xffff0000, v86
    v_pk_fma_f32 v[250:251], v[250:251], v[248:249], v[246:247] op_sel_hi:[1,0,0]
    v_cvt_pk_bf16_f32 v85, v252, v253
    v_lshlrev_b32 v252, 16, v87
    v_and_b32 v253, 0xffff0000, v87
    v_pk_fma_f32 v[252:253], v[252:253], v[248:249], v[246:247] op_sel_hi:[1,0,0]
    v_cvt_pk_bf16_f32 v86, v250, v251
    v_lshlrev_b32 v250, 16, v88
    v_and_b32 v251, 0xffff0000, v88
    v_pk_fma_f32 v[250:251], v[250:251], v[248:249], v[246:247] op_sel_hi:[1,0,0]
    v_cvt_pk_bf16_f32 v87, v252, v253
    v_lshlrev_b32 v252, 16, v89
    v_and_b32 v253, 0xffff0000, v89
    v_pk_fma_f32 v[252:253], v[252:253], v[248:249], v[246:247] op_sel_hi:[1,0,0]
    v_cvt_pk_bf16_f32 v88, v250, v251
    v_lshlrev_b32 v250, 16, v90
    v_and_b32 v251, 0xffff0000, v90
    v_pk_fma_f32 v[250:251], v[250:251], v[248:249], v[246:247] op_sel_hi:[1,0,0]
    v_cvt_pk_bf16_f32 v89, v252, v253
    v_lshlrev_b32 v252, 16, v91
    v_and_b32 v253, 0xffff0000, v91
    v_pk_fma_f32 v[252:253], v[252:253], v[248:249], v[246:247] op_sel_hi:[1,0,0]
    v_cvt_pk_bf16_f32 v90, v250, v251
    v_lshlrev_b32 v250, 16, v92
    v_and_b32 v251, 0xffff0000, v92
    v_pk_fma_f32 v[250:251], v[250:251], v[248:249], v[246:247] op_sel_hi:[1,0,0]
    v_cvt_pk_bf16_f32 v91, v252, v253
    v_lshlrev_b32 v252, 16, v93
    v_and_b32 v253, 0xffff0000, v93
    v_pk_fma_f32 v[252:253], v[252:253], v[248:249], v[246:247] op_sel_hi:[1,0,0]
    v_cvt_pk_bf16_f32 v92, v250, v251
    v_lshlrev_b32 v250, 16, v94
    v_and_b32 v251, 0xffff0000, v94
    v_pk_fma_f32 v[250:251], v[250:251], v[248:249], v[246:247] op_sel_hi:[1,0,0]
    v_cvt_pk_bf16_f32 v93, v252, v253
    v_lshlrev_b32 v252, 16, v95
    v_and_b32 v253, 0xffff0000, v95
    v_pk_fma_f32 v[252:253], v[252:253], v[248:249], v[246:247] op_sel_hi:[1,0,0]
    v_cvt_pk_bf16_f32 v94, v250, v251
    v_lshlrev_b32 v250, 16, v96
    v_and_b32 v251, 0xffff0000, v96
    v_pk_fma_f32 v[250:251], v[250:251], v[248:249], v[246:247] op_sel_hi:[1,0,0]
    v_cvt_pk_bf16_f32 v95, v252, v253
    v_lshlrev_b32 v252, 16, v97
    v_and_b32 v253, 0xffff0000, v97
    v_pk_fma_f32 v[252:253], v[252:253], v[248:249], v[246:247] op_sel_hi:[1,0,0]
    v_cvt_pk_bf16_f32 v96, v250, v251
    v_lshlrev_b32 v250, 16, v98
    v_and_b32 v251, 0xffff0000, v98
    v_pk_fma_f32 v[250:251], v[250:251], v[248:249], v[246:247] op_sel_hi:[1,0,0]
    v_cvt_pk_bf16_f32 v97, v252, v253
    v_lshlrev_b32 v252, 16, v99
    v_and_b32 v253, 0xffff0000, v99
    v_pk_fma_f32 v[252:253], v[252:253], v[248:249], v[246:247] op_sel_hi:[1,0,0]
    v_cvt_pk_bf16_f32 v98, v250, v251
    v_lshlrev_b32 v250, 16, v100
    v_and_b32 v251, 0xffff0000, v100
    v_pk_fma_f32 v[250:251], v[250:251], v[248:249], v[246:247] op_sel_hi:[1,0,0]
    v_cvt_pk_bf16_f32 v99, v252, v253
    v_lshlrev_b32 v252, 16, v101
    v_and_b32 v253, 0xffff0000, v101
    v_pk_fma_f32 v[252:253], v[252:253], v[248:249], v[246:247] op_sel_hi:[1,0,0]
    v_cvt_pk_bf16_f32 v100, v250, v251
    v_lshlrev_b32 v250, 16, v102
    v_and_b32 v251, 0xffff0000, v102
    v_pk_fma_f32 v[250:251], v[250:251], v[248:249], v[246:247] op_sel_hi:[1,0,0]
    v_cvt_pk_bf16_f32 v101, v252, v253
    v_lshlrev_b32 v252, 16, v103
    v_and_b32 v253, 0xffff0000, v103
    v_pk_fma_f32 v[252:253], v[252:253], v[248:249], v[246:247] op_sel_hi:[1,0,0]
    v_cvt_pk_bf16_f32 v102, v250, v251
    v_lshlrev_b32 v250, 16, v104
    v_and_b32 v251, 0xffff0000, v104
    v_pk_fma_f32 v[250:251], v[250:251], v[248:249], v[246:247] op_sel_hi:[1,0,0]
    v_cvt_pk_bf16_f32 v103, v252, v253
    v_lshlrev_b32 v252, 16, v105
    v_and_b32 v253, 0xffff0000, v105
    v_pk_fma_f32 v[252:253], v[252:253], v[248:249], v[246:247] op_sel_hi:[1,0,0]
    v_cvt_pk_bf16_f32 v104, v250, v251
    v_lshlrev_b32 v250, 16, v106
    v_and_b32 v251, 0xffff0000, v106
    v_pk_fma_f32 v[250:251], v[250:251], v[248:249], v[246:247] op_sel_hi:[1,0,0]
    v_cvt_pk_bf16_f32 v105, v252, v253
    v_lshlrev_b32 v252, 16, v107
    v_and_b32 v253, 0xffff0000, v107
    v_pk_fma_f32 v[252:253], v[252:253], v[248:249], v[246:247] op_sel_hi:[1,0,0]
    v_cvt_pk_bf16_f32 v106, v250, v251
    v_lshlrev_b32 v250, 16, v108
    v_and_b32 v251, 0xffff0000, v108
    v_pk_fma_f32 v[250:251], v[250:251], v[248:249], v[246:247] op_sel_hi:[1,0,0]
    v_cvt_pk_bf16_f32 v107, v252, v253
    v_lshlrev_b32 v252, 16, v109
    v_and_b32 v253, 0xffff0000, v109
    v_pk_fma_f32 v[252:253], v[252:253], v[248:249], v[246:247] op_sel_hi:[1,0,0]
    v_cvt_pk_bf16_f32 v108, v250, v251
    v_lshlrev_b32 v250, 16, v110
    v_and_b32 v251, 0xffff0000, v110
    v_pk_fma_f32 v[250:251], v[250:251], v[248:249], v[246:247] op_sel_hi:[1,0,0]
    v_cvt_pk_bf16_f32 v109, v252, v253
    v_lshlrev_b32 v252, 16, v111
    v_and_b32 v253, 0xffff0000, v111
    v_pk_fma_f32 v[252:253], v[252:253], v[248:249], v[246:247] op_sel_hi:[1,0,0]
    v_cvt_pk_bf16_f32 v110, v250, v251
    v_lshlrev_b32 v250, 16, v112
    v_and_b32 v251, 0xffff0000, v112
    v_pk_fma_f32 v[250:251], v[250:251], v[248:249], v[246:247] op_sel_hi:[1,0,0]
    v_cvt_pk_bf16_f32 v111, v252, v253
    v_lshlrev_b32 v252, 16, v113
    v_and_b32 v253, 0xffff0000, v113
    v_pk_fma_f32 v[252:253], v[252:253], v[248:249], v[246:247] op_sel_hi:[1,0,0]
    v_cvt_pk_bf16_f32 v112, v250, v251
    v_lshlrev_b32 v250, 16, v114
    v_and_b32 v251, 0xffff0000, v114
    v_pk_fma_f32 v[250:251], v[250:251], v[248:249], v[246:247] op_sel_hi:[1,0,0]
    v_cvt_pk_bf16_f32 v113, v252, v253
    v_lshlrev_b32 v252, 16, v115
    v_and_b32 v253, 0xffff0000, v115
    v_pk_fma_f32 v[252:253], v[252:253], v[248:249], v[246:247] op_sel_hi:[1,0,0]
    v_cvt_pk_bf16_f32 v114, v250, v251
    v_lshlrev_b32 v250, 16, v116
    v_and_b32 v251, 0xffff0000, v116
    v_pk_fma_f32 v[250:251], v[250:251], v[248:249], v[246:247] op_sel_hi:[1,0,0]
    v_cvt_pk_bf16_f32 v115, v252, v253
    v_lshlrev_b32 v252, 16, v117
    v_and_b32 v253, 0xffff0000, v117
    v_pk_fma_f32 v[252:253], v[252:253], v[248:249], v[246:247] op_sel_hi:[1,0,0]
    v_cvt_pk_bf16_f32 v116, v250, v251
    v_lshlrev_b32 v250, 16, v118
    v_and_b32 v251, 0xffff0000, v118
    v_pk_fma_f32 v[250:251], v[250:251], v[248:249], v[246:247] op_sel_hi:[1,0,0]
    v_cvt_pk_bf16_f32 v117, v252, v253
    v_lshlrev_b32 v252, 16, v119
    v_and_b32 v253, 0xffff0000, v119
    v_pk_fma_f32 v[252:253], v[252:253], v[248:249], v[246:247] op_sel_hi:[1,0,0]
    v_cvt_pk_bf16_f32 v118, v250, v251
    v_cvt_pk_bf16_f32 v119, v252, v253
    s_waitcnt lgkmcnt(0)
    s_mov_b64 exec, s[82:83]
    v_swap_b32 v20, v22
    v_swap_b32 v21, v23
    v_swap_b32 v24, v26
    v_swap_b32 v25, v27
    s_mov_b64 exec, -1
    v_mov_b32 v124, 0x27510
    v_mov_b32 v125, 1
    s_bitcmp1_b32 s70, 0
    s_cselect_b32 s4, 0x7000, 0
    s_cselect_b32 s6, 0, 0x1c000
    s_cselect_b32 s7, 0x1c000, 0
    s_sub_u32 s5, 0x15000, s4
    s_add_u32 s4, s4, 0xe000
    s_mov_b32 s84, 0x0
    v_add_u32 v11, s84, v7
    v_add_u32 v12, s84, v8
    v_add_u32 v13, s84, v9
    v_add_u32 v14, s84, v10
    s_mov_b32 s84, 0x7000
    v_add_u32 v120, s84, v7
    v_add_u32 v121, s84, v8
    v_add_u32 v122, s84, v9
    v_add_u32 v123, s84, v10
    s_add_u32 s8, s55, 0x70000
    s_add_u32 s9, s55, 0xa8000
    s_add_u32 s86, s55, 0x0
    s_mul_i32 s10, s76, 0x400
    s_add_u32 s10, s10, s74
    s_add_u32 s10, s10, 0xf9000
    s_add_u32 s10, s10, s78
    s_add_u32 s11, s10, 4
    s_lshl_b32 s84, s71, 2
    s_mul_i32 s87, s76, 0x80
    s_add_u32 s87, s87, s74
    s_add_u32 s87, s87, 0xe8000
    s_add_u32 s87, s87, s84
    v_mov_b32 v249, 0x27500
    v_mov_b32 v248, 0x3e8b97f6
    s_barrier
    v_mov_b32 v15, 0x27504
    ds_read_b32 v15, v15
    ds_read_b64_tr_b16 v[128:129], v11 offset:0
    ds_read_b64_tr_b16 v[130:131], v11 offset:1024
    ds_read_b64_tr_b16 v[132:133], v12 offset:0
    ds_read_b64_tr_b16 v[134:135], v12 offset:1024
    ds_read_b64_tr_b16 v[136:137], v13 offset:0
    ds_read_b64_tr_b16 v[138:139], v13 offset:1024
    ds_read_b64_tr_b16 v[140:141], v14 offset:0
    ds_read_b64_tr_b16 v[142:143], v14 offset:1024
    ds_read_b64_tr_b16 v[144:145], v11 offset:4096
    ds_read_b64_tr_b16 v[146:147], v11 offset:5120
    ds_read_b64_tr_b16 v[148:149], v12 offset:4096
    ds_read_b64_tr_b16 v[150:151], v12 offset:5120
    ds_read_b64_tr_b16 v[152:153], v13 offset:4096
    ds_read_b64_tr_b16 v[154:155], v13 offset:5120
    ds_read_b64_tr_b16 v[156:157], v14 offset:4096
    ds_read_b64_tr_b16 v[158:159], v14 offset:5120
    s_waitcnt lgkmcnt(8)
    v_mfma_f32_16x16x32_bf16 v[48:51], v[128:131], v[64:67], 0
    ds_read_b64_tr_b16 v[160:161], v11 offset:8192
    ds_read_b64_tr_b16 v[162:163], v11 offset:9216
    v_mfma_f32_16x16x32_bf16 v[52:55], v[132:135], v[64:67], 0
    ds_read_b64_tr_b16 v[164:165], v12 offset:8192
    ds_read_b64_tr_b16 v[166:167], v12 offset:9216
    v_mfma_f32_16x16x32_bf16 v[56:59], v[136:139], v[64:67], 0
    ds_read_b64_tr_b16 v[168:169], v13 offset:8192
    ds_read_b64_tr_b16 v[170:171], v13 offset:9216
    v_mfma_f32_16x16x32_bf16 v[60:63], v[140:143], v[64:67], 0
    ds_read_b64_tr_b16 v[172:173], v14 offset:8192
    ds_read_b64_tr_b16 v[174:175], v14 offset:9216
    s_waitcnt lgkmcnt(8)
    v_mfma_f32_16x16x32_bf16 v[48:51], v[144:147], v[68:71], v[48:51]
    ds_read_b64_tr_b16 v[176:177], v11 offset:12288
    ds_read_b64_tr_b16 v[178:179], v11 offset:13312
    v_mfma_f32_16x16x32_bf16 v[52:55], v[148:151], v[68:71], v[52:55]
    ds_read_b64_tr_b16 v[180:181], v12 offset:12288
    ds_read_b64_tr_b16 v[182:183], v12 offset:13312
    v_mfma_f32_16x16x32_bf16 v[56:59], v[152:155], v[68:71], v[56:59]
    ds_read_b64_tr_b16 v[184:185], v13 offset:12288
    ds_read_b64_tr_b16 v[186:187], v13 offset:13312
    v_mfma_f32_16x16x32_bf16 v[60:63], v[156:159], v[68:71], v[60:63]
    ds_read_b64_tr_b16 v[188:189], v14 offset:12288
    ds_read_b64_tr_b16 v[190:191], v14 offset:13312
    v_readfirstlane_b32 s75, v15
    s_waitcnt lgkmcnt(8)
    v_mfma_f32_16x16x32_bf16 v[48:51], v[160:163], v[72:75], v[48:51]
    ds_read_b64_tr_b16 v[128:129], v11 offset:16384
    ds_read_b64_tr_b16 v[130:131], v11 offset:17408
    v_mfma_f32_16x16x32_bf16 v[52:55], v[164:167], v[72:75], v[52:55]
    ds_read_b64_tr_b16 v[132:133], v12 offset:16384
    ds_read_b64_tr_b16 v[134:135], v12 offset:17408
    v_mfma_f32_16x16x32_bf16 v[56:59], v[168:171], v[72:75], v[56:59]
    ds_read_b64_tr_b16 v[136:137], v13 offset:16384
    ds_read_b64_tr_b16 v[138:139], v13 offset:17408
    v_mfma_f32_16x16x32_bf16 v[60:63], v[172:175], v[72:75], v[60:63]
    ds_read_b64_tr_b16 v[140:141], v14 offset:16384
    ds_read_b64_tr_b16 v[142:143], v14 offset:17408
    s_waitcnt lgkmcnt(8)
    v_mfma_f32_16x16x32_bf16 v[48:51], v[176:179], v[76:79], v[48:51]
    ds_read_b64_tr_b16 v[144:145], v11 offset:20480
    ds_read_b64_tr_b16 v[146:147], v11 offset:21504
    v_mfma_f32_16x16x32_bf16 v[52:55], v[180:183], v[76:79], v[52:55]
    ds_read_b64_tr_b16 v[148:149], v12 offset:20480
    ds_read_b64_tr_b16 v[150:151], v12 offset:21504
    v_mfma_f32_16x16x32_bf16 v[56:59], v[184:187], v[76:79], v[56:59]
    ds_read_b64_tr_b16 v[152:153], v13 offset:20480
    ds_read_b64_tr_b16 v[154:155], v13 offset:21504
    v_mfma_f32_16x16x32_bf16 v[60:63], v[188:191], v[76:79], v[60:63]
    ds_read_b64_tr_b16 v[156:157], v14 offset:20480
    ds_read_b64_tr_b16 v[158:159], v14 offset:21504
    s_waitcnt lgkmcnt(8)
    v_mfma_f32_16x16x32_bf16 v[48:51], v[128:131], v[80:83], v[48:51]
    ds_read_b64_tr_b16 v[160:161], v11 offset:24576
    ds_read_b64_tr_b16 v[162:163], v11 offset:25600
    v_mfma_f32_16x16x32_bf16 v[52:55], v[132:135], v[80:83], v[52:55]
    ds_read_b64_tr_b16 v[164:165], v12 offset:24576
    ds_read_b64_tr_b16 v[166:167], v12 offset:25600
    v_mfma_f32_16x16x32_bf16 v[56:59], v[136:139], v[80:83], v[56:59]
    ds_read_b64_tr_b16 v[168:169], v13 offset:24576
    ds_read_b64_tr_b16 v[170:171], v13 offset:25600
    v_mfma_f32_16x16x32_bf16 v[60:63], v[140:143], v[80:83], v[60:63]
    ds_read_b64_tr_b16 v[172:173], v14 offset:24576
    ds_read_b64_tr_b16 v[174:175], v14 offset:25600
    v_add_u32 v11, s4, v7
    v_add_u32 v12, s4, v8
    v_add_u32 v13, s4, v9
    v_add_u32 v14, s4, v10
    s_waitcnt lgkmcnt(8)
    v_mfma_f32_16x16x32_bf16 v[48:51], v[144:147], v[84:87], v[48:51]
    ds_read_b64_tr_b16 v[176:177], v120 offset:0
    ds_read_b64_tr_b16 v[178:179], v120 offset:1024
    v_mfma_f32_16x16x32_bf16 v[52:55], v[148:151], v[84:87], v[52:55]
    ds_read_b64_tr_b16 v[180:181], v121 offset:0
    ds_read_b64_tr_b16 v[182:183], v121 offset:1024
    v_mfma_f32_16x16x32_bf16 v[56:59], v[152:155], v[84:87], v[56:59]
    ds_read_b64_tr_b16 v[184:185], v122 offset:0
    ds_read_b64_tr_b16 v[186:187], v122 offset:1024
    v_mfma_f32_16x16x32_bf16 v[60:63], v[156:159], v[84:87], v[60:63]
    ds_read_b64_tr_b16 v[188:189], v123 offset:0
    ds_read_b64_tr_b16 v[190:191], v123 offset:1024
    s_waitcnt lgkmcnt(8)
    v_mfma_f32_16x16x32_bf16 v[48:51], v[160:163], v[88:91], v[48:51]
    ds_read_b64_tr_b16 v[128:129], v120 offset:4096
    ds_read_b64_tr_b16 v[130:131], v120 offset:5120
    v_mfma_f32_16x16x32_bf16 v[52:55], v[164:167], v[88:91], v[52:55]
    ds_read_b64_tr_b16 v[132:133], v121 offset:4096
    ds_read_b64_tr_b16 v[134:135], v121 offset:5120
    v_mfma_f32_16x16x32_bf16 v[56:59], v[168:171], v[88:91], v[56:59]
    ds_read_b64_tr_b16 v[136:137], v122 offset:4096
    ds_read_b64_tr_b16 v[138:139], v122 offset:5120
    v_mfma_f32_16x16x32_bf16 v[60:63], v[172:175], v[88:91], v[60:63]
    ds_read_b64_tr_b16 v[140:141], v123 offset:4096
    ds_read_b64_tr_b16 v[142:143], v123 offset:5120
    s_waitcnt lgkmcnt(8)
    v_mfma_f32_16x16x32_bf16 v[48:51], v[176:179], v[92:95], v[48:51]
    ds_read_b64_tr_b16 v[144:145], v120 offset:8192
    ds_read_b64_tr_b16 v[146:147], v120 offset:9216
    v_mfma_f32_16x16x32_bf16 v[52:55], v[180:183], v[92:95], v[52:55]
    ds_read_b64_tr_b16 v[148:149], v121 offset:8192
    ds_read_b64_tr_b16 v[150:151], v121 offset:9216
    v_mfma_f32_16x16x32_bf16 v[56:59], v[184:187], v[92:95], v[56:59]
    ds_read_b64_tr_b16 v[152:153], v122 offset:8192
    ds_read_b64_tr_b16 v[154:155], v122 offset:9216
    v_mfma_f32_16x16x32_bf16 v[60:63], v[188:191], v[92:95], v[60:63]
    ds_read_b64_tr_b16 v[156:157], v123 offset:8192
    ds_read_b64_tr_b16 v[158:159], v123 offset:9216
    s_waitcnt lgkmcnt(8)
    v_mfma_f32_16x16x32_bf16 v[48:51], v[128:131], v[96:99], v[48:51]
    ds_read_b64_tr_b16 v[160:161], v120 offset:12288
    ds_read_b64_tr_b16 v[162:163], v120 offset:13312
    v_mfma_f32_16x16x32_bf16 v[52:55], v[132:135], v[96:99], v[52:55]
    ds_read_b64_tr_b16 v[164:165], v121 offset:12288
    ds_read_b64_tr_b16 v[166:167], v121 offset:13312
    v_mfma_f32_16x16x32_bf16 v[56:59], v[136:139], v[96:99], v[56:59]
    ds_read_b64_tr_b16 v[168:169], v122 offset:12288
    ds_read_b64_tr_b16 v[170:171], v122 offset:13312
    v_mfma_f32_16x16x32_bf16 v[60:63], v[140:143], v[96:99], v[60:63]
    ds_read_b64_tr_b16 v[172:173], v123 offset:12288
    ds_read_b64_tr_b16 v[174:175], v123 offset:13312
    s_waitcnt lgkmcnt(8)
    v_mfma_f32_16x16x32_bf16 v[48:51], v[144:147], v[100:103], v[48:51]
    ds_read_b64_tr_b16 v[176:177], v120 offset:16384
    ds_read_b64_tr_b16 v[178:179], v120 offset:17408
    v_mfma_f32_16x16x32_bf16 v[52:55], v[148:151], v[100:103], v[52:55]
    ds_read_b64_tr_b16 v[180:181], v121 offset:16384
    ds_read_b64_tr_b16 v[182:183], v121 offset:17408
    v_mfma_f32_16x16x32_bf16 v[56:59], v[152:155], v[100:103], v[56:59]
    ds_read_b64_tr_b16 v[184:185], v122 offset:16384
    ds_read_b64_tr_b16 v[186:187], v122 offset:17408
    v_mfma_f32_16x16x32_bf16 v[60:63], v[156:159], v[100:103], v[60:63]
    ds_read_b64_tr_b16 v[188:189], v123 offset:16384
    ds_read_b64_tr_b16 v[190:191], v123 offset:17408
    s_waitcnt lgkmcnt(8)
    v_mfma_f32_16x16x32_bf16 v[48:51], v[160:163], v[104:107], v[48:51]
    ds_read_b64_tr_b16 v[128:129], v120 offset:20480
    ds_read_b64_tr_b16 v[130:131], v120 offset:21504
    v_mfma_f32_16x16x32_bf16 v[52:55], v[164:167], v[104:107], v[52:55]
    ds_read_b64_tr_b16 v[132:133], v121 offset:20480
    ds_read_b64_tr_b16 v[134:135], v121 offset:21504
    v_mfma_f32_16x16x32_bf16 v[56:59], v[168:171], v[104:107], v[56:59]
    ds_read_b64_tr_b16 v[136:137], v122 offset:20480
    ds_read_b64_tr_b16 v[138:139], v122 offset:21504
    v_mfma_f32_16x16x32_bf16 v[60:63], v[172:175], v[104:107], v[60:63]
    ds_read_b64_tr_b16 v[140:141], v123 offset:20480
    ds_read_b64_tr_b16 v[142:143], v123 offset:21504
    s_waitcnt lgkmcnt(8)
    v_mfma_f32_16x16x32_bf16 v[48:51], v[176:179], v[108:111], v[48:51]
    ds_read_b64_tr_b16 v[144:145], v120 offset:24576
    ds_read_b64_tr_b16 v[146:147], v120 offset:25600
    v_mfma_f32_16x16x32_bf16 v[52:55], v[180:183], v[108:111], v[52:55]
    ds_read_b64_tr_b16 v[148:149], v121 offset:24576
    ds_read_b64_tr_b16 v[150:151], v121 offset:25600
    v_mfma_f32_16x16x32_bf16 v[56:59], v[184:187], v[108:111], v[56:59]
    ds_read_b64_tr_b16 v[152:153], v122 offset:24576
    ds_read_b64_tr_b16 v[154:155], v122 offset:25600
    v_mfma_f32_16x16x32_bf16 v[60:63], v[188:191], v[108:111], v[60:63]
    ds_read_b64_tr_b16 v[156:157], v123 offset:24576
    ds_read_b64_tr_b16 v[158:159], v123 offset:25600
    v_add_u32 v120, s5, v7
    v_add_u32 v121, s5, v8
    v_add_u32 v122, s5, v9
    v_add_u32 v123, s5, v10
    s_waitcnt lgkmcnt(8)
    v_mfma_f32_16x16x32_bf16 v[48:51], v[128:131], v[112:115], v[48:51]
    v_mfma_f32_16x16x32_bf16 v[52:55], v[132:135], v[112:115], v[52:55]
    v_mfma_f32_16x16x32_bf16 v[56:59], v[136:139], v[112:115], v[56:59]
    v_mfma_f32_16x16x32_bf16 v[60:63], v[140:143], v[112:115], v[60:63]
    s_waitcnt lgkmcnt(0)
    v_mfma_f32_16x16x32_bf16 v[48:51], v[144:147], v[116:119], v[48:51]
    v_mfma_f32_16x16x32_bf16 v[52:55], v[148:151], v[116:119], v[52:55]
    v_mfma_f32_16x16x32_bf16 v[56:59], v[152:155], v[116:119], v[56:59]
    v_mfma_f32_16x16x32_bf16 v[60:63], v[156:159], v[116:119], v[60:63]
    s_nop 4
    v_cvt_pk_bf16_f32 v240, v48, v49
    v_cvt_pk_bf16_f32 v241, v50, v51
    v_cvt_pk_bf16_f32 v242, v52, v53
    v_cvt_pk_bf16_f32 v243, v54, v55
    v_cvt_pk_bf16_f32 v244, v56, v57
    v_cvt_pk_bf16_f32 v245, v58, v59
    v_cvt_pk_bf16_f32 v246, v60, v61
    v_cvt_pk_bf16_f32 v247, v62, v63
    s_mov_b64 exec, s[82:83]
    v_swap_b32 v240, v242
    v_swap_b32 v241, v243
    v_swap_b32 v244, v246
    v_swap_b32 v245, v247
    s_mov_b64 exec, -1
    buffer_store_dwordx4 v[240:243], v3, s[60:63], s8 offen sc1
    buffer_store_dwordx4 v[244:247], v3, s[60:63], s8 offen offset:1024 sc1
    s_barrier
    ds_read_b64_tr_b16 v[128:129], v11 offset:0
    ds_read_b64_tr_b16 v[130:131], v11 offset:1024
    ds_read_b64_tr_b16 v[132:133], v12 offset:0
    ds_read_b64_tr_b16 v[134:135], v12 offset:1024
    ds_read_b64_tr_b16 v[136:137], v13 offset:0
    ds_read_b64_tr_b16 v[138:139], v13 offset:1024
    ds_read_b64_tr_b16 v[140:141], v14 offset:0
    ds_read_b64_tr_b16 v[142:143], v14 offset:1024
    ds_read_b64_tr_b16 v[144:145], v11 offset:4096
    ds_read_b64_tr_b16 v[146:147], v11 offset:5120
    ds_read_b64_tr_b16 v[148:149], v12 offset:4096
    ds_read_b64_tr_b16 v[150:151], v12 offset:5120
    ds_read_b64_tr_b16 v[152:153], v13 offset:4096
    ds_read_b64_tr_b16 v[154:155], v13 offset:5120
    ds_read_b64_tr_b16 v[156:157], v14 offset:4096
    ds_read_b64_tr_b16 v[158:159], v14 offset:5120
    s_waitcnt lgkmcnt(8)
    v_mfma_f32_16x16x32_bf16 v[224:227], v[128:131], v[64:67], 0
    ds_read_b64_tr_b16 v[160:161], v11 offset:8192
    ds_read_b64_tr_b16 v[162:163], v11 offset:9216
    v_mfma_f32_16x16x32_bf16 v[228:231], v[132:135], v[64:67], 0
    ds_read_b64_tr_b16 v[164:165], v12 offset:8192
    ds_read_b64_tr_b16 v[166:167], v12 offset:9216
    v_mfma_f32_16x16x32_bf16 v[232:235], v[136:139], v[64:67], 0
    ds_read_b64_tr_b16 v[168:169], v13 offset:8192
    ds_read_b64_tr_b16 v[170:171], v13 offset:9216
    v_mfma_f32_16x16x32_bf16 v[236:239], v[140:143], v[64:67], 0
    ds_read_b64_tr_b16 v[172:173], v14 offset:8192
    ds_read_b64_tr_b16 v[174:175], v14 offset:9216
    s_waitcnt lgkmcnt(8)
    v_mfma_f32_16x16x32_bf16 v[224:227], v[144:147], v[68:71], v[224:227]
    ds_read_b64_tr_b16 v[176:177], v11 offset:12288
    ds_read_b64_tr_b16 v[178:179], v11 offset:13312
    v_mfma_f32_16x16x32_bf16 v[228:231], v[148:151], v[68:71], v[228:231]
    ds_read_b64_tr_b16 v[180:181], v12 offset:12288
    ds_read_b64_tr_b16 v[182:183], v12 offset:13312
    v_mfma_f32_16x16x32_bf16 v[232:235], v[152:155], v[68:71], v[232:235]
    ds_read_b64_tr_b16 v[184:185], v13 offset:12288
    ds_read_b64_tr_b16 v[186:187], v13 offset:13312
    v_mfma_f32_16x16x32_bf16 v[236:239], v[156:159], v[68:71], v[236:239]
    ds_read_b64_tr_b16 v[188:189], v14 offset:12288
    ds_read_b64_tr_b16 v[190:191], v14 offset:13312
    s_waitcnt lgkmcnt(8)
    v_mfma_f32_16x16x32_bf16 v[224:227], v[160:163], v[72:75], v[224:227]
    ds_read_b64_tr_b16 v[128:129], v11 offset:16384
    ds_read_b64_tr_b16 v[130:131], v11 offset:17408
    v_mfma_f32_16x16x32_bf16 v[228:231], v[164:167], v[72:75], v[228:231]
    ds_read_b64_tr_b16 v[132:133], v12 offset:16384
    ds_read_b64_tr_b16 v[134:135], v12 offset:17408
    v_mfma_f32_16x16x32_bf16 v[232:235], v[168:171], v[72:75], v[232:235]
    ds_read_b64_tr_b16 v[136:137], v13 offset:16384
    ds_read_b64_tr_b16 v[138:139], v13 offset:17408
    v_mfma_f32_16x16x32_bf16 v[236:239], v[172:175], v[72:75], v[236:239]
    ds_read_b64_tr_b16 v[140:141], v14 offset:16384
    ds_read_b64_tr_b16 v[142:143], v14 offset:17408
    s_waitcnt lgkmcnt(8)
    v_mfma_f32_16x16x32_bf16 v[224:227], v[176:179], v[76:79], v[224:227]
    ds_read_b64_tr_b16 v[144:145], v11 offset:20480
    ds_read_b64_tr_b16 v[146:147], v11 offset:21504
    v_mfma_f32_16x16x32_bf16 v[228:231], v[180:183], v[76:79], v[228:231]
    ds_read_b64_tr_b16 v[148:149], v12 offset:20480
    ds_read_b64_tr_b16 v[150:151], v12 offset:21504
    v_mfma_f32_16x16x32_bf16 v[232:235], v[184:187], v[76:79], v[232:235]
    ds_read_b64_tr_b16 v[152:153], v13 offset:20480
    ds_read_b64_tr_b16 v[154:155], v13 offset:21504
    v_mfma_f32_16x16x32_bf16 v[236:239], v[188:191], v[76:79], v[236:239]
    ds_read_b64_tr_b16 v[156:157], v14 offset:20480
    ds_read_b64_tr_b16 v[158:159], v14 offset:21504
    s_waitcnt lgkmcnt(8)
    v_mfma_f32_16x16x32_bf16 v[224:227], v[128:131], v[80:83], v[224:227]
    ds_read_b64_tr_b16 v[160:161], v11 offset:24576
    ds_read_b64_tr_b16 v[162:163], v11 offset:25600
    v_mfma_f32_16x16x32_bf16 v[228:231], v[132:135], v[80:83], v[228:231]
    ds_read_b64_tr_b16 v[164:165], v12 offset:24576
    ds_read_b64_tr_b16 v[166:167], v12 offset:25600
    v_mfma_f32_16x16x32_bf16 v[232:235], v[136:139], v[80:83], v[232:235]
    ds_read_b64_tr_b16 v[168:169], v13 offset:24576
    ds_read_b64_tr_b16 v[170:171], v13 offset:25600
    v_mfma_f32_16x16x32_bf16 v[236:239], v[140:143], v[80:83], v[236:239]
    ds_read_b64_tr_b16 v[172:173], v14 offset:24576
    ds_read_b64_tr_b16 v[174:175], v14 offset:25600
    v_add_u32 v11, s6, v7
    v_add_u32 v12, s6, v8
    v_add_u32 v13, s6, v9
    v_add_u32 v14, s6, v10
    s_waitcnt lgkmcnt(8)
    v_mfma_f32_16x16x32_bf16 v[224:227], v[144:147], v[84:87], v[224:227]
    ds_read_b64_tr_b16 v[176:177], v120 offset:0
    ds_read_b64_tr_b16 v[178:179], v120 offset:1024
    v_mfma_f32_16x16x32_bf16 v[228:231], v[148:151], v[84:87], v[228:231]
    ds_read_b64_tr_b16 v[180:181], v121 offset:0
    ds_read_b64_tr_b16 v[182:183], v121 offset:1024
    v_mfma_f32_16x16x32_bf16 v[232:235], v[152:155], v[84:87], v[232:235]
    ds_read_b64_tr_b16 v[184:185], v122 offset:0
    ds_read_b64_tr_b16 v[186:187], v122 offset:1024
    v_mfma_f32_16x16x32_bf16 v[236:239], v[156:159], v[84:87], v[236:239]
    ds_read_b64_tr_b16 v[188:189], v123 offset:0
    ds_read_b64_tr_b16 v[190:191], v123 offset:1024
    s_waitcnt lgkmcnt(8)
    v_mfma_f32_16x16x32_bf16 v[224:227], v[160:163], v[88:91], v[224:227]
    ds_read_b64_tr_b16 v[128:129], v120 offset:4096
    ds_read_b64_tr_b16 v[130:131], v120 offset:5120
    v_mfma_f32_16x16x32_bf16 v[228:231], v[164:167], v[88:91], v[228:231]
    ds_read_b64_tr_b16 v[132:133], v121 offset:4096
    ds_read_b64_tr_b16 v[134:135], v121 offset:5120
    v_mfma_f32_16x16x32_bf16 v[232:235], v[168:171], v[88:91], v[232:235]
    ds_read_b64_tr_b16 v[136:137], v122 offset:4096
    ds_read_b64_tr_b16 v[138:139], v122 offset:5120
    v_mfma_f32_16x16x32_bf16 v[236:239], v[172:175], v[88:91], v[236:239]
    ds_read_b64_tr_b16 v[140:141], v123 offset:4096
    ds_read_b64_tr_b16 v[142:143], v123 offset:5120
    s_waitcnt lgkmcnt(8)
    v_mfma_f32_16x16x32_bf16 v[224:227], v[176:179], v[92:95], v[224:227]
    ds_read_b64_tr_b16 v[144:145], v120 offset:8192
    ds_read_b64_tr_b16 v[146:147], v120 offset:9216
    v_mfma_f32_16x16x32_bf16 v[228:231], v[180:183], v[92:95], v[228:231]
    ds_read_b64_tr_b16 v[148:149], v121 offset:8192
    ds_read_b64_tr_b16 v[150:151], v121 offset:9216
    v_mfma_f32_16x16x32_bf16 v[232:235], v[184:187], v[92:95], v[232:235]
    ds_read_b64_tr_b16 v[152:153], v122 offset:8192
    ds_read_b64_tr_b16 v[154:155], v122 offset:9216
    v_mfma_f32_16x16x32_bf16 v[236:239], v[188:191], v[92:95], v[236:239]
    ds_read_b64_tr_b16 v[156:157], v123 offset:8192
    ds_read_b64_tr_b16 v[158:159], v123 offset:9216
    s_waitcnt lgkmcnt(8)
    v_mfma_f32_16x16x32_bf16 v[224:227], v[128:131], v[96:99], v[224:227]
    ds_read_b64_tr_b16 v[160:161], v120 offset:12288
    ds_read_b64_tr_b16 v[162:163], v120 offset:13312
    v_mfma_f32_16x16x32_bf16 v[228:231], v[132:135], v[96:99], v[228:231]
    ds_read_b64_tr_b16 v[164:165], v121 offset:12288
    ds_read_b64_tr_b16 v[166:167], v121 offset:13312
    v_mfma_f32_16x16x32_bf16 v[232:235], v[136:139], v[96:99], v[232:235]
    ds_read_b64_tr_b16 v[168:169], v122 offset:12288
    ds_read_b64_tr_b16 v[170:171], v122 offset:13312
    v_mfma_f32_16x16x32_bf16 v[236:239], v[140:143], v[96:99], v[236:239]
    ds_read_b64_tr_b16 v[172:173], v123 offset:12288
    ds_read_b64_tr_b16 v[174:175], v123 offset:13312
    s_waitcnt vmcnt(0)
    s_mov_b64 exec, 1
    buffer_store_dword v15, off, s[60:63], s10 sc1
    s_mov_b64 exec, -1
    s_waitcnt lgkmcnt(8)
    v_mfma_f32_16x16x32_bf16 v[224:227], v[144:147], v[100:103], v[224:227]
    ds_read_b64_tr_b16 v[176:177], v120 offset:16384
    ds_read_b64_tr_b16 v[178:179], v120 offset:17408
    v_mfma_f32_16x16x32_bf16 v[228:231], v[148:151], v[100:103], v[228:231]
    ds_read_b64_tr_b16 v[180:181], v121 offset:16384
    ds_read_b64_tr_b16 v[182:183], v121 offset:17408
    v_mfma_f32_16x16x32_bf16 v[232:235], v[152:155], v[100:103], v[232:235]
    ds_read_b64_tr_b16 v[184:185], v122 offset:16384
    ds_read_b64_tr_b16 v[186:187], v122 offset:17408
    v_mfma_f32_16x16x32_bf16 v[236:239], v[156:159], v[100:103], v[236:239]
    ds_read_b64_tr_b16 v[188:189], v123 offset:16384
    ds_read_b64_tr_b16 v[190:191], v123 offset:17408
    ds_read_b32 v126, v124 offset:112
    s_waitcnt lgkmcnt(9)
    v_mfma_f32_16x16x32_bf16 v[224:227], v[160:163], v[104:107], v[224:227]
    ds_read_b64_tr_b16 v[128:129], v120 offset:20480
    ds_read_b64_tr_b16 v[130:131], v120 offset:21504
    v_mfma_f32_16x16x32_bf16 v[228:231], v[164:167], v[104:107], v[228:231]
    ds_read_b64_tr_b16 v[132:133], v121 offset:20480
    ds_read_b64_tr_b16 v[134:135], v121 offset:21504
    v_mfma_f32_16x16x32_bf16 v[232:235], v[168:171], v[104:107], v[232:235]
    ds_read_b64_tr_b16 v[136:137], v122 offset:20480
    ds_read_b64_tr_b16 v[138:139], v122 offset:21504
    v_mfma_f32_16x16x32_bf16 v[236:239], v[172:175], v[104:107], v[236:239]
    ds_read_b64_tr_b16 v[140:141], v123 offset:20480
    ds_read_b64_tr_b16 v[142:143], v123 offset:21504
    s_waitcnt lgkmcnt(9)
    v_mfma_f32_16x16x32_bf16 v[224:227], v[176:179], v[108:111], v[224:227]
    ds_read_b64_tr_b16 v[144:145], v120 offset:24576
    ds_read_b64_tr_b16 v[146:147], v120 offset:25600
    v_mfma_f32_16x16x32_bf16 v[228:231], v[180:183], v[108:111], v[228:231]
    ds_read_b64_tr_b16 v[148:149], v121 offset:24576
    ds_read_b64_tr_b16 v[150:151], v121 offset:25600
    v_mfma_f32_16x16x32_bf16 v[232:235], v[184:187], v[108:111], v[232:235]
    ds_read_b64_tr_b16 v[152:153], v122 offset:24576
    ds_read_b64_tr_b16 v[154:155], v122 offset:25600
    v_mfma_f32_16x16x32_bf16 v[236:239], v[188:191], v[108:111], v[236:239]
    ds_read_b64_tr_b16 v[156:157], v123 offset:24576
    ds_read_b64_tr_b16 v[158:159], v123 offset:25600
    s_waitcnt lgkmcnt(15)
    v_cmp_gt_u32 vcc, 4, v126
    s_cbranch_vccz Lvk_1
    s_mov_b32 s97, 0x61a80
Lvl_2:
    ds_read_b32 v126, v124 offset:112
    s_sub_u32 s97, s97, 1
    s_waitcnt lgkmcnt(0)
    v_cmp_gt_u32 vcc, 4, v126
    s_cbranch_vccz Lvk_1
    s_cmp_lg_u32 s97, 0
    s_cbranch_scc1 Lvl_2
Lvk_1:
    v_add_u32 v120, s7, v7
    v_add_u32 v121, s7, v8
    v_add_u32 v122, s7, v9
    v_add_u32 v123, s7, v10
    s_waitcnt lgkmcnt(8)
    v_mfma_f32_16x16x32_bf16 v[224:227], v[128:131], v[112:115], v[224:227]
    ds_read_b64_tr_b16 v[160:161], v11 offset:0
    ds_read_b64_tr_b16 v[162:163], v11 offset:1024
    v_mfma_f32_16x16x32_bf16 v[228:231], v[132:135], v[112:115], v[228:231]
    ds_read_b64_tr_b16 v[164:165], v12 offset:0
    ds_read_b64_tr_b16 v[166:167], v12 offset:1024
    v_mfma_f32_16x16x32_bf16 v[232:235], v[136:139], v[112:115], v[232:235]
    ds_read_b64_tr_b16 v[168:169], v13 offset:0
    ds_read_b64_tr_b16 v[170:171], v13 offset:1024
    v_mfma_f32_16x16x32_bf16 v[236:239], v[140:143], v[112:115], v[236:239]
    ds_read_b64_tr_b16 v[172:173], v14 offset:0
    ds_read_b64_tr_b16 v[174:175], v14 offset:1024
    s_waitcnt lgkmcnt(8)
    v_mfma_f32_16x16x32_bf16 v[224:227], v[144:147], v[116:119], v[224:227]
    ds_read_b64_tr_b16 v[176:177], v11 offset:4096
    ds_read_b64_tr_b16 v[178:179], v11 offset:5120
    v_mfma_f32_16x16x32_bf16 v[228:231], v[148:151], v[116:119], v[228:231]
    ds_read_b64_tr_b16 v[180:181], v12 offset:4096
    ds_read_b64_tr_b16 v[182:183], v12 offset:5120
    v_mfma_f32_16x16x32_bf16 v[232:235], v[152:155], v[116:119], v[232:235]
    ds_read_b64_tr_b16 v[184:185], v13 offset:4096
    ds_read_b64_tr_b16 v[186:187], v13 offset:5120
    v_mfma_f32_16x16x32_bf16 v[236:239], v[156:159], v[116:119], v[236:239]
    ds_read_b64_tr_b16 v[188:189], v14 offset:4096
    ds_read_b64_tr_b16 v[190:191], v14 offset:5120
    s_waitcnt lgkmcnt(8)
    v_mfma_f32_16x16x32_bf16 v[48:51], v[160:163], v[64:67], 0
    ds_read_b64_tr_b16 v[128:129], v11 offset:8192
    ds_read_b64_tr_b16 v[130:131], v11 offset:9216
    v_mfma_f32_16x16x32_bf16 v[52:55], v[164:167], v[64:67], 0
    ds_read_b64_tr_b16 v[132:133], v12 offset:8192
    ds_read_b64_tr_b16 v[134:135], v12 offset:9216
    v_mfma_f32_16x16x32_bf16 v[56:59], v[168:171], v[64:67], 0
    ds_read_b64_tr_b16 v[136:137], v13 offset:8192
    ds_read_b64_tr_b16 v[138:139], v13 offset:9216
    v_mfma_f32_16x16x32_bf16 v[60:63], v[172:175], v[64:67], 0
    ds_read_b64_tr_b16 v[140:141], v14 offset:8192
    ds_read_b64_tr_b16 v[142:143], v14 offset:9216
    s_waitcnt lgkmcnt(8)
    v_mfma_f32_16x16x32_bf16 v[48:51], v[176:179], v[68:71], v[48:51]
    ds_read_b64_tr_b16 v[144:145], v11 offset:12288
    ds_read_b64_tr_b16 v[146:147], v11 offset:13312
    v_cvt_pk_bf16_f32 v240, v224, v225
    v_cvt_pk_bf16_f32 v241, v226, v227
    v_cvt_pk_bf16_f32 v242, v228, v229
    v_mfma_f32_16x16x32_bf16 v[52:55], v[180:183], v[68:71], v[52:55]
    ds_read_b64_tr_b16 v[148:149], v12 offset:12288
    ds_read_b64_tr_b16 v[150:151], v12 offset:13312
    v_cvt_pk_bf16_f32 v243, v230, v231
    v_cvt_pk_bf16_f32 v244, v232, v233
    v_cvt_pk_bf16_f32 v245, v234, v235
    v_mfma_f32_16x16x32_bf16 v[56:59], v[184:187], v[68:71], v[56:59]
    ds_read_b64_tr_b16 v[152:153], v13 offset:12288
    ds_read_b64_tr_b16 v[154:155], v13 offset:13312
    v_cvt_pk_bf16_f32 v246, v236, v237
    v_cvt_pk_bf16_f32 v247, v238, v239
    s_mov_b64 exec, s[82:83]
    v_swap_b32 v240, v242
    v_swap_b32 v241, v243
    v_swap_b32 v244, v246
    v_swap_b32 v245, v247
    s_mov_b64 exec, -1
    buffer_store_dwordx4 v[240:243], v3, s[60:63], s9 offen sc1
    buffer_store_dwordx4 v[244:247], v3, s[60:63], s9 offen offset:1024 sc1
    v_mfma_f32_16x16x32_bf16 v[60:63], v[188:191], v[68:71], v[60:63]
    ds_read_b64_tr_b16 v[156:157], v14 offset:12288
    ds_read_b64_tr_b16 v[158:159], v14 offset:13312
    s_waitcnt lgkmcnt(8)
    v_mfma_f32_16x16x32_bf16 v[48:51], v[128:131], v[72:75], v[48:51]
    ds_read_b64_tr_b16 v[160:161], v11 offset:16384
    ds_read_b64_tr_b16 v[162:163], v11 offset:17408
    v_mfma_f32_16x16x32_bf16 v[52:55], v[132:135], v[72:75], v[52:55]
    ds_read_b64_tr_b16 v[164:165], v12 offset:16384
    ds_read_b64_tr_b16 v[166:167], v12 offset:17408
    v_mfma_f32_16x16x32_bf16 v[56:59], v[136:139], v[72:75], v[56:59]
    ds_read_b64_tr_b16 v[168:169], v13 offset:16384
    ds_read_b64_tr_b16 v[170:171], v13 offset:17408
    v_mfma_f32_16x16x32_bf16 v[60:63], v[140:143], v[72:75], v[60:63]
    ds_read_b64_tr_b16 v[172:173], v14 offset:16384
    ds_read_b64_tr_b16 v[174:175], v14 offset:17408
    s_waitcnt lgkmcnt(8)
    v_mfma_f32_16x16x32_bf16 v[48:51], v[144:147], v[76:79], v[48:51]
    ds_read_b64_tr_b16 v[176:177], v11 offset:20480
    ds_read_b64_tr_b16 v[178:179], v11 offset:21504
    v_mfma_f32_16x16x32_bf16 v[52:55], v[148:151], v[76:79], v[52:55]
    ds_read_b64_tr_b16 v[180:181], v12 offset:20480
    ds_read_b64_tr_b16 v[182:183], v12 offset:21504
    v_mfma_f32_16x16x32_bf16 v[56:59], v[152:155], v[76:79], v[56:59]
    ds_read_b64_tr_b16 v[184:185], v13 offset:20480
    ds_read_b64_tr_b16 v[186:187], v13 offset:21504
    v_mfma_f32_16x16x32_bf16 v[60:63], v[156:159], v[76:79], v[60:63]
    ds_read_b64_tr_b16 v[188:189], v14 offset:20480
    ds_read_b64_tr_b16 v[190:191], v14 offset:21504
    s_waitcnt lgkmcnt(8)
    v_mfma_f32_16x16x32_bf16 v[48:51], v[160:163], v[80:83], v[48:51]
    ds_read_b64_tr_b16 v[128:129], v11 offset:24576
    ds_read_b64_tr_b16 v[130:131], v11 offset:25600
    v_mfma_f32_16x16x32_bf16 v[52:55], v[164:167], v[80:83], v[52:55]
    ds_read_b64_tr_b16 v[132:133], v12 offset:24576
    ds_read_b64_tr_b16 v[134:135], v12 offset:25600
    v_mfma_f32_16x16x32_bf16 v[56:59], v[168:171], v[80:83], v[56:59]
    ds_read_b64_tr_b16 v[136:137], v13 offset:24576
    ds_read_b64_tr_b16 v[138:139], v13 offset:25600
    v_mfma_f32_16x16x32_bf16 v[60:63], v[172:175], v[80:83], v[60:63]
    ds_read_b64_tr_b16 v[140:141], v14 offset:24576
    ds_read_b64_tr_b16 v[142:143], v14 offset:25600
    s_waitcnt lgkmcnt(8)
    v_mfma_f32_16x16x32_bf16 v[48:51], v[176:179], v[84:87], v[48:51]
    ds_read_b64_tr_b16 v[144:145], v120 offset:0
    ds_read_b64_tr_b16 v[146:147], v120 offset:1024
    v_mfma_f32_16x16x32_bf16 v[52:55], v[180:183], v[84:87], v[52:55]
    ds_read_b64_tr_b16 v[148:149], v121 offset:0
    ds_read_b64_tr_b16 v[150:151], v121 offset:1024
    v_mfma_f32_16x16x32_bf16 v[56:59], v[184:187], v[84:87], v[56:59]
    ds_read_b64_tr_b16 v[152:153], v122 offset:0
    ds_read_b64_tr_b16 v[154:155], v122 offset:1024
    v_mfma_f32_16x16x32_bf16 v[60:63], v[188:191], v[84:87], v[60:63]
    ds_read_b64_tr_b16 v[156:157], v123 offset:0
    ds_read_b64_tr_b16 v[158:159], v123 offset:1024
    s_waitcnt lgkmcnt(8)
    v_mfma_f32_16x16x32_bf16 v[48:51], v[128:131], v[88:91], v[48:51]
    ds_read_b64_tr_b16 v[160:161], v120 offset:4096
    ds_read_b64_tr_b16 v[162:163], v120 offset:5120
    v_mfma_f32_16x16x32_bf16 v[52:55], v[132:135], v[88:91], v[52:55]
    ds_read_b64_tr_b16 v[164:165], v121 offset:4096
    ds_read_b64_tr_b16 v[166:167], v121 offset:5120
    v_mfma_f32_16x16x32_bf16 v[56:59], v[136:139], v[88:91], v[56:59]
    ds_read_b64_tr_b16 v[168:169], v122 offset:4096
    ds_read_b64_tr_b16 v[170:171], v122 offset:5120
    v_mfma_f32_16x16x32_bf16 v[60:63], v[140:143], v[88:91], v[60:63]
    ds_read_b64_tr_b16 v[172:173], v123 offset:4096
    ds_read_b64_tr_b16 v[174:175], v123 offset:5120
    s_waitcnt lgkmcnt(8)
    v_mfma_f32_16x16x32_bf16 v[48:51], v[144:147], v[92:95], v[48:51]
    ds_read_b64_tr_b16 v[176:177], v120 offset:8192
    ds_read_b64_tr_b16 v[178:179], v120 offset:9216
    v_mfma_f32_16x16x32_bf16 v[52:55], v[148:151], v[92:95], v[52:55]
    ds_read_b64_tr_b16 v[180:181], v121 offset:8192
    ds_read_b64_tr_b16 v[182:183], v121 offset:9216
    v_mfma_f32_16x16x32_bf16 v[56:59], v[152:155], v[92:95], v[56:59]
    ds_read_b64_tr_b16 v[184:185], v122 offset:8192
    ds_read_b64_tr_b16 v[186:187], v122 offset:9216
    v_mfma_f32_16x16x32_bf16 v[60:63], v[156:159], v[92:95], v[60:63]
    ds_read_b64_tr_b16 v[188:189], v123 offset:8192
    ds_read_b64_tr_b16 v[190:191], v123 offset:9216
    s_waitcnt lgkmcnt(8)
    v_mfma_f32_16x16x32_bf16 v[48:51], v[160:163], v[96:99], v[48:51]
    ds_read_b64_tr_b16 v[128:129], v120 offset:12288
    ds_read_b64_tr_b16 v[130:131], v120 offset:13312
    v_mfma_f32_16x16x32_bf16 v[52:55], v[164:167], v[96:99], v[52:55]
    ds_read_b64_tr_b16 v[132:133], v121 offset:12288
    ds_read_b64_tr_b16 v[134:135], v121 offset:13312
    v_mfma_f32_16x16x32_bf16 v[56:59], v[168:171], v[96:99], v[56:59]
    ds_read_b64_tr_b16 v[136:137], v122 offset:12288
    ds_read_b64_tr_b16 v[138:139], v122 offset:13312
    v_mfma_f32_16x16x32_bf16 v[60:63], v[172:175], v[96:99], v[60:63]
    ds_read_b64_tr_b16 v[140:141], v123 offset:12288
    ds_read_b64_tr_b16 v[142:143], v123 offset:13312
    s_waitcnt lgkmcnt(8)
    v_mfma_f32_16x16x32_bf16 v[48:51], v[176:179], v[100:103], v[48:51]
    ds_read_b64_tr_b16 v[144:145], v120 offset:16384
    ds_read_b64_tr_b16 v[146:147], v120 offset:17408
    v_mfma_f32_16x16x32_bf16 v[52:55], v[180:183], v[100:103], v[52:55]
    ds_read_b64_tr_b16 v[148:149], v121 offset:16384
    ds_read_b64_tr_b16 v[150:151], v121 offset:17408
    v_mfma_f32_16x16x32_bf16 v[56:59], v[184:187], v[100:103], v[56:59]
    ds_read_b64_tr_b16 v[152:153], v122 offset:16384
    ds_read_b64_tr_b16 v[154:155], v122 offset:17408
    v_mfma_f32_16x16x32_bf16 v[60:63], v[188:191], v[100:103], v[60:63]
    ds_read_b64_tr_b16 v[156:157], v123 offset:16384
    ds_read_b64_tr_b16 v[158:159], v123 offset:17408
    ds_read_b32 v126, v124 offset:120
    s_waitcnt lgkmcnt(9)
    v_mfma_f32_16x16x32_bf16 v[48:51], v[128:131], v[104:107], v[48:51]
    ds_read_b64_tr_b16 v[160:161], v120 offset:20480
    ds_read_b64_tr_b16 v[162:163], v120 offset:21504
    v_mfma_f32_16x16x32_bf16 v[52:55], v[132:135], v[104:107], v[52:55]
    ds_read_b64_tr_b16 v[164:165], v121 offset:20480
    ds_read_b64_tr_b16 v[166:167], v121 offset:21504
    v_mfma_f32_16x16x32_bf16 v[56:59], v[136:139], v[104:107], v[56:59]
    ds_read_b64_tr_b16 v[168:169], v122 offset:20480
    ds_read_b64_tr_b16 v[170:171], v122 offset:21504
    v_mfma_f32_16x16x32_bf16 v[60:63], v[140:143], v[104:107], v[60:63]
    ds_read_b64_tr_b16 v[172:173], v123 offset:20480
    ds_read_b64_tr_b16 v[174:175], v123 offset:21504
    s_waitcnt lgkmcnt(9)
    v_mfma_f32_16x16x32_bf16 v[48:51], v[144:147], v[108:111], v[48:51]
    ds_read_b64_tr_b16 v[176:177], v120 offset:24576
    ds_read_b64_tr_b16 v[178:179], v120 offset:25600
    v_mfma_f32_16x16x32_bf16 v[52:55], v[148:151], v[108:111], v[52:55]
    ds_read_b64_tr_b16 v[180:181], v121 offset:24576
    ds_read_b64_tr_b16 v[182:183], v121 offset:25600
    v_mfma_f32_16x16x32_bf16 v[56:59], v[152:155], v[108:111], v[56:59]
    ds_read_b64_tr_b16 v[184:185], v122 offset:24576
    ds_read_b64_tr_b16 v[186:187], v122 offset:25600
    v_mfma_f32_16x16x32_bf16 v[60:63], v[156:159], v[108:111], v[60:63]
    ds_read_b64_tr_b16 v[188:189], v123 offset:24576
    ds_read_b64_tr_b16 v[190:191], v123 offset:25600
    s_waitcnt lgkmcnt(15)
    v_cmp_gt_u32 vcc, 4, v126
    s_cbranch_vccz Lvk_3
    s_mov_b32 s97, 0x61a80
Lvl_4:
    ds_read_b32 v126, v124 offset:120
    s_sub_u32 s97, s97, 1
    s_waitcnt lgkmcnt(0)
    v_cmp_gt_u32 vcc, 4, v126
    s_cbranch_vccz Lvk_3
    s_cmp_lg_u32 s97, 0
    s_cbranch_scc1 Lvl_4
Lvk_3:
    ds_read_b32 v249, v249
    s_waitcnt lgkmcnt(9)
    v_mfma_f32_16x16x32_bf16 v[48:51], v[160:163], v[112:115], v[48:51]
    v_mfma_f32_16x16x32_bf16 v[52:55], v[164:167], v[112:115], v[52:55]
    v_mfma_f32_16x16x32_bf16 v[56:59], v[168:171], v[112:115], v[56:59]
    v_mfma_f32_16x16x32_bf16 v[60:63], v[172:175], v[112:115], v[60:63]
    s_waitcnt lgkmcnt(1)
    v_mfma_f32_16x16x32_bf16 v[48:51], v[176:179], v[116:119], v[48:51]
    v_mfma_f32_16x16x32_bf16 v[52:55], v[180:183], v[116:119], v[52:55]
    v_mfma_f32_16x16x32_bf16 v[56:59], v[184:187], v[116:119], v[56:59]
    v_mfma_f32_16x16x32_bf16 v[60:63], v[188:191], v[116:119], v[60:63]
    s_waitcnt lgkmcnt(0)
    v_readfirstlane_b32 s77, v249
    s_nop 2
    v_pk_mul_f32 v[48:49], v[48:49], v[248:249] op_sel_hi:[1,0]
    v_pk_mul_f32 v[50:51], v[50:51], v[248:249] op_sel_hi:[1,0]
    v_pk_mul_f32 v[52:53], v[52:53], v[248:249] op_sel_hi:[1,0]
    v_pk_mul_f32 v[54:55], v[54:55], v[248:249] op_sel_hi:[1,0]
    v_pk_mul_f32 v[56:57], v[56:57], v[248:249] op_sel_hi:[1,0]
    v_pk_mul_f32 v[58:59], v[58:59], v[248:249] op_sel_hi:[1,0]
    v_pk_mul_f32 v[60:61], v[60:61], v[248:249] op_sel_hi:[1,0]
    v_pk_mul_f32 v[62:63], v[62:63], v[248:249] op_sel_hi:[1,0]
    v_cvt_pk_bf16_f32 v240, v48, v49
    v_cvt_pk_bf16_f32 v241, v50, v51
    v_cvt_pk_bf16_f32 v242, v52, v53
    v_cvt_pk_bf16_f32 v243, v54, v55
    v_cvt_pk_bf16_f32 v244, v56, v57
    v_cvt_pk_bf16_f32 v245, v58, v59
    v_cvt_pk_bf16_f32 v246, v60, v61
    v_cvt_pk_bf16_f32 v247, v62, v63
    s_mov_b64 exec, s[82:83]
    v_swap_b32 v240, v242
    v_swap_b32 v241, v243
    v_swap_b32 v244, v246
    v_swap_b32 v245, v247
    s_mov_b64 exec, -1
    s_cmp_eq_u32 s77, 1
    s_cbranch_scc0 Lsl_5
    buffer_store_dwordx4 v[240:243], v3, s[60:63], s86 offen
    buffer_store_dwordx4 v[244:247], v3, s[60:63], s86 offen offset:1024
    s_branch Lse_6
Lsl_5:
    buffer_store_dwordx4 v[240:243], v3, s[60:63], s86 offen sc1
    buffer_store_dwordx4 v[244:247], v3, s[60:63], s86 offen offset:1024 sc1
Lse_6:
    s_waitcnt vmcnt(2)
    s_mov_b64 exec, 1
    buffer_store_dword v15, off, s[60:63], s11 sc1
    s_mov_b64 exec, -1
    s_lshr_b32 s84, s70, 1
    s_mul_i32 s79, s84, 0
    s_lshl_b32 s84, s84, 3
    s_lshl_b32 s85, s73, 1
    s_add_u32 s0, s84, s85
    s_add_u32 s79, s79, s71
    s_cmp_ge_u32 s79, 7
    s_cselect_b32 s84, 7, 0
    s_sub_u32 s79, s79, s84
    s_bitcmp1_b32 s70, 0
    s_cselect_b32 s84, 0x1c00, 0
    s_add_u32 s84, s84, s74
    s_mul_i32 s18, s79, 0x400
    s_add_u32 s18, s18, s84
    s_add_u32 s79, s79, 1
    s_cmp_eq_u32 s79, 7
    s_cmov_b32 s79, 0
    s_mul_i32 s19, s79, 0x400
    s_add_u32 s19, s19, s84
    s_add_u32 s79, s79, 1
    s_cmp_eq_u32 s79, 7
    s_cmov_b32 s79, 0
    s_mul_i32 s20, s79, 0x400
    s_add_u32 s20, s20, s84
    s_add_u32 s79, s79, 1
    s_cmp_eq_u32 s79, 7
    s_cmov_b32 s79, 0
    s_mul_i32 s21, s79, 0x400
    s_add_u32 s21, s21, s84
    s_add_u32 s79, s79, 1
    s_cmp_eq_u32 s79, 7
    s_cmov_b32 s79, 0
    s_mul_i32 s22, s79, 0x400
    s_add_u32 s22, s22, s84
    s_add_u32 s79, s79, 1
    s_cmp_eq_u32 s79, 7
    s_cmov_b32 s79, 0
    s_mul_i32 s23, s79, 0x400
    s_add_u32 s23, s23, s84
    s_add_u32 s79, s79, 1
    s_cmp_eq_u32 s79, 7
    s_cmov_b32 s79, 0
    s_mul_i32 s3, s79, 0x400
    s_add_u32 s3, s3, s84
    s_waitcnt vmcnt(1)
    s_cmp_eq_u32 s77, 1
    s_cbranch_scc0 Lsl_7
    s_mov_b64 exec, 1
    buffer_store_dword v15, off, s[60:63], s87
    s_mov_b64 exec, -1
    s_branch Lse_8
Lsl_7:
    s_mov_b64 exec, 1
    buffer_store_dword v15, off, s[60:63], s87 sc1
    s_mov_b64 exec, -1
Lse_8:
    v_cmp_gt_u32 vcc, 3, v2
    v_subrev_u32 v5, 0x100, v3
    s_nop 0
    v_cndmask_b32 v5, v5, v3, vcc
    v_mov_b32 v46, 1.0
    v_cndmask_b32 v46, 0, v46, vcc
    v_lshlrev_b32 v6, 4, v2
    v_add_u32 v6, 0x20000, v6
    s_lshl_b32 s85, s68, 8
    s_lshl_b32 s84, s76, 4
    s_add_u32 s85, s85, s84
    v_mov_b32 v251, 0x40000000
    s_add_u32 s84, s85, -1
    v_add_u32 v248, s84, v1
    v_lshrrev_b32 v249, 8, v248
    v_bfe_u32 v250, v248, 4, 4
    v_mul_u32_u24 v36, 0x3800, v250
    v_add_u32 v36, 0x0, v36
    v_and_b32 v250, 1, v250
    v_mul_u32_u24 v250, 0x3800, v250
    v_add_u32 v250, 0xe0000, v250
    v_cmp_ne_u32 vcc, s68, v249
    s_nop 1
    v_cndmask_b32 v36, v36, v250, vcc
    v_lshl_add_u32 v36, v249, 21, v36
    v_and_b32 v249, 15, v248
    v_lshl_add_u32 v36, v249, 4, v36
    v_lshl_add_u32 v36, v2, 8, v36
    v_cmp_gt_u32 vcc, 0x800, v248
    s_nop 1
    v_cndmask_b32 v36, v251, v36, vcc
    s_add_u32 s84, s85, 1
    v_add_u32 v248, s84, v1
    v_lshrrev_b32 v249, 8, v248
    v_bfe_u32 v250, v248, 4, 4
    v_mul_u32_u24 v37, 0x3800, v250
    v_add_u32 v37, 0x0, v37
    v_and_b32 v250, 1, v250
    v_mul_u32_u24 v250, 0x3800, v250
    v_add_u32 v250, 0xe0000, v250
    v_cmp_ne_u32 vcc, s68, v249
    s_nop 1
    v_cndmask_b32 v37, v37, v250, vcc
    v_lshl_add_u32 v37, v249, 21, v37
    v_and_b32 v249, 15, v248
    v_lshl_add_u32 v37, v249, 4, v37
    v_lshl_add_u32 v37, v2, 8, v37
    v_cmp_gt_u32 vcc, 0x800, v248
    s_nop 1
    v_cndmask_b32 v37, v251, v37, vcc
    s_add_u32 s84, s85, -2
    v_add_u32 v248, s84, v1
    v_lshrrev_b32 v249, 8, v248
    v_bfe_u32 v250, v248, 4, 4
    v_mul_u32_u24 v39, 0x3800, v250
    v_add_u32 v39, 0x0, v39
    v_and_b32 v250, 1, v250
    v_mul_u32_u24 v250, 0x3800, v250
    v_add_u32 v250, 0xe0000, v250
    v_cmp_ne_u32 vcc, s68, v249
    s_nop 1
    v_cndmask_b32 v39, v39, v250, vcc
    v_lshl_add_u32 v39, v249, 21, v39
    v_and_b32 v249, 15, v248
    v_lshl_add_u32 v39, v249, 4, v39
    v_lshl_add_u32 v39, v2, 8, v39
    v_cmp_gt_u32 vcc, 0x800, v248
    s_nop 1
    v_cndmask_b32 v39, v251, v39, vcc
    s_add_u32 s84, s85, 2
    v_add_u32 v248, s84, v1
    v_lshrrev_b32 v249, 8, v248
    v_bfe_u32 v250, v248, 4, 4
    v_mul_u32_u24 v40, 0x3800, v250
    v_add_u32 v40, 0x0, v40
    v_and_b32 v250, 1, v250
    v_mul_u32_u24 v250, 0x3800, v250
    v_add_u32 v250, 0xe0000, v250
    v_cmp_ne_u32 vcc, s68, v249
    s_nop 1
    v_cndmask_b32 v40, v40, v250, vcc
    v_lshl_add_u32 v40, v249, 21, v40
    v_and_b32 v249, 15, v248
    v_lshl_add_u32 v40, v249, 4, v40
    v_lshl_add_u32 v40, v2, 8, v40
    v_cmp_gt_u32 vcc, 0x800, v248
    s_nop 1
    v_cndmask_b32 v40, v251, v40, vcc
    v_cmp_gt_u32 vcc, 2, v2
    s_nop 1
    v_cndmask_b32 v38, v37, v36, vcc
    v_cndmask_b32 v41, v40, v39, vcc
    s_lshr_b32 s85, s85, 4
    s_sub_u32 s84, s85, 1
    v_min_u32 v248, 2, v2
    v_add_u32 v248, s84, v248
    v_max_i32 v248, 0, v248
    v_min_i32 v248, 0x7f, v248
    v_lshrrev_b32 v249, 4, v248
    v_and_b32 v248, 15, v248
    v_min_u32 v250, 6, v1
    v_lshlrev_b32 v251, 2, v250
    v_lshl_add_u32 v251, v248, 7, v251
    v_lshl_add_u32 v251, v249, 21, v251
    v_add_u32 v42, 0xe7800, v251
    v_and_b32 v248, 1, v248
    v_lshlrev_b32 v250, 7, v250
    v_lshl_add_u32 v250, v248, 10, v250
    v_lshl_add_u32 v250, v249, 21, v250
    v_add_u32 v250, 0xfd000, v250
    v_cmp_ne_u32 vcc, s68, v249
    s_nop 1
    v_cndmask_b32 v42, v42, v250, vcc
L_att:
    v_mov_b32 v245, 0xff800000
    v_mov_b32 v246, v245
    v_mov_b32 v248, v245
    v_mov_b32 v250, v245
    v_mov_b32 v252, v245
    s_cmp_ge_u32 s96, 16
    s_cbranch_scc1 Lpf_9
    v_mov_b32 v244, v245
    v_mov_b64 v[104:105], v[244:245]
    v_mov_b64 v[106:107], v[244:245]
    v_mov_b64 v[108:109], v[244:245]
    v_mov_b64 v[110:111], v[244:245]
    v_mov_b64 v[112:113], v[244:245]
    v_mov_b64 v[114:115], v[244:245]
    v_mov_b64 v[116:117], v[244:245]
    v_mov_b64 v[118:119], v[244:245]
    v_mov_b64 v[120:121], v[244:245]
    v_mov_b64 v[122:123], v[244:245]
    v_mov_b64 v[124:125], v[244:245]
    v_mov_b64 v[126:127], v[244:245]
    v_mov_b64 v[128:129], v[244:245]
    v_mov_b64 v[130:131], v[244:245]
    v_mov_b64 v[132:133], v[244:245]
    v_mov_b64 v[134:135], v[244:245]
    v_mov_b64 v[136:137], v[244:245]
    v_mov_b64 v[138:139], v[244:245]
    v_mov_b64 v[140:141], v[244:245]
    v_mov_b64 v[142:143], v[244:245]
    v_mov_b64 v[144:145], v[244:245]
    v_mov_b64 v[146:147], v[244:245]
    v_mov_b64 v[148:149], v[244:245]
    v_mov_b64 v[150:151], v[244:245]
    v_mov_b64 v[152:153], v[244:245]
    v_mov_b64 v[154:155], v[244:245]
    v_mov_b64 v[156:157], v[244:245]
    v_mov_b64 v[158:159], v[244:245]
    v_mov_b64 v[160:161], v[244:245]
    v_mov_b64 v[162:163], v[244:245]
    v_mov_b64 v[164:165], v[244:245]
    v_mov_b64 v[166:167], v[244:245]
    v_mov_b64 v[172:173], v[244:245]
    v_mov_b64 v[174:175], v[244:245]
    v_mov_b64 v[176:177], v[244:245]
    v_mov_b64 v[178:179], v[244:245]
    v_mov_b64 v[180:181], v[244:245]
    v_mov_b64 v[182:183], v[244:245]
    v_mov_b64 v[184:185], v[244:245]
    v_mov_b64 v[186:187], v[244:245]
    v_mov_b64 v[188:189], v[244:245]
    v_mov_b64 v[190:191], v[244:245]
    v_mov_b64 v[192:193], v[244:245]
    v_mov_b64 v[194:195], v[244:245]
    v_mov_b64 v[196:197], v[244:245]
    v_mov_b64 v[198:199], v[244:245]
    v_mov_b64 v[200:201], v[244:245]
    v_mov_b64 v[202:203], v[244:245]
    v_mov_b64 v[204:205], v[244:245]
    v_mov_b64 v[206:207], v[244:245]
    v_mov_b64 v[208:209], v[244:245]
    v_mov_b64 v[210:211], v[244:245]
    v_mov_b64 v[212:213], v[244:245]
    v_mov_b64 v[214:215], v[244:245]
    v_mov_b64 v[216:217], v[244:245]
    v_mov_b64 v[218:219], v[244:245]
    v_mov_b64 v[220:221], v[244:245]
    v_mov_b64 v[222:223], v[244:245]
    v_mov_b64 v[224:225], v[244:245]
    v_mov_b64 v[226:227], v[244:245]
    v_mov_b64 v[228:229], v[244:245]
    v_mov_b64 v[230:231], v[244:245]
Lpf_9:
    s_barrier
    ds_read_b128 v[72:75], v30
    ds_read_b128 v[76:79], v30 offset:1024
    ds_read_b32 v31, v31
    s_cmp_lt_u32 s96, 16
    s_cbranch_scc1 Lx0_10
    ds_read_b128 v[80:83], v32 offset:0
    ds_read_b128 v[84:87], v32 offset:1024
    ds_read_b128 v[88:91], v32 offset:2048
    ds_read_b128 v[92:95], v32 offset:3072
    s_waitcnt lgkmcnt(4)
    v_readfirstlane_b32 s77, v31
    v_and_b32 v72, v28, v72
    v_and_b32 v73, v28, v73
    v_and_b32 v74, v29, v74
    v_and_b32 v75, v29, v75
    v_and_b32 v76, v28, v76
    v_and_b32 v77, v28, v77
    v_and_b32 v78, v29, v78
    v_and_b32 v79, v29, v79
    s_waitcnt lgkmcnt(3)
    v_mfma_f32_16x16x32_bf16 v[104:107], v[80:83], v[72:75], 0
    ds_read_b128 v[80:83], v32 offset:4096
    s_waitcnt lgkmcnt(3)
    v_mfma_f32_16x16x32_bf16 v[108:111], v[84:87], v[72:75], 0
    v_mfma_f32_16x16x32_bf16 v[172:175], v[84:87], v[76:79], 0
    ds_read_b128 v[84:87], v32 offset:5120
Lst_11:
    s_waitcnt lgkmcnt(3)
    v_mfma_f32_16x16x32_bf16 v[112:115], v[88:91], v[72:75], 0
    v_mfma_f32_16x16x32_bf16 v[176:179], v[88:91], v[76:79], 0
    ds_read_b128 v[88:91], v32 offset:6144
    v_cndmask_b32 v104, v245, v104, s[36:37]
    v_cndmask_b32 v105, v245, v105, s[38:39]
    v_cndmask_b32 v106, v245, v106, s[50:51]
    v_cndmask_b32 v107, v245, v107, s[52:53]
    v_max3_f32 v246, v246, v104, v105
    v_max3_f32 v248, v248, v106, v107
    s_waitcnt lgkmcnt(3)
    v_mfma_f32_16x16x32_bf16 v[116:119], v[92:95], v[72:75], 0
    v_mfma_f32_16x16x32_bf16 v[180:183], v[92:95], v[76:79], 0
    ds_read_b128 v[92:95], v32 offset:7168
    v_max3_f32 v246, v246, v108, v109
    v_max3_f32 v248, v248, v110, v111
    v_cndmask_b32 v172, v245, v172, s[36:37]
    v_cndmask_b32 v173, v245, v173, s[38:39]
    v_cndmask_b32 v174, v245, v174, s[50:51]
    v_cndmask_b32 v175, v245, v175, s[52:53]
    v_max3_f32 v250, v250, v172, v173
    v_max3_f32 v252, v252, v174, v175
Lst_12:
    s_waitcnt lgkmcnt(3)
    v_mfma_f32_16x16x32_bf16 v[120:123], v[80:83], v[72:75], 0
    v_mfma_f32_16x16x32_bf16 v[184:187], v[80:83], v[76:79], 0
    ds_read_b128 v[80:83], v32 offset:8192
    v_max3_f32 v246, v246, v112, v113
    v_max3_f32 v248, v248, v114, v115
    v_max3_f32 v250, v250, v176, v177
    v_max3_f32 v252, v252, v178, v179
    s_waitcnt lgkmcnt(3)
    v_mfma_f32_16x16x32_bf16 v[124:127], v[84:87], v[72:75], 0
    v_mfma_f32_16x16x32_bf16 v[188:191], v[84:87], v[76:79], 0
    ds_read_b128 v[84:87], v32 offset:9216
    v_max3_f32 v246, v246, v116, v117
    v_max3_f32 v248, v248, v118, v119
    v_max3_f32 v250, v250, v180, v181
    v_max3_f32 v252, v252, v182, v183
Lst_13:
    s_waitcnt lgkmcnt(3)
    v_mfma_f32_16x16x32_bf16 v[128:131], v[88:91], v[72:75], 0
    v_mfma_f32_16x16x32_bf16 v[192:195], v[88:91], v[76:79], 0
    ds_read_b128 v[88:91], v32 offset:10240
    v_max3_f32 v246, v246, v120, v121
    v_max3_f32 v248, v248, v122, v123
    v_max3_f32 v250, v250, v184, v185
    v_max3_f32 v252, v252, v186, v187
    s_waitcnt lgkmcnt(3)
    v_mfma_f32_16x16x32_bf16 v[132:135], v[92:95], v[72:75], 0
    v_mfma_f32_16x16x32_bf16 v[196:199], v[92:95], v[76:79], 0
    ds_read_b128 v[92:95], v32 offset:11264
    v_max3_f32 v246, v246, v124, v125
    v_max3_f32 v248, v248, v126, v127
    v_max3_f32 v250, v250, v188, v189
    v_max3_f32 v252, v252, v190, v191
Lst_14:
    s_waitcnt lgkmcnt(3)
    v_mfma_f32_16x16x32_bf16 v[136:139], v[80:83], v[72:75], 0
    v_mfma_f32_16x16x32_bf16 v[200:203], v[80:83], v[76:79], 0
    ds_read_b128 v[80:83], v32 offset:12288
    v_max3_f32 v246, v246, v128, v129
    v_max3_f32 v248, v248, v130, v131
    v_max3_f32 v250, v250, v192, v193
    v_max3_f32 v252, v252, v194, v195
    s_waitcnt lgkmcnt(3)
    v_mfma_f32_16x16x32_bf16 v[140:143], v[84:87], v[72:75], 0
    v_mfma_f32_16x16x32_bf16 v[204:207], v[84:87], v[76:79], 0
    ds_read_b128 v[84:87], v32 offset:13312
    v_max3_f32 v246, v246, v132, v133
    v_max3_f32 v248, v248, v134, v135
    v_max3_f32 v250, v250, v196, v197
    v_max3_f32 v252, v252, v198, v199
Lst_15:
    s_waitcnt lgkmcnt(3)
    v_mfma_f32_16x16x32_bf16 v[144:147], v[88:91], v[72:75], 0
    v_mfma_f32_16x16x32_bf16 v[208:211], v[88:91], v[76:79], 0
    ds_read_b128 v[88:91], v32 offset:14336
    v_max3_f32 v246, v246, v136, v137
    v_max3_f32 v248, v248, v138, v139
    v_max3_f32 v250, v250, v200, v201
    v_max3_f32 v252, v252, v202, v203
    s_waitcnt lgkmcnt(3)
    v_mfma_f32_16x16x32_bf16 v[148:151], v[92:95], v[72:75], 0
    v_mfma_f32_16x16x32_bf16 v[212:215], v[92:95], v[76:79], 0
    ds_read_b128 v[92:95], v32 offset:15360
    v_max3_f32 v246, v246, v140, v141
    v_max3_f32 v248, v248, v142, v143
    v_max3_f32 v250, v250, v204, v205
    v_max3_f32 v252, v252, v206, v207
Lst_16:
    s_waitcnt lgkmcnt(3)
    v_mfma_f32_16x16x32_bf16 v[152:155], v[80:83], v[72:75], 0
    v_mfma_f32_16x16x32_bf16 v[216:219], v[80:83], v[76:79], 0
    ds_read_b128 v[80:83], v32 offset:16384
    v_max3_f32 v246, v246, v144, v145
    v_max3_f32 v248, v248, v146, v147
    v_max3_f32 v250, v250, v208, v209
    v_max3_f32 v252, v252, v210, v211
    s_waitcnt lgkmcnt(3)
    v_mfma_f32_16x16x32_bf16 v[156:159], v[84:87], v[72:75], 0
    v_mfma_f32_16x16x32_bf16 v[220:223], v[84:87], v[76:79], 0
    ds_read_b128 v[84:87], v32 offset:17408
    v_max3_f32 v246, v246, v148, v149
    v_max3_f32 v248, v248, v150, v151
    v_max3_f32 v250, v250, v212, v213
    v_max3_f32 v252, v252, v214, v215
Lst_17:
    s_waitcnt lgkmcnt(3)
    v_mfma_f32_16x16x32_bf16 v[160:163], v[88:91], v[72:75], 0
    v_mfma_f32_16x16x32_bf16 v[224:227], v[88:91], v[76:79], 0
    v_max3_f32 v246, v246, v152, v153
    v_max3_f32 v248, v248, v154, v155
    v_max3_f32 v250, v250, v216, v217
    v_max3_f32 v252, v252, v218, v219
    s_waitcnt lgkmcnt(2)
    v_mfma_f32_16x16x32_bf16 v[164:167], v[92:95], v[72:75], 0
    v_mfma_f32_16x16x32_bf16 v[228:231], v[92:95], v[76:79], 0
    v_max3_f32 v246, v246, v156, v157
    v_max3_f32 v248, v248, v158, v159
    v_max3_f32 v250, v250, v220, v221
    v_max3_f32 v252, v252, v222, v223
Lst_18:
    s_waitcnt lgkmcnt(1)
    v_mfma_f32_16x16x32_bf16 v[168:171], v[80:83], v[72:75], 0
    v_mfma_f32_16x16x32_bf16 v[232:235], v[80:83], v[76:79], 0
    v_max3_f32 v246, v246, v160, v161
    v_max3_f32 v248, v248, v162, v163
    v_max3_f32 v250, v250, v224, v225
    v_max3_f32 v252, v252, v226, v227
    s_waitcnt lgkmcnt(0)
    v_mfma_f32_16x16x32_bf16 v[236:239], v[84:87], v[76:79], 0
    v_max3_f32 v246, v246, v164, v165
    v_max3_f32 v248, v248, v166, v167
    v_max3_f32 v250, v250, v228, v229
    v_max3_f32 v252, v252, v230, v231
    v_cndmask_b32 v168, v168, v245, s[36:37]
    v_cndmask_b32 v169, v169, v245, s[38:39]
    v_cndmask_b32 v170, v170, v245, s[50:51]
    v_cndmask_b32 v171, v171, v245, s[52:53]
    v_max3_f32 v246, v246, v168, v169
    v_max3_f32 v248, v248, v170, v171
    v_max3_f32 v250, v250, v232, v233
    v_max3_f32 v252, v252, v234, v235
    v_cndmask_b32 v236, v236, v245, s[36:37]
    v_cndmask_b32 v237, v237, v245, s[38:39]
    v_cndmask_b32 v238, v238, v245, s[50:51]
    v_cndmask_b32 v239, v239, v245, s[52:53]
    v_max3_f32 v250, v250, v236, v237
    v_max3_f32 v252, v252, v238, v239
    v_max_f32 v246, v246, v248
    v_max_f32 v250, v250, v252
    v_mov_b32 v248, v246
    v_mov_b32 v252, v250
    s_nop 0
    v_permlane32_swap_b32 v246, v248
    v_permlane32_swap_b32 v250, v252
    v_max_f32 v246, v246, v248
    v_max_f32 v250, v250, v252
    v_mov_b32 v248, v246
    v_mov_b32 v252, v250
    s_nop 0
    v_permlane16_swap_b32 v246, v248
    v_permlane16_swap_b32 v250, v252
    v_max_f32 v246, v246, v248
    v_max_f32 v250, v250, v252
    v_sub_f32 v246, 0, v246
    v_sub_f32 v250, 0, v250
    v_pk_add_f32 v[104:105], v[104:105], v[246:247] op_sel_hi:[1,0]
    v_pk_add_f32 v[106:107], v[106:107], v[246:247] op_sel_hi:[1,0]
    v_pk_add_f32 v[108:109], v[108:109], v[246:247] op_sel_hi:[1,0]
    v_pk_add_f32 v[110:111], v[110:111], v[246:247] op_sel_hi:[1,0]
    v_pk_add_f32 v[112:113], v[112:113], v[246:247] op_sel_hi:[1,0]
    v_pk_add_f32 v[114:115], v[114:115], v[246:247] op_sel_hi:[1,0]
    v_pk_add_f32 v[116:117], v[116:117], v[246:247] op_sel_hi:[1,0]
    v_pk_add_f32 v[118:119], v[118:119], v[246:247] op_sel_hi:[1,0]
    v_pk_add_f32 v[120:121], v[120:121], v[246:247] op_sel_hi:[1,0]
    v_pk_add_f32 v[122:123], v[122:123], v[246:247] op_sel_hi:[1,0]
    v_pk_add_f32 v[124:125], v[124:125], v[246:247] op_sel_hi:[1,0]
    v_pk_add_f32 v[126:127], v[126:127], v[246:247] op_sel_hi:[1,0]
    v_pk_add_f32 v[128:129], v[128:129], v[246:247] op_sel_hi:[1,0]
    v_pk_add_f32 v[130:131], v[130:131], v[246:247] op_sel_hi:[1,0]
    v_pk_add_f32 v[132:133], v[132:133], v[246:247] op_sel_hi:[1,0]
    v_pk_add_f32 v[134:135], v[134:135], v[246:247] op_sel_hi:[1,0]
    v_pk_add_f32 v[136:137], v[136:137], v[246:247] op_sel_hi:[1,0]
    v_pk_add_f32 v[138:139], v[138:139], v[246:247] op_sel_hi:[1,0]
    v_pk_add_f32 v[140:141], v[140:141], v[246:247] op_sel_hi:[1,0]
    v_pk_add_f32 v[142:143], v[142:143], v[246:247] op_sel_hi:[1,0]
    v_pk_add_f32 v[144:145], v[144:145], v[246:247] op_sel_hi:[1,0]
    v_pk_add_f32 v[146:147], v[146:147], v[246:247] op_sel_hi:[1,0]
    v_pk_add_f32 v[148:149], v[148:149], v[246:247] op_sel_hi:[1,0]
    v_pk_add_f32 v[150:151], v[150:151], v[246:247] op_sel_hi:[1,0]
    v_pk_add_f32 v[152:153], v[152:153], v[246:247] op_sel_hi:[1,0]
    v_pk_add_f32 v[154:155], v[154:155], v[246:247] op_sel_hi:[1,0]
    v_pk_add_f32 v[156:157], v[156:157], v[246:247] op_sel_hi:[1,0]
    v_pk_add_f32 v[158:159], v[158:159], v[246:247] op_sel_hi:[1,0]
    v_pk_add_f32 v[160:161], v[160:161], v[246:247] op_sel_hi:[1,0]
    v_pk_add_f32 v[162:163], v[162:163], v[246:247] op_sel_hi:[1,0]
    v_pk_add_f32 v[164:165], v[164:165], v[246:247] op_sel_hi:[1,0]
    v_pk_add_f32 v[166:167], v[166:167], v[246:247] op_sel_hi:[1,0]
    v_pk_add_f32 v[168:169], v[168:169], v[246:247] op_sel_hi:[1,0]
    v_pk_add_f32 v[170:171], v[170:171], v[246:247] op_sel_hi:[1,0]
    v_pk_add_f32 v[172:173], v[172:173], v[250:251] op_sel_hi:[1,0]
    v_pk_add_f32 v[174:175], v[174:175], v[250:251] op_sel_hi:[1,0]
    v_pk_add_f32 v[176:177], v[176:177], v[250:251] op_sel_hi:[1,0]
    v_pk_add_f32 v[178:179], v[178:179], v[250:251] op_sel_hi:[1,0]
    v_pk_add_f32 v[180:181], v[180:181], v[250:251] op_sel_hi:[1,0]
    v_pk_add_f32 v[182:183], v[182:183], v[250:251] op_sel_hi:[1,0]
    v_pk_add_f32 v[184:185], v[184:185], v[250:251] op_sel_hi:[1,0]
    v_pk_add_f32 v[186:187], v[186:187], v[250:251] op_sel_hi:[1,0]
    v_pk_add_f32 v[188:189], v[188:189], v[250:251] op_sel_hi:[1,0]
    v_pk_add_f32 v[190:191], v[190:191], v[250:251] op_sel_hi:[1,0]
    v_pk_add_f32 v[192:193], v[192:193], v[250:251] op_sel_hi:[1,0]
    v_pk_add_f32 v[194:195], v[194:195], v[250:251] op_sel_hi:[1,0]
    v_pk_add_f32 v[196:197], v[196:197], v[250:251] op_sel_hi:[1,0]
    v_pk_add_f32 v[198:199], v[198:199], v[250:251] op_sel_hi:[1,0]
    v_pk_add_f32 v[200:201], v[200:201], v[250:251] op_sel_hi:[1,0]
    v_pk_add_f32 v[202:203], v[202:203], v[250:251] op_sel_hi:[1,0]
    v_pk_add_f32 v[204:205], v[204:205], v[250:251] op_sel_hi:[1,0]
    v_pk_add_f32 v[206:207], v[206:207], v[250:251] op_sel_hi:[1,0]
    v_pk_add_f32 v[208:209], v[208:209], v[250:251] op_sel_hi:[1,0]
    v_pk_add_f32 v[210:211], v[210:211], v[250:251] op_sel_hi:[1,0]
    v_pk_add_f32 v[212:213], v[212:213], v[250:251] op_sel_hi:[1,0]
    v_pk_add_f32 v[214:215], v[214:215], v[250:251] op_sel_hi:[1,0]
    v_pk_add_f32 v[216:217], v[216:217], v[250:251] op_sel_hi:[1,0]
    v_pk_add_f32 v[218:219], v[218:219], v[250:251] op_sel_hi:[1,0]
    v_pk_add_f32 v[220:221], v[220:221], v[250:251] op_sel_hi:[1,0]
    v_pk_add_f32 v[222:223], v[222:223], v[250:251] op_sel_hi:[1,0]
    v_pk_add_f32 v[224:225], v[224:225], v[250:251] op_sel_hi:[1,0]
    v_pk_add_f32 v[226:227], v[226:227], v[250:251] op_sel_hi:[1,0]
    v_pk_add_f32 v[228:229], v[228:229], v[250:251] op_sel_hi:[1,0]
    v_pk_add_f32 v[230:231], v[230:231], v[250:251] op_sel_hi:[1,0]
    v_pk_add_f32 v[232:233], v[232:233], v[250:251] op_sel_hi:[1,0]
    v_pk_add_f32 v[234:235], v[234:235], v[250:251] op_sel_hi:[1,0]
    v_pk_add_f32 v[236:237], v[236:237], v[250:251] op_sel_hi:[1,0]
    v_pk_add_f32 v[238:239], v[238:239], v[250:251] op_sel_hi:[1,0]
    v_exp_f32 v104, v104
    v_exp_f32 v105, v105
    v_exp_f32 v106, v106
    v_exp_f32 v107, v107
    v_exp_f32 v108, v108
    v_exp_f32 v109, v109
    v_exp_f32 v110, v110
    v_exp_f32 v111, v111
    v_exp_f32 v172, v172
    v_exp_f32 v173, v173
    v_exp_f32 v174, v174
    v_exp_f32 v175, v175
    v_exp_f32 v112, v112
    v_exp_f32 v113, v113
    v_exp_f32 v114, v114
    v_exp_f32 v115, v115
    v_exp_f32 v116, v116
    v_exp_f32 v117, v117
    v_exp_f32 v118, v118
    v_exp_f32 v119, v119
    v_exp_f32 v176, v176
    v_exp_f32 v177, v177
    v_exp_f32 v178, v178
    v_exp_f32 v179, v179
    v_exp_f32 v180, v180
    v_exp_f32 v181, v181
    v_exp_f32 v182, v182
    v_exp_f32 v183, v183
    v_cvt_pk_bf16_f32 v104, v104, v105
    v_cvt_pk_bf16_f32 v105, v106, v107
    v_cvt_pk_bf16_f32 v106, v108, v109
    v_cvt_pk_bf16_f32 v107, v110, v111
    v_cvt_pk_bf16_f32 v172, v172, v173
    v_cvt_pk_bf16_f32 v173, v174, v175
    v_exp_f32 v120, v120
    v_exp_f32 v121, v121
    v_exp_f32 v122, v122
    v_exp_f32 v123, v123
    v_exp_f32 v124, v124
    v_exp_f32 v125, v125
    v_exp_f32 v126, v126
    v_exp_f32 v127, v127
    v_exp_f32 v184, v184
    v_exp_f32 v185, v185
    v_exp_f32 v186, v186
    v_exp_f32 v187, v187
    v_exp_f32 v188, v188
    v_exp_f32 v189, v189
    v_exp_f32 v190, v190
    v_exp_f32 v191, v191
    v_cvt_pk_bf16_f32 v112, v112, v113
    v_cvt_pk_bf16_f32 v113, v114, v115
    v_cvt_pk_bf16_f32 v114, v116, v117
    v_cvt_pk_bf16_f32 v115, v118, v119
    v_cvt_pk_bf16_f32 v176, v176, v177
    v_cvt_pk_bf16_f32 v177, v178, v179
    v_cvt_pk_bf16_f32 v178, v180, v181
    v_cvt_pk_bf16_f32 v179, v182, v183
    s_barrier
    v_exp_f32 v128, v128
    ds_read_b64_tr_b16 v[72:73], v33 offset:0
    v_exp_f32 v129, v129
    ds_read_b64_tr_b16 v[74:75], v33 offset:1024
    v_exp_f32 v130, v130
    ds_read_b64_tr_b16 v[76:77], v34 offset:0
    v_exp_f32 v131, v131
    ds_read_b64_tr_b16 v[78:79], v34 offset:1024
    v_exp_f32 v132, v132
    ds_read_b64_tr_b16 v[80:81], v33 offset:2048
    v_exp_f32 v133, v133
    ds_read_b64_tr_b16 v[82:83], v33 offset:3072
    v_exp_f32 v134, v134
    ds_read_b64_tr_b16 v[84:85], v34 offset:2048
    v_exp_f32 v135, v135
    ds_read_b64_tr_b16 v[86:87], v34 offset:3072
    v_exp_f32 v192, v192
    v_exp_f32 v193, v193
    v_exp_f32 v194, v194
    v_exp_f32 v195, v195
    v_exp_f32 v196, v196
    v_exp_f32 v197, v197
    v_exp_f32 v198, v198
    v_exp_f32 v199, v199
    v_cvt_pk_bf16_f32 v120, v120, v121
    v_cvt_pk_bf16_f32 v121, v122, v123
    v_cvt_pk_bf16_f32 v122, v124, v125
    v_cvt_pk_bf16_f32 v123, v126, v127
    v_cvt_pk_bf16_f32 v184, v184, v185
    v_cvt_pk_bf16_f32 v185, v186, v187
    v_cvt_pk_bf16_f32 v186, v188, v189
    v_cvt_pk_bf16_f32 v187, v190, v191
    v_exp_f32 v136, v136
    ds_read_b64_tr_b16 v[88:89], v33 offset:4096
    v_exp_f32 v137, v137
    ds_read_b64_tr_b16 v[90:91], v33 offset:5120
    v_exp_f32 v138, v138
    ds_read_b64_tr_b16 v[92:93], v34 offset:4096
    v_exp_f32 v139, v139
    ds_read_b64_tr_b16 v[94:95], v34 offset:5120
    v_exp_f32 v140, v140
    s_waitcnt lgkmcnt(8)
    v_exp_f32 v141, v141
    v_mfma_f32_16x16x32_bf16 v[56:59], v[16:19], v[104:107], 0
    v_exp_f32 v142, v142
    v_mfma_f32_16x16x32_bf16 v[48:51], v[72:75], v[104:107], 0
    v_exp_f32 v143, v143
    v_mfma_f32_16x16x32_bf16 v[52:55], v[76:79], v[104:107], 0
    v_exp_f32 v200, v200
    v_mfma_f32_16x16x16_bf16 v[68:71], v[16:17], v[172:173], 0
    v_exp_f32 v201, v201
    v_mfma_f32_16x16x16_bf16 v[60:63], v[74:75], v[172:173], 0
    v_exp_f32 v202, v202
    v_mfma_f32_16x16x16_bf16 v[64:67], v[78:79], v[172:173], 0
    v_exp_f32 v203, v203
    ds_read_b64_tr_b16 v[72:73], v33 offset:6144
    v_exp_f32 v204, v204
    ds_read_b64_tr_b16 v[74:75], v33 offset:7168
    v_exp_f32 v205, v205
    ds_read_b64_tr_b16 v[76:77], v34 offset:6144
    v_exp_f32 v206, v206
    ds_read_b64_tr_b16 v[78:79], v34 offset:7168
    v_exp_f32 v207, v207
    s_waitcnt lgkmcnt(8)
    v_cvt_pk_bf16_f32 v128, v128, v129
    v_mfma_f32_16x16x32_bf16 v[56:59], v[16:19], v[112:115], v[56:59]
    v_cvt_pk_bf16_f32 v129, v130, v131
    v_mfma_f32_16x16x32_bf16 v[48:51], v[80:83], v[112:115], v[48:51]
    v_cvt_pk_bf16_f32 v130, v132, v133
    v_mfma_f32_16x16x32_bf16 v[52:55], v[84:87], v[112:115], v[52:55]
    v_cvt_pk_bf16_f32 v131, v134, v135
    v_mfma_f32_16x16x32_bf16 v[68:71], v[16:19], v[176:179], v[68:71]
    v_cvt_pk_bf16_f32 v192, v192, v193
    v_mfma_f32_16x16x32_bf16 v[60:63], v[80:83], v[176:179], v[60:63]
    v_cvt_pk_bf16_f32 v193, v194, v195
    v_mfma_f32_16x16x32_bf16 v[64:67], v[84:87], v[176:179], v[64:67]
    v_cvt_pk_bf16_f32 v194, v196, v197
    v_cvt_pk_bf16_f32 v195, v198, v199
    v_exp_f32 v144, v144
    ds_read_b64_tr_b16 v[80:81], v33 offset:8192
    v_exp_f32 v145, v145
    ds_read_b64_tr_b16 v[82:83], v33 offset:9216
    v_exp_f32 v146, v146
    ds_read_b64_tr_b16 v[84:85], v34 offset:8192
    v_exp_f32 v147, v147
    ds_read_b64_tr_b16 v[86:87], v34 offset:9216
    v_exp_f32 v148, v148
    s_waitcnt lgkmcnt(8)
    v_exp_f32 v149, v149
    v_mfma_f32_16x16x32_bf16 v[56:59], v[16:19], v[120:123], v[56:59]
    v_exp_f32 v150, v150
    v_mfma_f32_16x16x32_bf16 v[48:51], v[88:91], v[120:123], v[48:51]
    v_exp_f32 v151, v151
    v_mfma_f32_16x16x32_bf16 v[52:55], v[92:95], v[120:123], v[52:55]
    v_exp_f32 v208, v208
    v_mfma_f32_16x16x32_bf16 v[68:71], v[16:19], v[184:187], v[68:71]
    v_exp_f32 v209, v209
    v_mfma_f32_16x16x32_bf16 v[60:63], v[88:91], v[184:187], v[60:63]
    v_exp_f32 v210, v210
    v_mfma_f32_16x16x32_bf16 v[64:67], v[92:95], v[184:187], v[64:67]
    v_exp_f32 v211, v211
    ds_read_b64_tr_b16 v[88:89], v33 offset:10240
    v_exp_f32 v212, v212
    ds_read_b64_tr_b16 v[90:91], v33 offset:11264
    v_exp_f32 v213, v213
    ds_read_b64_tr_b16 v[92:93], v34 offset:10240
    v_exp_f32 v214, v214
    ds_read_b64_tr_b16 v[94:95], v34 offset:11264
    v_exp_f32 v215, v215
    s_waitcnt lgkmcnt(8)
    v_cvt_pk_bf16_f32 v136, v136, v137
    v_mfma_f32_16x16x32_bf16 v[56:59], v[16:19], v[128:131], v[56:59]
    v_cvt_pk_bf16_f32 v137, v138, v139
    v_mfma_f32_16x16x32_bf16 v[48:51], v[72:75], v[128:131], v[48:51]
    v_cvt_pk_bf16_f32 v138, v140, v141
    v_mfma_f32_16x16x32_bf16 v[52:55], v[76:79], v[128:131], v[52:55]
    v_cvt_pk_bf16_f32 v139, v142, v143
    v_mfma_f32_16x16x32_bf16 v[68:71], v[16:19], v[192:195], v[68:71]
    v_cvt_pk_bf16_f32 v200, v200, v201
    v_mfma_f32_16x16x32_bf16 v[60:63], v[72:75], v[192:195], v[60:63]
    v_cvt_pk_bf16_f32 v201, v202, v203
    v_mfma_f32_16x16x32_bf16 v[64:67], v[76:79], v[192:195], v[64:67]
    v_cvt_pk_bf16_f32 v202, v204, v205
    v_cvt_pk_bf16_f32 v203, v206, v207
    v_exp_f32 v152, v152
    ds_read_b64_tr_b16 v[72:73], v33 offset:12288
    v_exp_f32 v153, v153
    ds_read_b64_tr_b16 v[74:75], v33 offset:13312
    v_exp_f32 v154, v154
    ds_read_b64_tr_b16 v[76:77], v34 offset:12288
    v_exp_f32 v155, v155
    ds_read_b64_tr_b16 v[78:79], v34 offset:13312
    v_exp_f32 v156, v156
    s_waitcnt lgkmcnt(8)
    v_exp_f32 v157, v157
    v_mfma_f32_16x16x32_bf16 v[56:59], v[16:19], v[136:139], v[56:59]
    v_exp_f32 v158, v158
    v_mfma_f32_16x16x32_bf16 v[48:51], v[80:83], v[136:139], v[48:51]
    v_exp_f32 v159, v159
    v_mfma_f32_16x16x32_bf16 v[52:55], v[84:87], v[136:139], v[52:55]
    v_exp_f32 v216, v216
    v_mfma_f32_16x16x32_bf16 v[68:71], v[16:19], v[200:203], v[68:71]
    v_exp_f32 v217, v217
    v_mfma_f32_16x16x32_bf16 v[60:63], v[80:83], v[200:203], v[60:63]
    v_exp_f32 v218, v218
    v_mfma_f32_16x16x32_bf16 v[64:67], v[84:87], v[200:203], v[64:67]
    v_exp_f32 v219, v219
    v_exp_f32 v220, v220
    v_exp_f32 v221, v221
    v_exp_f32 v222, v222
    v_exp_f32 v223, v223
    v_cvt_pk_bf16_f32 v144, v144, v145
    v_cvt_pk_bf16_f32 v145, v146, v147
    v_cvt_pk_bf16_f32 v146, v148, v149
    v_cvt_pk_bf16_f32 v147, v150, v151
    v_cvt_pk_bf16_f32 v208, v208, v209
    v_cvt_pk_bf16_f32 v209, v210, v211
    v_cvt_pk_bf16_f32 v210, v212, v213
    v_cvt_pk_bf16_f32 v211, v214, v215
    v_exp_f32 v160, v160
    ds_read_b64_tr_b16 v[80:81], v33 offset:14336
    v_exp_f32 v161, v161
    ds_read_b64_tr_b16 v[82:83], v33 offset:15360
    v_exp_f32 v162, v162
    ds_read_b64_tr_b16 v[84:85], v34 offset:14336
    v_exp_f32 v163, v163
    ds_read_b64_tr_b16 v[86:87], v34 offset:15360
    v_exp_f32 v164, v164
    s_waitcnt lgkmcnt(8)
    v_exp_f32 v165, v165
    v_mfma_f32_16x16x32_bf16 v[56:59], v[16:19], v[144:147], v[56:59]
    v_exp_f32 v166, v166
    v_mfma_f32_16x16x32_bf16 v[48:51], v[88:91], v[144:147], v[48:51]
    v_exp_f32 v167, v167
    v_mfma_f32_16x16x32_bf16 v[52:55], v[92:95], v[144:147], v[52:55]
    v_exp_f32 v224, v224
    v_mfma_f32_16x16x32_bf16 v[68:71], v[16:19], v[208:211], v[68:71]
    v_exp_f32 v225, v225
    v_mfma_f32_16x16x32_bf16 v[60:63], v[88:91], v[208:211], v[60:63]
    v_exp_f32 v226, v226
    v_mfma_f32_16x16x32_bf16 v[64:67], v[92:95], v[208:211], v[64:67]
    v_exp_f32 v227, v227
    v_exp_f32 v228, v228
    v_exp_f32 v229, v229
    v_exp_f32 v230, v230
    v_exp_f32 v231, v231
    v_cvt_pk_bf16_f32 v152, v152, v153
    v_cvt_pk_bf16_f32 v153, v154, v155
    v_cvt_pk_bf16_f32 v154, v156, v157
    v_cvt_pk_bf16_f32 v155, v158, v159
    v_cvt_pk_bf16_f32 v216, v216, v217
    v_cvt_pk_bf16_f32 v217, v218, v219
    v_cvt_pk_bf16_f32 v218, v220, v221
    v_cvt_pk_bf16_f32 v219, v222, v223
    v_exp_f32 v168, v168
    ds_read_b64_tr_b16 v[88:89], v33 offset:16384
    v_exp_f32 v169, v169
    ds_read_b64_tr_b16 v[90:91], v33 offset:17408
    v_exp_f32 v170, v170
    ds_read_b64_tr_b16 v[92:93], v34 offset:16384
    v_exp_f32 v171, v171
    ds_read_b64_tr_b16 v[94:95], v34 offset:17408
    v_exp_f32 v232, v232
    s_waitcnt lgkmcnt(8)
    v_exp_f32 v233, v233
    v_mfma_f32_16x16x32_bf16 v[56:59], v[16:19], v[152:155], v[56:59]
    v_exp_f32 v234, v234
    v_mfma_f32_16x16x32_bf16 v[48:51], v[72:75], v[152:155], v[48:51]
    v_exp_f32 v235, v235
    v_mfma_f32_16x16x32_bf16 v[52:55], v[76:79], v[152:155], v[52:55]
    v_exp_f32 v236, v236
    v_mfma_f32_16x16x32_bf16 v[68:71], v[16:19], v[216:219], v[68:71]
    v_exp_f32 v237, v237
    v_mfma_f32_16x16x32_bf16 v[60:63], v[72:75], v[216:219], v[60:63]
    v_exp_f32 v238, v238
    v_mfma_f32_16x16x32_bf16 v[64:67], v[76:79], v[216:219], v[64:67]
    v_exp_f32 v239, v239
    v_cvt_pk_bf16_f32 v160, v160, v161
    v_cvt_pk_bf16_f32 v161, v162, v163
    v_cvt_pk_bf16_f32 v162, v164, v165
    v_cvt_pk_bf16_f32 v163, v166, v167
    v_cvt_pk_bf16_f32 v224, v224, v225
    v_cvt_pk_bf16_f32 v225, v226, v227
    v_cvt_pk_bf16_f32 v226, v228, v229
    v_cvt_pk_bf16_f32 v227, v230, v231
    v_cvt_pk_bf16_f32 v168, v168, v169
    v_cvt_pk_bf16_f32 v169, v170, v171
    v_cvt_pk_bf16_f32 v232, v232, v233
    v_cvt_pk_bf16_f32 v233, v234, v235
    v_cvt_pk_bf16_f32 v234, v236, v237
    v_cvt_pk_bf16_f32 v235, v238, v239
    s_waitcnt lgkmcnt(4)
    v_mfma_f32_16x16x32_bf16 v[56:59], v[16:19], v[160:163], v[56:59]
    v_mfma_f32_16x16x32_bf16 v[48:51], v[80:83], v[160:163], v[48:51]
    v_mfma_f32_16x16x32_bf16 v[52:55], v[84:87], v[160:163], v[52:55]
    v_mfma_f32_16x16x32_bf16 v[68:71], v[16:19], v[224:227], v[68:71]
    v_mfma_f32_16x16x32_bf16 v[60:63], v[80:83], v[224:227], v[60:63]
    v_mfma_f32_16x16x32_bf16 v[64:67], v[84:87], v[224:227], v[64:67]
    s_waitcnt lgkmcnt(0)
    v_mfma_f32_16x16x16_bf16 v[56:59], v[16:17], v[168:169], v[56:59]
    v_mfma_f32_16x16x16_bf16 v[48:51], v[88:89], v[168:169], v[48:51]
    v_mfma_f32_16x16x16_bf16 v[52:55], v[92:93], v[168:169], v[52:55]
    v_mfma_f32_16x16x32_bf16 v[68:71], v[16:19], v[232:235], v[68:71]
    v_mfma_f32_16x16x32_bf16 v[60:63], v[88:91], v[232:235], v[60:63]
    v_mfma_f32_16x16x32_bf16 v[64:67], v[92:95], v[232:235], v[64:67]
    s_nop 2
    v_rcp_f32 v252, v56
    s_nop 1
    v_rcp_f32 v253, v68
    v_mul_f32 v48, v48, v252
    v_mul_f32 v49, v49, v252
    v_mul_f32 v50, v50, v252
    v_mul_f32 v51, v51, v252
    v_mul_f32 v52, v52, v252
    v_mul_f32 v53, v53, v252
    v_mul_f32 v54, v54, v252
    v_mul_f32 v55, v55, v252
    v_mul_f32 v60, v60, v253
    v_mul_f32 v61, v61, v253
    v_mul_f32 v62, v62, v253
    v_mul_f32 v63, v63, v253
    v_mul_f32 v64, v64, v253
    v_mul_f32 v65, v65, v253
    v_mul_f32 v66, v66, v253
    v_mul_f32 v67, v67, v253
    v_cvt_pk_bf16_f32 v240, v48, v49
    v_cvt_pk_bf16_f32 v241, v50, v51
    v_cvt_pk_bf16_f32 v242, v52, v53
    v_cvt_pk_bf16_f32 v243, v54, v55
    v_cvt_pk_bf16_f32 v244, v60, v61
    v_cvt_pk_bf16_f32 v245, v62, v63
    v_cvt_pk_bf16_f32 v246, v64, v65
    v_cvt_pk_bf16_f32 v247, v66, v67
    s_mov_b64 exec, s[82:83]
    v_swap_b32 v240, v242
    v_swap_b32 v241, v243
    v_swap_b32 v244, v246
    v_swap_b32 v245, v247
    s_mov_b64 exec, -1
    v_cndmask_b32 v248, v240, v242, s[48:49]
    v_cndmask_b32 v249, v241, v243, s[48:49]
    v_cndmask_b32 v250, v244, v246, s[48:49]
    v_cndmask_b32 v251, v245, v247, s[48:49]
    s_cmp_eq_u32 s77, 1
    s_cbranch_scc0 Lsl_19
    s_mov_b64 exec, s[40:41]
    buffer_store_dwordx4 v[240:243], v3, s[60:63], s44 offen
    buffer_store_dwordx4 v[244:247], v3, s[60:63], s45 offen
    s_mov_b64 exec, s[42:43]
    buffer_store_dwordx2 v[248:249], v3, s[60:63], s46 offen
    buffer_store_dwordx2 v[250:251], v3, s[60:63], s47 offen
    s_mov_b64 exec, -1
    s_branch Lse_20
Lsl_19:
    s_mov_b64 exec, s[40:41]
    buffer_store_dwordx4 v[240:243], v3, s[60:63], s44 offen sc1
    buffer_store_dwordx4 v[244:247], v3, s[60:63], s45 offen sc1
    s_mov_b64 exec, s[42:43]
    buffer_store_dwordx2 v[248:249], v3, s[60:63], s46 offen sc1
    buffer_store_dwordx2 v[250:251], v3, s[60:63], s47 offen sc1
    s_mov_b64 exec, -1
Lse_20:
    s_cmp_ge_u32 s69, 28
    s_cbranch_scc1 L_spare2a
    v_mov_b32 v35, 0x27510
    v_mov_b32 v43, 1
    ds_read_b32 v255, v35 offset:52
    s_mov_b32 s84, 0x15000
    v_add_u32 v11, s84, v7
    v_add_u32 v12, s84, v8
    v_add_u32 v13, s84, v9
    v_add_u32 v14, s84, v10
    v_lshlrev_b32 v48, 16, v20
    v_and_b32 v49, 0xffff0000, v20
    v_lshlrev_b32 v50, 16, v21
    v_and_b32 v51, 0xffff0000, v21
    v_lshlrev_b32 v52, 16, v22
    v_and_b32 v53, 0xffff0000, v22
    v_lshlrev_b32 v54, 16, v23
    v_and_b32 v55, 0xffff0000, v23
    v_lshlrev_b32 v56, 16, v24
    v_and_b32 v57, 0xffff0000, v24
    v_lshlrev_b32 v58, 16, v25
    v_and_b32 v59, 0xffff0000, v25
    v_lshlrev_b32 v60, 16, v26
    v_and_b32 v61, 0xffff0000, v26
    v_lshlrev_b32 v62, 16, v27
    v_and_b32 v63, 0xffff0000, v27
    s_waitcnt lgkmcnt(0)
    v_cmp_gt_u32 vcc, 4, v255
    s_cbranch_vccz Lvk_21
    s_mov_b32 s97, 0x61a80
Lvl_22:
    ds_read_b32 v255, v35 offset:52
    s_sub_u32 s97, s97, 1
    s_waitcnt lgkmcnt(0)
    v_cmp_gt_u32 vcc, 4, v255
    s_cbranch_vccz Lvk_21
    s_cmp_lg_u32 s97, 0
    s_cbranch_scc1 Lvl_22
Lvk_21:
    ds_read_b64_tr_b16 v[128:129], v11 offset:0
    ds_read_b64_tr_b16 v[130:131], v11 offset:1024
    ds_read_b64_tr_b16 v[132:133], v12 offset:0
    ds_read_b64_tr_b16 v[134:135], v12 offset:1024
    ds_read_b64_tr_b16 v[136:137], v13 offset:0
    ds_read_b64_tr_b16 v[138:139], v13 offset:1024
    ds_read_b64_tr_b16 v[140:141], v14 offset:0
    ds_read_b64_tr_b16 v[142:143], v14 offset:1024
    v_min_u32 v34, 15, v0
    s_mul_i32 s84, s76, 0x80
    s_add_u32 s84, s84, s74
    s_add_u32 s84, s84, 0xe7000
    v_lshl_add_u32 v34, v34, 2, s84
    s_add_u32 s101, s54, 0x0
    s_add_u32 s50, s101, 0x0
    s_add_u32 s51, s101, 0x1000
    s_add_u32 s52, s101, 0x2000
    s_add_u32 s53, s101, 0x3000
    s_waitcnt vmcnt(0)
    s_cmp_eq_u32 s77, 1
    s_cbranch_scc0 Lsl_23
    s_mov_b64 exec, 1
    buffer_store_dword v15, off, s[60:63], s59
    buffer_store_dword v15, off, s[60:63], s59 offset:128
    s_mov_b64 exec, -1
    s_branch Lse_24
Lsl_23:
    s_mov_b64 exec, 1
    buffer_store_dword v15, off, s[60:63], s59 sc1
    buffer_store_dword v15, off, s[60:63], s59 offset:128 sc1
    s_mov_b64 exec, -1
Lse_24:
    ds_read_b64_tr_b16 v[144:145], v11 offset:4096
    ds_read_b64_tr_b16 v[146:147], v11 offset:5120
    ds_read_b64_tr_b16 v[148:149], v12 offset:4096
    ds_read_b64_tr_b16 v[150:151], v12 offset:5120
    ds_read_b64_tr_b16 v[152:153], v13 offset:4096
    ds_read_b64_tr_b16 v[154:155], v13 offset:5120
    ds_read_b64_tr_b16 v[156:157], v14 offset:4096
    ds_read_b64_tr_b16 v[158:159], v14 offset:5120
    ds_read_b64_tr_b16 v[160:161], v11 offset:8192
    ds_read_b64_tr_b16 v[162:163], v11 offset:9216
    ds_read_b64_tr_b16 v[164:165], v12 offset:8192
    ds_read_b64_tr_b16 v[166:167], v12 offset:9216
    ds_read_b64_tr_b16 v[168:169], v13 offset:8192
    ds_read_b64_tr_b16 v[170:171], v13 offset:9216
    ds_read_b64_tr_b16 v[172:173], v14 offset:8192
    ds_read_b64_tr_b16 v[174:175], v14 offset:9216
    ds_read_b64_tr_b16 v[176:177], v11 offset:12288
    ds_read_b64_tr_b16 v[178:179], v11 offset:13312
    ds_read_b64_tr_b16 v[180:181], v12 offset:12288
    ds_read_b64_tr_b16 v[182:183], v12 offset:13312
    ds_read_b64_tr_b16 v[184:185], v13 offset:12288
    ds_read_b64_tr_b16 v[186:187], v13 offset:13312
    ds_read_b64_tr_b16 v[188:189], v14 offset:12288
    ds_read_b64_tr_b16 v[190:191], v14 offset:13312
    ds_read_b64_tr_b16 v[192:193], v11 offset:16384
    ds_read_b64_tr_b16 v[194:195], v11 offset:17408
    ds_read_b64_tr_b16 v[196:197], v12 offset:16384
    ds_read_b64_tr_b16 v[198:199], v12 offset:17408
    ds_read_b64_tr_b16 v[200:201], v13 offset:16384
    ds_read_b64_tr_b16 v[202:203], v13 offset:17408
    ds_read_b64_tr_b16 v[204:205], v14 offset:16384
    ds_read_b64_tr_b16 v[206:207], v14 offset:17408
    buffer_load_dword v253, v34, s[60:63], 0 offen sc1
    ds_read_b64_tr_b16 v[208:209], v11 offset:20480
    ds_read_b64_tr_b16 v[210:211], v11 offset:21504
    ds_read_b64_tr_b16 v[212:213], v12 offset:20480
    ds_read_b64_tr_b16 v[214:215], v12 offset:21504
    ds_read_b64_tr_b16 v[216:217], v13 offset:20480
    ds_read_b64_tr_b16 v[218:219], v13 offset:21504
    ds_read_b64_tr_b16 v[220:221], v14 offset:20480
    ds_read_b64_tr_b16 v[222:223], v14 offset:21504
    ds_read_b64_tr_b16 v[224:225], v11 offset:24576
    ds_read_b64_tr_b16 v[226:227], v11 offset:25600
    ds_read_b64_tr_b16 v[228:229], v12 offset:24576
    ds_read_b64_tr_b16 v[230:231], v12 offset:25600
    ds_read_b64_tr_b16 v[232:233], v13 offset:24576
    ds_read_b64_tr_b16 v[234:235], v13 offset:25600
    ds_read_b64_tr_b16 v[236:237], v14 offset:24576
    ds_read_b64_tr_b16 v[238:239], v14 offset:25600
    s_mov_b64 exec, 1
    ds_add_u32 v35, v43 offset:20
    s_mov_b64 exec, -1
    s_add_u32 s86, s55, 0x38000
    s_mov_b32 s87, s56
    s_mov_b32 s97, 0x9c40
Lpoll_25:
    s_waitcnt vmcnt(0)
    v_cmp_ne_u32 vcc, s75, v253
    s_cbranch_vccz Lpd_26
    s_sub_u32 s97, s97, 1
    s_cmp_eq_u32 s97, 0
    s_cbranch_scc1 Lpd_26
    buffer_load_dword v253, v34, s[60:63], 0 offen sc1
    s_branch Lpoll_25
Lpd_26:
    s_waitcnt lgkmcnt(0)
    buffer_load_dwordx4 v[64:67], v3, s[60:63], s50 offen sc1
    buffer_load_dwordx4 v[68:71], v3, s[60:63], s50 offen offset:1024 sc1
    buffer_load_dwordx4 v[72:75], v3, s[60:63], s50 offen offset:2048 sc1
    buffer_load_dwordx4 v[76:79], v3, s[60:63], s50 offen offset:3072 sc1
    buffer_load_dwordx4 v[80:83], v3, s[60:63], s51 offen sc1
    buffer_load_dwordx4 v[84:87], v3, s[60:63], s51 offen offset:1024 sc1
    buffer_load_dwordx4 v[88:91], v3, s[60:63], s51 offen offset:2048 sc1
    buffer_load_dwordx4 v[92:95], v3, s[60:63], s51 offen offset:3072 sc1
    s_waitcnt vmcnt(7)
    v_mfma_f32_16x16x32_bf16 v[48:51], v[128:131], v[64:67], v[48:51]
    buffer_load_dwordx4 v[96:99], v3, s[60:63], s52 offen sc1
    ds_read_b64_tr_b16 v[128:129], v11 offset:28672
    ds_read_b64_tr_b16 v[130:131], v11 offset:29696
    v_mfma_f32_16x16x32_bf16 v[52:55], v[132:135], v[64:67], v[52:55]
    ds_read_b64_tr_b16 v[132:133], v12 offset:28672
    ds_read_b64_tr_b16 v[134:135], v12 offset:29696
    v_mfma_f32_16x16x32_bf16 v[56:59], v[136:139], v[64:67], v[56:59]
    ds_read_b64_tr_b16 v[136:137], v13 offset:28672
    ds_read_b64_tr_b16 v[138:139], v13 offset:29696
    v_mfma_f32_16x16x32_bf16 v[60:63], v[140:143], v[64:67], v[60:63]
    ds_read_b64_tr_b16 v[140:141], v14 offset:28672
    ds_read_b64_tr_b16 v[142:143], v14 offset:29696
    s_waitcnt vmcnt(7)
    v_mfma_f32_16x16x32_bf16 v[48:51], v[144:147], v[68:71], v[48:51]
    buffer_load_dwordx4 v[100:103], v3, s[60:63], s52 offen offset:1024 sc1
    ds_read_b64_tr_b16 v[144:145], v11 offset:32768
    ds_read_b64_tr_b16 v[146:147], v11 offset:33792
    v_mfma_f32_16x16x32_bf16 v[52:55], v[148:151], v[68:71], v[52:55]
    ds_read_b64_tr_b16 v[148:149], v12 offset:32768
    ds_read_b64_tr_b16 v[150:151], v12 offset:33792
    v_mfma_f32_16x16x32_bf16 v[56:59], v[152:155], v[68:71], v[56:59]
    ds_read_b64_tr_b16 v[152:153], v13 offset:32768
    ds_read_b64_tr_b16 v[154:155], v13 offset:33792
    v_mfma_f32_16x16x32_bf16 v[60:63], v[156:159], v[68:71], v[60:63]
    ds_read_b64_tr_b16 v[156:157], v14 offset:32768
    ds_read_b64_tr_b16 v[158:159], v14 offset:33792
    s_waitcnt vmcnt(7)
    v_mfma_f32_16x16x32_bf16 v[48:51], v[160:163], v[72:75], v[48:51]
    buffer_load_dwordx4 v[104:107], v3, s[60:63], s52 offen offset:2048 sc1
    ds_read_b64_tr_b16 v[160:161], v11 offset:36864
    ds_read_b64_tr_b16 v[162:163], v11 offset:37888
    v_mfma_f32_16x16x32_bf16 v[52:55], v[164:167], v[72:75], v[52:55]
    ds_read_b64_tr_b16 v[164:165], v12 offset:36864
    ds_read_b64_tr_b16 v[166:167], v12 offset:37888
    v_mfma_f32_16x16x32_bf16 v[56:59], v[168:171], v[72:75], v[56:59]
    ds_read_b64_tr_b16 v[168:169], v13 offset:36864
    ds_read_b64_tr_b16 v[170:171], v13 offset:37888
    v_mfma_f32_16x16x32_bf16 v[60:63], v[172:175], v[72:75], v[60:63]
    ds_read_b64_tr_b16 v[172:173], v14 offset:36864
    ds_read_b64_tr_b16 v[174:175], v14 offset:37888
    s_waitcnt vmcnt(7)
    v_mfma_f32_16x16x32_bf16 v[48:51], v[176:179], v[76:79], v[48:51]
    buffer_load_dwordx4 v[108:111], v3, s[60:63], s52 offen offset:3072 sc1
    ds_read_b64_tr_b16 v[176:177], v11 offset:40960
    ds_read_b64_tr_b16 v[178:179], v11 offset:41984
    v_mfma_f32_16x16x32_bf16 v[52:55], v[180:183], v[76:79], v[52:55]
    ds_read_b64_tr_b16 v[180:181], v12 offset:40960
    ds_read_b64_tr_b16 v[182:183], v12 offset:41984
    v_mfma_f32_16x16x32_bf16 v[56:59], v[184:187], v[76:79], v[56:59]
    ds_read_b64_tr_b16 v[184:185], v13 offset:40960
    ds_read_b64_tr_b16 v[186:187], v13 offset:41984
    v_mfma_f32_16x16x32_bf16 v[60:63], v[188:191], v[76:79], v[60:63]
    ds_read_b64_tr_b16 v[188:189], v14 offset:40960
    ds_read_b64_tr_b16 v[190:191], v14 offset:41984
    s_waitcnt vmcnt(7)
    v_mfma_f32_16x16x32_bf16 v[48:51], v[192:195], v[80:83], v[48:51]
    buffer_load_dwordx4 v[112:115], v3, s[60:63], s53 offen sc1
    ds_read_b64_tr_b16 v[192:193], v11 offset:45056
    ds_read_b64_tr_b16 v[194:195], v11 offset:46080
    v_mfma_f32_16x16x32_bf16 v[52:55], v[196:199], v[80:83], v[52:55]
    ds_read_b64_tr_b16 v[196:197], v12 offset:45056
    ds_read_b64_tr_b16 v[198:199], v12 offset:46080
    v_mfma_f32_16x16x32_bf16 v[56:59], v[200:203], v[80:83], v[56:59]
    ds_read_b64_tr_b16 v[200:201], v13 offset:45056
    ds_read_b64_tr_b16 v[202:203], v13 offset:46080
    v_mfma_f32_16x16x32_bf16 v[60:63], v[204:207], v[80:83], v[60:63]
    ds_read_b64_tr_b16 v[204:205], v14 offset:45056
    ds_read_b64_tr_b16 v[206:207], v14 offset:46080
    s_waitcnt vmcnt(7)
    v_mfma_f32_16x16x32_bf16 v[48:51], v[208:211], v[84:87], v[48:51]
    buffer_load_dwordx4 v[116:119], v3, s[60:63], s53 offen offset:1024 sc1
    ds_read_b64_tr_b16 v[208:209], v11 offset:49152
    ds_read_b64_tr_b16 v[210:211], v11 offset:50176
    v_mfma_f32_16x16x32_bf16 v[52:55], v[212:215], v[84:87], v[52:55]
    ds_read_b64_tr_b16 v[212:213], v12 offset:49152
    ds_read_b64_tr_b16 v[214:215], v12 offset:50176
    v_mfma_f32_16x16x32_bf16 v[56:59], v[216:219], v[84:87], v[56:59]
    ds_read_b64_tr_b16 v[216:217], v13 offset:49152
    ds_read_b64_tr_b16 v[218:219], v13 offset:50176
    v_mfma_f32_16x16x32_bf16 v[60:63], v[220:223], v[84:87], v[60:63]
    ds_read_b64_tr_b16 v[220:221], v14 offset:49152
    ds_read_b64_tr_b16 v[222:223], v14 offset:50176
    s_waitcnt vmcnt(7)
    v_mfma_f32_16x16x32_bf16 v[48:51], v[224:227], v[88:91], v[48:51]
    ds_read_b64_tr_b16 v[224:225], v11 offset:53248
    ds_read_b64_tr_b16 v[226:227], v11 offset:54272
    v_mfma_f32_16x16x32_bf16 v[52:55], v[228:231], v[88:91], v[52:55]
    ds_read_b64_tr_b16 v[228:229], v12 offset:53248
    ds_read_b64_tr_b16 v[230:231], v12 offset:54272
    v_mfma_f32_16x16x32_bf16 v[56:59], v[232:235], v[88:91], v[56:59]
    ds_read_b64_tr_b16 v[232:233], v13 offset:53248
    ds_read_b64_tr_b16 v[234:235], v13 offset:54272
    v_mfma_f32_16x16x32_bf16 v[60:63], v[236:239], v[88:91], v[60:63]
    ds_read_b64_tr_b16 v[236:237], v14 offset:53248
    ds_read_b64_tr_b16 v[238:239], v14 offset:54272
    s_waitcnt vmcnt(6) lgkmcnt(15)
    v_mfma_f32_16x16x32_bf16 v[48:51], v[128:131], v[92:95], v[48:51]
    v_mfma_f32_16x16x32_bf16 v[52:55], v[132:135], v[92:95], v[52:55]
    v_mfma_f32_16x16x32_bf16 v[56:59], v[136:139], v[92:95], v[56:59]
    v_mfma_f32_16x16x32_bf16 v[60:63], v[140:143], v[92:95], v[60:63]
    s_mov_b64 exec, 1
    ds_add_u32 v35, v43 offset:24
    s_mov_b64 exec, -1
    s_waitcnt vmcnt(5)
    v_mfma_f32_16x16x32_bf16 v[48:51], v[144:147], v[96:99], v[48:51]
    v_mfma_f32_16x16x32_bf16 v[52:55], v[148:151], v[96:99], v[52:55]
    v_mfma_f32_16x16x32_bf16 v[56:59], v[152:155], v[96:99], v[56:59]
    v_mfma_f32_16x16x32_bf16 v[60:63], v[156:159], v[96:99], v[60:63]
    s_waitcnt vmcnt(4)
    v_mfma_f32_16x16x32_bf16 v[48:51], v[160:163], v[100:103], v[48:51]
    v_mfma_f32_16x16x32_bf16 v[52:55], v[164:167], v[100:103], v[52:55]
    v_mfma_f32_16x16x32_bf16 v[56:59], v[168:171], v[100:103], v[56:59]
    v_mfma_f32_16x16x32_bf16 v[60:63], v[172:175], v[100:103], v[60:63]
    s_waitcnt vmcnt(3)
    v_mfma_f32_16x16x32_bf16 v[48:51], v[176:179], v[104:107], v[48:51]
    v_mfma_f32_16x16x32_bf16 v[52:55], v[180:183], v[104:107], v[52:55]
    v_mfma_f32_16x16x32_bf16 v[56:59], v[184:187], v[104:107], v[56:59]
    v_mfma_f32_16x16x32_bf16 v[60:63], v[188:191], v[104:107], v[60:63]
    s_waitcnt vmcnt(2)
    v_mfma_f32_16x16x32_bf16 v[48:51], v[192:195], v[108:111], v[48:51]
    v_mfma_f32_16x16x32_bf16 v[52:55], v[196:199], v[108:111], v[52:55]
    v_mfma_f32_16x16x32_bf16 v[56:59], v[200:203], v[108:111], v[56:59]
    v_mfma_f32_16x16x32_bf16 v[60:63], v[204:207], v[108:111], v[60:63]
    s_waitcnt vmcnt(1) lgkmcnt(9)
    v_mfma_f32_16x16x32_bf16 v[48:51], v[208:211], v[112:115], v[48:51]
    v_mfma_f32_16x16x32_bf16 v[52:55], v[212:215], v[112:115], v[52:55]
    v_mfma_f32_16x16x32_bf16 v[56:59], v[216:219], v[112:115], v[56:59]
    v_mfma_f32_16x16x32_bf16 v[60:63], v[220:223], v[112:115], v[60:63]
    s_waitcnt vmcnt(0) lgkmcnt(1)
    v_mfma_f32_16x16x32_bf16 v[48:51], v[224:227], v[116:119], v[48:51]
    v_mfma_f32_16x16x32_bf16 v[52:55], v[228:231], v[116:119], v[52:55]
    v_mfma_f32_16x16x32_bf16 v[56:59], v[232:235], v[116:119], v[56:59]
    v_mfma_f32_16x16x32_bf16 v[60:63], v[236:239], v[116:119], v[60:63]
    s_nop 4
    v_cvt_pk_bf16_f32 v20, v48, v49
    v_cvt_pk_bf16_f32 v21, v50, v51
    v_cvt_pk_bf16_f32 v22, v52, v53
    v_cvt_pk_bf16_f32 v23, v54, v55
    v_cvt_pk_bf16_f32 v24, v56, v57
    v_cvt_pk_bf16_f32 v25, v58, v59
    v_cvt_pk_bf16_f32 v26, v60, v61
    v_cvt_pk_bf16_f32 v27, v62, v63
    s_mov_b64 exec, s[82:83]
    v_swap_b32 v20, v22
    v_swap_b32 v21, v23
    v_swap_b32 v24, v26
    v_swap_b32 v25, v27
    s_mov_b64 exec, -1
    s_cmp_eq_u32 s77, 1
    s_cbranch_scc0 Lsl_27
    buffer_store_dwordx4 v[20:23], v3, s[60:63], s86 offen
    buffer_store_dwordx4 v[24:27], v3, s[60:63], s86 offen offset:1024
    s_branch Lse_28
Lsl_27:
    buffer_store_dwordx4 v[20:23], v3, s[60:63], s86 offen sc1
    buffer_store_dwordx4 v[24:27], v3, s[60:63], s86 offen offset:1024 sc1
Lse_28:
    ds_read_b32 v255, v35 offset:60
    v_mov_b32 v248, 0
    v_mov_b32 v250, 0
    v_dot2c_f32_bf16 v248, v20, v16
    v_dot2c_f32_bf16 v250, v20, v20
    v_dot2c_f32_bf16 v248, v21, v16
    v_dot2c_f32_bf16 v250, v21, v21
    v_dot2c_f32_bf16 v248, v22, v16
    v_dot2c_f32_bf16 v250, v22, v22
    v_dot2c_f32_bf16 v248, v23, v16
    v_dot2c_f32_bf16 v250, v23, v23
    v_dot2c_f32_bf16 v248, v24, v16
    v_dot2c_f32_bf16 v250, v24, v24
    v_dot2c_f32_bf16 v248, v25, v16
    v_dot2c_f32_bf16 v250, v25, v25
    v_dot2c_f32_bf16 v248, v26, v16
    v_dot2c_f32_bf16 v250, v26, v26
    v_dot2c_f32_bf16 v248, v27, v16
    v_dot2c_f32_bf16 v250, v27, v27
    v_mov_b32 v249, v15
    v_mov_b32 v251, v15
    s_nop 0
    v_permlane32_swap_b32 v248, v250
    v_add_f32 v248, v248, v250
    v_mov_b32 v250, v248
    s_nop 1
    v_permlane16_swap_b32 v248, v250
    v_add_f32 v248, v248, v250
    v_mov_b32 v250, v248
    s_nop 1
    v_permlane32_swap_b32 v248, v250
    s_mov_b32 s84, 0x0
    v_add_u32 v11, s84, v7
    v_add_u32 v12, s84, v8
    v_add_u32 v13, s84, v9
    v_add_u32 v14, s84, v10
    s_waitcnt lgkmcnt(0)
    v_cmp_gt_u32 vcc, 4, v255
    s_cbranch_vccz Lvk_29
    s_mov_b32 s97, 0x61a80
Lvl_30:
    ds_read_b32 v255, v35 offset:60
    s_sub_u32 s97, s97, 1
    s_waitcnt lgkmcnt(0)
    v_cmp_gt_u32 vcc, 4, v255
    s_cbranch_vccz Lvk_29
    s_cmp_lg_u32 s97, 0
    s_cbranch_scc1 Lvl_30
Lvk_29:
    ds_read_b64_tr_b16 v[128:129], v11 offset:0
    ds_read_b64_tr_b16 v[130:131], v11 offset:1024
    ds_read_b64_tr_b16 v[132:133], v12 offset:0
    ds_read_b64_tr_b16 v[134:135], v12 offset:1024
    ds_read_b64_tr_b16 v[136:137], v13 offset:0
    ds_read_b64_tr_b16 v[138:139], v13 offset:1024
    ds_read_b64_tr_b16 v[140:141], v14 offset:0
    ds_read_b64_tr_b16 v[142:143], v14 offset:1024
    s_waitcnt vmcnt(0)
    s_cmp_eq_u32 s77, 1
    s_cbranch_scc0 Lsl_31
    s_mov_b64 exec, 0xffff
    buffer_store_dwordx4 v[248:251], v3, s[60:63], s87 offen
    s_mov_b64 exec, -1
    s_branch Lse_32
Lsl_31:
    s_mov_b64 exec, 0xffff
    buffer_store_dwordx4 v[248:251], v3, s[60:63], s87 offen sc1
    s_mov_b64 exec, -1
Lse_32:
    ds_read_b64_tr_b16 v[144:145], v11 offset:4096
    ds_read_b64_tr_b16 v[146:147], v11 offset:5120
    ds_read_b64_tr_b16 v[148:149], v12 offset:4096
    ds_read_b64_tr_b16 v[150:151], v12 offset:5120
    ds_read_b64_tr_b16 v[152:153], v13 offset:4096
    ds_read_b64_tr_b16 v[154:155], v13 offset:5120
    ds_read_b64_tr_b16 v[156:157], v14 offset:4096
    ds_read_b64_tr_b16 v[158:159], v14 offset:5120
    ds_read_b64_tr_b16 v[160:161], v11 offset:8192
    ds_read_b64_tr_b16 v[162:163], v11 offset:9216
    ds_read_b64_tr_b16 v[164:165], v12 offset:8192
    ds_read_b64_tr_b16 v[166:167], v12 offset:9216
    ds_read_b64_tr_b16 v[168:169], v13 offset:8192
    ds_read_b64_tr_b16 v[170:171], v13 offset:9216
    ds_read_b64_tr_b16 v[172:173], v14 offset:8192
    ds_read_b64_tr_b16 v[174:175], v14 offset:9216
    ds_read_b64_tr_b16 v[176:177], v11 offset:12288
    ds_read_b64_tr_b16 v[178:179], v11 offset:13312
    ds_read_b64_tr_b16 v[180:181], v12 offset:12288
    ds_read_b64_tr_b16 v[182:183], v12 offset:13312
    ds_read_b64_tr_b16 v[184:185], v13 offset:12288
    ds_read_b64_tr_b16 v[186:187], v13 offset:13312
    ds_read_b64_tr_b16 v[188:189], v14 offset:12288
    ds_read_b64_tr_b16 v[190:191], v14 offset:13312
    ds_read_b64_tr_b16 v[192:193], v11 offset:16384
    ds_read_b64_tr_b16 v[194:195], v11 offset:17408
    ds_read_b64_tr_b16 v[196:197], v12 offset:16384
    ds_read_b64_tr_b16 v[198:199], v12 offset:17408
    ds_read_b64_tr_b16 v[200:201], v13 offset:16384
    ds_read_b64_tr_b16 v[202:203], v13 offset:17408
    ds_read_b64_tr_b16 v[204:205], v14 offset:16384
    ds_read_b64_tr_b16 v[206:207], v14 offset:17408
    buffer_load_dwordx4 v[244:247], v3, s[60:63], s58 offen sc1
    buffer_load_dwordx4 v[248:251], v5, s[60:63], s58 offen offset:1024 sc1
    ds_read_b64_tr_b16 v[208:209], v11 offset:20480
    ds_read_b64_tr_b16 v[210:211], v11 offset:21504
    ds_read_b64_tr_b16 v[212:213], v12 offset:20480
    ds_read_b64_tr_b16 v[214:215], v12 offset:21504
    ds_read_b64_tr_b16 v[216:217], v13 offset:20480
    ds_read_b64_tr_b16 v[218:219], v13 offset:21504
    ds_read_b64_tr_b16 v[220:221], v14 offset:20480
    ds_read_b64_tr_b16 v[222:223], v14 offset:21504
    ds_read_b64_tr_b16 v[224:225], v11 offset:24576
    ds_read_b64_tr_b16 v[226:227], v11 offset:25600
    ds_read_b64_tr_b16 v[228:229], v12 offset:24576
    ds_read_b64_tr_b16 v[230:231], v12 offset:25600
    ds_read_b64_tr_b16 v[232:233], v13 offset:24576
    ds_read_b64_tr_b16 v[234:235], v13 offset:25600
    ds_read_b64_tr_b16 v[236:237], v14 offset:24576
    ds_read_b64_tr_b16 v[238:239], v14 offset:25600
    ds_read_b128 v[48:51], v6 offset:28672
    ds_read_b128 v[52:55], v6 offset:28736
    ds_read_b128 v[56:59], v6 offset:28800
    ds_read_b128 v[60:63], v6 offset:28864
    s_mov_b64 exec, 1
    ds_add_u32 v35, v43 offset:28
    s_mov_b64 exec, -1
    s_add_u32 s101, s54, 0x38000
    s_add_u32 s50, s101, 0x0
    s_add_u32 s51, s101, 0x1000
    s_add_u32 s52, s101, 0x2000
    s_add_u32 s53, s101, 0x3000
    s_mov_b32 s97, 0x9c40
Lpoll_33:
    s_waitcnt vmcnt(0)
    v_min3_u32 v252, v245, v247, v249
    v_max3_u32 v253, v245, v247, v249
    v_min3_u32 v252, v252, v251, v15
    v_max3_u32 v253, v253, v251, v15
    v_cmp_ne_u32 vcc, v252, v253
    s_cbranch_vccz Lpd_34
    s_sub_u32 s97, s97, 1
    s_cmp_eq_u32 s97, 0
    s_cbranch_scc1 Lpd_34
    buffer_load_dwordx4 v[244:247], v3, s[60:63], s58 offen sc1
    buffer_load_dwordx4 v[248:251], v5, s[60:63], s58 offen offset:1024 sc1
    s_branch Lpoll_33
Lpd_34:
    buffer_load_dwordx4 v[64:67], v3, s[60:63], s50 offen sc1
    buffer_load_dwordx4 v[68:71], v3, s[60:63], s50 offen offset:1024 sc1
    buffer_load_dwordx4 v[72:75], v3, s[60:63], s50 offen offset:2048 sc1
    buffer_load_dwordx4 v[76:79], v3, s[60:63], s50 offen offset:3072 sc1
    buffer_load_dwordx4 v[80:83], v3, s[60:63], s51 offen sc1
    buffer_load_dwordx4 v[84:87], v3, s[60:63], s51 offen offset:1024 sc1
    buffer_load_dwordx4 v[88:91], v3, s[60:63], s51 offen offset:2048 sc1
    buffer_load_dwordx4 v[92:95], v3, s[60:63], s51 offen offset:3072 sc1
    v_fmac_f32 v244, v248, v46
    v_fmac_f32 v246, v250, v46
    s_nop 1
    v_permlane32_swap_b32 v244, v246
    v_add_f32 v244, v244, v246
    v_mov_b32 v246, v244
    s_nop 1
    v_permlane16_swap_b32 v244, v246
    v_add_f32 v244, v244, v246
    v_mov_b32 v246, v244
    s_nop 1
    v_permlane32_swap_b32 v244, v246
    v_mul_f32 v248, 0xbb124925, v244
    s_waitcnt lgkmcnt(0)
    v_pk_mul_f32 v[48:49], v[48:49], v[248:249] op_sel_hi:[1,0]
    v_pk_mul_f32 v[50:51], v[50:51], v[248:249] op_sel_hi:[1,0]
    v_pk_mul_f32 v[52:53], v[52:53], v[248:249] op_sel_hi:[1,0]
    v_pk_mul_f32 v[54:55], v[54:55], v[248:249] op_sel_hi:[1,0]
    v_pk_mul_f32 v[56:57], v[56:57], v[248:249] op_sel_hi:[1,0]
    v_pk_mul_f32 v[58:59], v[58:59], v[248:249] op_sel_hi:[1,0]
    v_pk_mul_f32 v[60:61], v[60:61], v[248:249] op_sel_hi:[1,0]
    v_pk_mul_f32 v[62:63], v[62:63], v[248:249] op_sel_hi:[1,0]
    s_waitcnt vmcnt(7)
    v_mfma_f32_16x16x32_bf16 v[48:51], v[128:131], v[64:67], v[48:51]
    buffer_load_dwordx4 v[96:99], v3, s[60:63], s52 offen sc1
    ds_read_b64_tr_b16 v[128:129], v11 offset:28672
    ds_read_b64_tr_b16 v[130:131], v11 offset:29696
    v_mfma_f32_16x16x32_bf16 v[52:55], v[132:135], v[64:67], v[52:55]
    ds_read_b64_tr_b16 v[132:133], v12 offset:28672
    ds_read_b64_tr_b16 v[134:135], v12 offset:29696
    v_mfma_f32_16x16x32_bf16 v[56:59], v[136:139], v[64:67], v[56:59]
    ds_read_b64_tr_b16 v[136:137], v13 offset:28672
    ds_read_b64_tr_b16 v[138:139], v13 offset:29696
    v_mfma_f32_16x16x32_bf16 v[60:63], v[140:143], v[64:67], v[60:63]
    ds_read_b64_tr_b16 v[140:141], v14 offset:28672
    ds_read_b64_tr_b16 v[142:143], v14 offset:29696
    s_waitcnt vmcnt(7)
    v_mfma_f32_16x16x32_bf16 v[48:51], v[144:147], v[68:71], v[48:51]
    buffer_load_dwordx4 v[100:103], v3, s[60:63], s52 offen offset:1024 sc1
    ds_read_b64_tr_b16 v[144:145], v11 offset:32768
    ds_read_b64_tr_b16 v[146:147], v11 offset:33792
    v_mfma_f32_16x16x32_bf16 v[52:55], v[148:151], v[68:71], v[52:55]
    ds_read_b64_tr_b16 v[148:149], v12 offset:32768
    ds_read_b64_tr_b16 v[150:151], v12 offset:33792
    v_mfma_f32_16x16x32_bf16 v[56:59], v[152:155], v[68:71], v[56:59]
    ds_read_b64_tr_b16 v[152:153], v13 offset:32768
    ds_read_b64_tr_b16 v[154:155], v13 offset:33792
    v_mfma_f32_16x16x32_bf16 v[60:63], v[156:159], v[68:71], v[60:63]
    ds_read_b64_tr_b16 v[156:157], v14 offset:32768
    ds_read_b64_tr_b16 v[158:159], v14 offset:33792
    s_waitcnt vmcnt(7)
    v_mfma_f32_16x16x32_bf16 v[48:51], v[160:163], v[72:75], v[48:51]
    buffer_load_dwordx4 v[104:107], v3, s[60:63], s52 offen offset:2048 sc1
    ds_read_b64_tr_b16 v[160:161], v11 offset:36864
    ds_read_b64_tr_b16 v[162:163], v11 offset:37888
    v_mfma_f32_16x16x32_bf16 v[52:55], v[164:167], v[72:75], v[52:55]
    ds_read_b64_tr_b16 v[164:165], v12 offset:36864
    ds_read_b64_tr_b16 v[166:167], v12 offset:37888
    v_mfma_f32_16x16x32_bf16 v[56:59], v[168:171], v[72:75], v[56:59]
    ds_read_b64_tr_b16 v[168:169], v13 offset:36864
    ds_read_b64_tr_b16 v[170:171], v13 offset:37888
    v_mfma_f32_16x16x32_bf16 v[60:63], v[172:175], v[72:75], v[60:63]
    ds_read_b64_tr_b16 v[172:173], v14 offset:36864
    ds_read_b64_tr_b16 v[174:175], v14 offset:37888
    s_waitcnt vmcnt(7)
    v_mfma_f32_16x16x32_bf16 v[48:51], v[176:179], v[76:79], v[48:51]
    buffer_load_dwordx4 v[108:111], v3, s[60:63], s52 offen offset:3072 sc1
    ds_read_b64_tr_b16 v[176:177], v11 offset:40960
    ds_read_b64_tr_b16 v[178:179], v11 offset:41984
    v_mfma_f32_16x16x32_bf16 v[52:55], v[180:183], v[76:79], v[52:55]
    ds_read_b64_tr_b16 v[180:181], v12 offset:40960
    ds_read_b64_tr_b16 v[182:183], v12 offset:41984
    v_mfma_f32_16x16x32_bf16 v[56:59], v[184:187], v[76:79], v[56:59]
    ds_read_b64_tr_b16 v[184:185], v13 offset:40960
    ds_read_b64_tr_b16 v[186:187], v13 offset:41984
    v_mfma_f32_16x16x32_bf16 v[60:63], v[188:191], v[76:79], v[60:63]
    ds_read_b64_tr_b16 v[188:189], v14 offset:40960
    ds_read_b64_tr_b16 v[190:191], v14 offset:41984
    s_waitcnt vmcnt(7)
    v_mfma_f32_16x16x32_bf16 v[48:51], v[192:195], v[80:83], v[48:51]
    buffer_load_dwordx4 v[112:115], v3, s[60:63], s53 offen sc1
    ds_read_b64_tr_b16 v[192:193], v11 offset:45056
    ds_read_b64_tr_b16 v[194:195], v11 offset:46080
    v_mfma_f32_16x16x32_bf16 v[52:55], v[196:199], v[80:83], v[52:55]
    ds_read_b64_tr_b16 v[196:197], v12 offset:45056
    ds_read_b64_tr_b16 v[198:199], v12 offset:46080
    v_mfma_f32_16x16x32_bf16 v[56:59], v[200:203], v[80:83], v[56:59]
    ds_read_b64_tr_b16 v[200:201], v13 offset:45056
    ds_read_b64_tr_b16 v[202:203], v13 offset:46080
    v_mfma_f32_16x16x32_bf16 v[60:63], v[204:207], v[80:83], v[60:63]
    ds_read_b64_tr_b16 v[204:205], v14 offset:45056
    ds_read_b64_tr_b16 v[206:207], v14 offset:46080
    s_waitcnt vmcnt(7)
    v_mfma_f32_16x16x32_bf16 v[48:51], v[208:211], v[84:87], v[48:51]
    buffer_load_dwordx4 v[116:119], v3, s[60:63], s53 offen offset:1024 sc1
    ds_read_b64_tr_b16 v[208:209], v11 offset:49152
    ds_read_b64_tr_b16 v[210:211], v11 offset:50176
    v_mfma_f32_16x16x32_bf16 v[52:55], v[212:215], v[84:87], v[52:55]
    ds_read_b64_tr_b16 v[212:213], v12 offset:49152
    ds_read_b64_tr_b16 v[214:215], v12 offset:50176
    v_mfma_f32_16x16x32_bf16 v[56:59], v[216:219], v[84:87], v[56:59]
    ds_read_b64_tr_b16 v[216:217], v13 offset:49152
    ds_read_b64_tr_b16 v[218:219], v13 offset:50176
    v_mfma_f32_16x16x32_bf16 v[60:63], v[220:223], v[84:87], v[60:63]
    ds_read_b64_tr_b16 v[220:221], v14 offset:49152
    ds_read_b64_tr_b16 v[222:223], v14 offset:50176
    s_waitcnt vmcnt(7)
    v_mfma_f32_16x16x32_bf16 v[48:51], v[224:227], v[88:91], v[48:51]
    ds_read_b64_tr_b16 v[224:225], v11 offset:53248
    ds_read_b64_tr_b16 v[226:227], v11 offset:54272
    v_mfma_f32_16x16x32_bf16 v[52:55], v[228:231], v[88:91], v[52:55]
    ds_read_b64_tr_b16 v[228:229], v12 offset:53248
    ds_read_b64_tr_b16 v[230:231], v12 offset:54272
    v_mfma_f32_16x16x32_bf16 v[56:59], v[232:235], v[88:91], v[56:59]
    ds_read_b64_tr_b16 v[232:233], v13 offset:53248
    ds_read_b64_tr_b16 v[234:235], v13 offset:54272
    v_mfma_f32_16x16x32_bf16 v[60:63], v[236:239], v[88:91], v[60:63]
    ds_read_b64_tr_b16 v[236:237], v14 offset:53248
    ds_read_b64_tr_b16 v[238:239], v14 offset:54272
    s_waitcnt vmcnt(6) lgkmcnt(15)
    v_mfma_f32_16x16x32_bf16 v[48:51], v[128:131], v[92:95], v[48:51]
    v_mul_f32 v44, 0x3b124925, v244
    v_mfma_f32_16x16x32_bf16 v[52:55], v[132:135], v[92:95], v[52:55]
    v_mul_f32 v247, 0x3b124925, v246
    v_mfma_f32_16x16x32_bf16 v[56:59], v[136:139], v[92:95], v[56:59]
    v_fma_f32 v247, -v44, v44, v247
    v_mfma_f32_16x16x32_bf16 v[60:63], v[140:143], v[92:95], v[60:63]
    v_max_f32 v247, 0, v247
    s_mov_b64 exec, 1
    ds_add_u32 v35, v43 offset:32
    s_mov_b64 exec, -1
    s_waitcnt vmcnt(5)
    v_mfma_f32_16x16x32_bf16 v[48:51], v[144:147], v[96:99], v[48:51]
    v_add_f32 v45, 0x3727c5ac, v247
    v_mfma_f32_16x16x32_bf16 v[52:55], v[148:151], v[96:99], v[52:55]
    v_rsq_f32 v45, v45
    v_mfma_f32_16x16x32_bf16 v[56:59], v[152:155], v[96:99], v[56:59]
    s_add_u32 s86, s55, 0x0
    v_mfma_f32_16x16x32_bf16 v[60:63], v[156:159], v[96:99], v[60:63]
    v_mul_f32 v247, v247, v45
    s_waitcnt vmcnt(4)
    v_mfma_f32_16x16x32_bf16 v[48:51], v[160:163], v[100:103], v[48:51]
    v_mul_f32 v247, v247, v45
    v_mfma_f32_16x16x32_bf16 v[52:55], v[164:167], v[100:103], v[52:55]
    v_add_f32 v250, 0x3727c5ac, v247
    v_mfma_f32_16x16x32_bf16 v[56:59], v[168:171], v[100:103], v[56:59]
    v_rsq_f32 v250, v250
    v_mfma_f32_16x16x32_bf16 v[60:63], v[172:175], v[100:103], v[60:63]
    s_add_u32 s84, s76, 1
    s_waitcnt vmcnt(3)
    v_mfma_f32_16x16x32_bf16 v[48:51], v[176:179], v[104:107], v[48:51]
    v_mul_f32 v250, v250, v45
    v_mfma_f32_16x16x32_bf16 v[52:55], v[180:183], v[104:107], v[52:55]
    v_rcp_f32 v252, v250
    v_mfma_f32_16x16x32_bf16 v[56:59], v[184:187], v[104:107], v[56:59]
    v_mul_f32 v242, v250, v250
    v_mfma_f32_16x16x32_bf16 v[60:63], v[188:191], v[104:107], v[60:63]
    v_mul_f32 v240, 0xc0135761, v250
    s_waitcnt vmcnt(2)
    v_mfma_f32_16x16x32_bf16 v[48:51], v[192:195], v[108:111], v[48:51]
    v_mul_f32 v242, v242, v250
    v_mfma_f32_16x16x32_bf16 v[52:55], v[196:199], v[108:111], v[52:55]
    v_mul_f32 v242, 0xbdd2d3e8, v242
    v_mfma_f32_16x16x32_bf16 v[56:59], v[200:203], v[108:111], v[56:59]
    s_and_b32 s100, s84, 15
    v_mfma_f32_16x16x32_bf16 v[60:63], v[204:207], v[108:111], v[60:63]
    v_mov_b32 v244, v45
    s_waitcnt vmcnt(1) lgkmcnt(9)
    v_mfma_f32_16x16x32_bf16 v[48:51], v[208:211], v[112:115], v[48:51]
    v_mul_f32 v246, v248, v45
    v_mfma_f32_16x16x32_bf16 v[52:55], v[212:215], v[112:115], v[52:55]
    v_mfma_f32_16x16x32_bf16 v[56:59], v[216:219], v[112:115], v[56:59]
    v_mfma_f32_16x16x32_bf16 v[60:63], v[220:223], v[112:115], v[60:63]
    s_waitcnt vmcnt(0) lgkmcnt(1)
    v_mfma_f32_16x16x32_bf16 v[48:51], v[224:227], v[116:119], v[48:51]
    v_mfma_f32_16x16x32_bf16 v[52:55], v[228:231], v[116:119], v[52:55]
    v_mfma_f32_16x16x32_bf16 v[56:59], v[232:235], v[116:119], v[56:59]
    v_mfma_f32_16x16x32_bf16 v[60:63], v[236:239], v[116:119], v[60:63]
    s_nop 4
    v_pk_mul_f32 v[64:65], v[48:49], v[48:49]
    v_pk_mul_f32 v[66:67], v[50:51], v[50:51]
    v_pk_mul_f32 v[68:69], v[52:53], v[52:53]
    v_pk_mul_f32 v[70:71], v[54:55], v[54:55]
    v_pk_mul_f32 v[72:73], v[56:57], v[56:57]
    v_pk_mul_f32 v[74:75], v[58:59], v[58:59]
    v_pk_mul_f32 v[76:77], v[60:61], v[60:61]
    v_pk_mul_f32 v[78:79], v[62:63], v[62:63]
    v_pk_fma_f32 v[64:65], v[64:65], v[242:243], v[240:241] op_sel_hi:[1,0,0]
    v_pk_fma_f32 v[66:67], v[66:67], v[242:243], v[240:241] op_sel_hi:[1,0,0]
    v_pk_fma_f32 v[68:69], v[68:69], v[242:243], v[240:241] op_sel_hi:[1,0,0]
    v_pk_fma_f32 v[70:71], v[70:71], v[242:243], v[240:241] op_sel_hi:[1,0,0]
    v_pk_fma_f32 v[72:73], v[72:73], v[242:243], v[240:241] op_sel_hi:[1,0,0]
    v_pk_fma_f32 v[74:75], v[74:75], v[242:243], v[240:241] op_sel_hi:[1,0,0]
    v_pk_fma_f32 v[76:77], v[76:77], v[242:243], v[240:241] op_sel_hi:[1,0,0]
    v_pk_fma_f32 v[78:79], v[78:79], v[242:243], v[240:241] op_sel_hi:[1,0,0]
    v_pk_mul_f32 v[64:65], v[64:65], v[48:49]
    v_pk_mul_f32 v[66:67], v[66:67], v[50:51]
    v_pk_mul_f32 v[68:69], v[68:69], v[52:53]
    v_pk_mul_f32 v[70:71], v[70:71], v[54:55]
    v_pk_mul_f32 v[72:73], v[72:73], v[56:57]
    v_pk_mul_f32 v[74:75], v[74:75], v[58:59]
    v_pk_mul_f32 v[76:77], v[76:77], v[60:61]
    v_pk_mul_f32 v[78:79], v[78:79], v[62:63]
    v_exp_f32 v64, v64
    v_exp_f32 v65, v65
    v_exp_f32 v66, v66
    v_exp_f32 v67, v67
    v_exp_f32 v68, v68
    v_exp_f32 v69, v69
    v_exp_f32 v70, v70
    v_exp_f32 v71, v71
    v_exp_f32 v72, v72
    v_exp_f32 v73, v73
    v_exp_f32 v74, v74
    v_exp_f32 v75, v75
    v_exp_f32 v76, v76
    v_exp_f32 v77, v77
    v_exp_f32 v78, v78
    v_exp_f32 v79, v79
    v_pk_fma_f32 v[64:65], v[64:65], v[252:253], v[252:253] op_sel_hi:[1,0,0]
    v_pk_fma_f32 v[66:67], v[66:67], v[252:253], v[252:253] op_sel_hi:[1,0,0]
    v_pk_fma_f32 v[68:69], v[68:69], v[252:253], v[252:253] op_sel_hi:[1,0,0]
    v_pk_fma_f32 v[70:71], v[70:71], v[252:253], v[252:253] op_sel_hi:[1,0,0]
    v_pk_fma_f32 v[72:73], v[72:73], v[252:253], v[252:253] op_sel_hi:[1,0,0]
    v_pk_fma_f32 v[74:75], v[74:75], v[252:253], v[252:253] op_sel_hi:[1,0,0]
    v_pk_fma_f32 v[76:77], v[76:77], v[252:253], v[252:253] op_sel_hi:[1,0,0]
    v_pk_fma_f32 v[78:79], v[78:79], v[252:253], v[252:253] op_sel_hi:[1,0,0]
    v_rcp_f32 v64, v64
    v_rcp_f32 v65, v65
    v_rcp_f32 v66, v66
    v_rcp_f32 v67, v67
    v_rcp_f32 v68, v68
    v_rcp_f32 v69, v69
    v_rcp_f32 v70, v70
    v_rcp_f32 v71, v71
    v_rcp_f32 v72, v72
    v_rcp_f32 v73, v73
    v_rcp_f32 v74, v74
    v_rcp_f32 v75, v75
    v_rcp_f32 v76, v76
    v_rcp_f32 v77, v77
    v_rcp_f32 v78, v78
    v_rcp_f32 v79, v79
    v_pk_mul_f32 v[48:49], v[48:49], v[64:65]
    v_pk_mul_f32 v[50:51], v[50:51], v[66:67]
    v_pk_mul_f32 v[52:53], v[52:53], v[68:69]
    v_pk_mul_f32 v[54:55], v[54:55], v[70:71]
    v_pk_mul_f32 v[56:57], v[56:57], v[72:73]
    v_pk_mul_f32 v[58:59], v[58:59], v[74:75]
    v_pk_mul_f32 v[60:61], v[60:61], v[76:77]
    v_pk_mul_f32 v[62:63], v[62:63], v[78:79]
    v_cvt_pk_bf16_f32 v80, v48, v49
    v_cvt_pk_bf16_f32 v81, v50, v51
    v_cvt_pk_bf16_f32 v82, v52, v53
    v_cvt_pk_bf16_f32 v83, v54, v55
    v_cvt_pk_bf16_f32 v84, v56, v57
    v_cvt_pk_bf16_f32 v85, v58, v59
    v_cvt_pk_bf16_f32 v86, v60, v61
    v_cvt_pk_bf16_f32 v87, v62, v63
    s_mov_b64 exec, s[82:83]
    v_swap_b32 v80, v82
    v_swap_b32 v81, v83
    v_swap_b32 v84, v86
    v_swap_b32 v85, v87
    s_mov_b64 exec, -1
    s_cmp_eq_u32 s77, 1
    s_cbranch_scc0 Lsl_35
    buffer_store_dwordx4 v[80:83], v3, s[60:63], s86 offen
    buffer_store_dwordx4 v[84:87], v3, s[60:63], s86 offen offset:1024
    s_branch Lse_36
Lsl_35:
    buffer_store_dwordx4 v[80:83], v3, s[60:63], s86 offen sc1
    buffer_store_dwordx4 v[84:87], v3, s[60:63], s86 offen offset:1024 sc1
Lse_36:
    s_cmp_gt_u32 s100, 1
    s_cbranch_scc1 Lhalo_37
    s_and_b32 s85, s76, 1
    s_lshl_b32 s84, s71, 11
    s_mul_i32 s86, s85, 0x3800
    s_add_u32 s86, s86, s74
    s_add_u32 s86, s86, 0xe0000
    s_add_u32 s86, s86, s84
    buffer_store_dwordx4 v[80:83], v3, s[60:63], s86 offen sc1
    buffer_store_dwordx4 v[84:87], v3, s[60:63], s86 offen offset:1024 sc1
Lhalo_37:
    ds_read_b32 v255, v35 offset:64
    s_mov_b32 s84, 0x15000
    v_add_u32 v11, s84, v7
    v_add_u32 v12, s84, v8
    v_add_u32 v13, s84, v9
    v_add_u32 v14, s84, v10
    s_mov_b64 exec, s[82:83]
    v_swap_b32 v20, v22
    v_swap_b32 v21, v23
    v_swap_b32 v24, v26
    v_swap_b32 v25, v27
    s_mov_b64 exec, -1
    v_lshlrev_b32 v48, 16, v20
    v_and_b32 v49, 0xffff0000, v20
    v_lshlrev_b32 v50, 16, v21
    v_and_b32 v51, 0xffff0000, v21
    v_lshlrev_b32 v52, 16, v22
    v_and_b32 v53, 0xffff0000, v22
    v_lshlrev_b32 v54, 16, v23
    v_and_b32 v55, 0xffff0000, v23
    v_lshlrev_b32 v56, 16, v24
    v_and_b32 v57, 0xffff0000, v24
    v_lshlrev_b32 v58, 16, v25
    v_and_b32 v59, 0xffff0000, v25
    v_lshlrev_b32 v60, 16, v26
    v_and_b32 v61, 0xffff0000, v26
    v_lshlrev_b32 v62, 16, v27
    v_and_b32 v63, 0xffff0000, v27
    v_pk_fma_f32 v[48:49], v[48:49], v[244:245], v[246:247] op_sel_hi:[1,0,0]
    v_pk_fma_f32 v[50:51], v[50:51], v[244:245], v[246:247] op_sel_hi:[1,0,0]
    v_pk_fma_f32 v[52:53], v[52:53], v[244:245], v[246:247] op_sel_hi:[1,0,0]
    v_pk_fma_f32 v[54:55], v[54:55], v[244:245], v[246:247] op_sel_hi:[1,0,0]
    v_pk_fma_f32 v[56:57], v[56:57], v[244:245], v[246:247] op_sel_hi:[1,0,0]
    v_pk_fma_f32 v[58:59], v[58:59], v[244:245], v[246:247] op_sel_hi:[1,0,0]
    v_pk_fma_f32 v[60:61], v[60:61], v[244:245], v[246:247] op_sel_hi:[1,0,0]
    v_pk_fma_f32 v[62:63], v[62:63], v[244:245], v[246:247] op_sel_hi:[1,0,0]
    s_waitcnt lgkmcnt(0)
    v_cmp_gt_u32 vcc, 4, v255
    s_cbranch_vccz Lvk_38
    s_mov_b32 s97, 0x61a80
Lvl_39:
    ds_read_b32 v255, v35 offset:64
    s_sub_u32 s97, s97, 1
    s_waitcnt lgkmcnt(0)
    v_cmp_gt_u32 vcc, 4, v255
    s_cbranch_vccz Lvk_38
    s_cmp_lg_u32 s97, 0
    s_cbranch_scc1 Lvl_39
Lvk_38:
    ds_read_b64_tr_b16 v[128:129], v11 offset:0
    ds_read_b64_tr_b16 v[130:131], v11 offset:1024
    ds_read_b64_tr_b16 v[132:133], v12 offset:0
    ds_read_b64_tr_b16 v[134:135], v12 offset:1024
    ds_read_b64_tr_b16 v[136:137], v13 offset:0
    ds_read_b64_tr_b16 v[138:139], v13 offset:1024
    ds_read_b64_tr_b16 v[140:141], v14 offset:0
    ds_read_b64_tr_b16 v[142:143], v14 offset:1024
    s_cmp_gt_u32 s100, 1
    s_cbranch_scc1 Lhalo_40
    s_waitcnt vmcnt(2)
    s_branch Lhalo_41
Lhalo_40:
    s_waitcnt vmcnt(0)
Lhalo_41:
    s_cmp_eq_u32 s77, 1
    s_cbranch_scc0 Lsl_42
    s_mov_b64 exec, 1
    buffer_store_dword v15, off, s[60:63], s57
    s_mov_b64 exec, -1
    s_branch Lse_43
Lsl_42:
    s_mov_b64 exec, 1
    buffer_store_dword v15, off, s[60:63], s57 sc1
    s_mov_b64 exec, -1
Lse_43:
    ds_read_b64_tr_b16 v[144:145], v11 offset:4096
    ds_read_b64_tr_b16 v[146:147], v11 offset:5120
    ds_read_b64_tr_b16 v[148:149], v12 offset:4096
    ds_read_b64_tr_b16 v[150:151], v12 offset:5120
    ds_read_b64_tr_b16 v[152:153], v13 offset:4096
    ds_read_b64_tr_b16 v[154:155], v13 offset:5120
    ds_read_b64_tr_b16 v[156:157], v14 offset:4096
    ds_read_b64_tr_b16 v[158:159], v14 offset:5120
    ds_read_b64_tr_b16 v[160:161], v11 offset:8192
    ds_read_b64_tr_b16 v[162:163], v11 offset:9216
    ds_read_b64_tr_b16 v[164:165], v12 offset:8192
    ds_read_b64_tr_b16 v[166:167], v12 offset:9216
    ds_read_b64_tr_b16 v[168:169], v13 offset:8192
    ds_read_b64_tr_b16 v[170:171], v13 offset:9216
    ds_read_b64_tr_b16 v[172:173], v14 offset:8192
    ds_read_b64_tr_b16 v[174:175], v14 offset:9216
    ds_read_b64_tr_b16 v[176:177], v11 offset:12288
    ds_read_b64_tr_b16 v[178:179], v11 offset:13312
    ds_read_b64_tr_b16 v[180:181], v12 offset:12288
    ds_read_b64_tr_b16 v[182:183], v12 offset:13312
    ds_read_b64_tr_b16 v[184:185], v13 offset:12288
    ds_read_b64_tr_b16 v[186:187], v13 offset:13312
    ds_read_b64_tr_b16 v[188:189], v14 offset:12288
    ds_read_b64_tr_b16 v[190:191], v14 offset:13312
    ds_read_b64_tr_b16 v[192:193], v11 offset:16384
    ds_read_b64_tr_b16 v[194:195], v11 offset:17408
    ds_read_b64_tr_b16 v[196:197], v12 offset:16384
    ds_read_b64_tr_b16 v[198:199], v12 offset:17408
    ds_read_b64_tr_b16 v[200:201], v13 offset:16384
    ds_read_b64_tr_b16 v[202:203], v13 offset:17408
    ds_read_b64_tr_b16 v[204:205], v14 offset:16384
    ds_read_b64_tr_b16 v[206:207], v14 offset:17408
    buffer_load_dword v253, v42, s[60:63], 0 offen sc1
    ds_read_b64_tr_b16 v[208:209], v11 offset:20480
    ds_read_b64_tr_b16 v[210:211], v11 offset:21504
    ds_read_b64_tr_b16 v[212:213], v12 offset:20480
    ds_read_b64_tr_b16 v[214:215], v12 offset:21504
    ds_read_b64_tr_b16 v[216:217], v13 offset:20480
    ds_read_b64_tr_b16 v[218:219], v13 offset:21504
    ds_read_b64_tr_b16 v[220:221], v14 offset:20480
    ds_read_b64_tr_b16 v[222:223], v14 offset:21504
    ds_read_b64_tr_b16 v[224:225], v11 offset:24576
    ds_read_b64_tr_b16 v[226:227], v11 offset:25600
    ds_read_b64_tr_b16 v[228:229], v12 offset:24576
    ds_read_b64_tr_b16 v[230:231], v12 offset:25600
    ds_read_b64_tr_b16 v[232:233], v13 offset:24576
    ds_read_b64_tr_b16 v[234:235], v13 offset:25600
    ds_read_b64_tr_b16 v[236:237], v14 offset:24576
    ds_read_b64_tr_b16 v[238:239], v14 offset:25600
    s_mov_b64 exec, 1
    ds_add_u32 v35, v43 offset:40
    s_mov_b64 exec, -1
    s_mov_b32 s101, 0
    s_add_u32 s50, s101, 0x0
    s_add_u32 s51, s101, 0x1000
    s_add_u32 s52, s101, 0x2000
    s_add_u32 s53, s101, 0x3000
    s_cmp_gt_u32 s100, 1
    s_cbranch_scc1 Lhalo_44
    s_and_b32 s85, s76, 1
    s_mul_i32 s86, s85, 0x400
    s_add_u32 s86, s86, s74
    s_add_u32 s86, s86, 0xfd000
    s_add_u32 s86, s86, s78
    s_waitcnt vmcnt(2)
    s_mov_b64 exec, 1
    buffer_store_dword v15, off, s[60:63], s86 sc1
    s_mov_b64 exec, -1
Lhalo_44:
    s_mov_b32 s97, 0x9c40
Lpoll_45:
    s_waitcnt vmcnt(0)
    v_cmp_ne_u32 vcc, s75, v253
    s_cbranch_vccz Lpd_46
    s_sub_u32 s97, s97, 1
    s_cmp_eq_u32 s97, 0
    s_cbranch_scc1 Lpd_46
    buffer_load_dword v253, v42, s[60:63], 0 offen sc1
    s_branch Lpoll_45
Lpd_46:
    s_waitcnt lgkmcnt(0)
    buffer_load_dwordx4 v[64:67], v36, s[60:63], s50 offen sc1
    buffer_load_dwordx4 v[68:71], v36, s[60:63], s50 offen offset:1024 sc1
    buffer_load_dwordx4 v[72:75], v36, s[60:63], s50 offen offset:2048 sc1
    buffer_load_dwordx4 v[76:79], v38, s[60:63], s50 offen offset:3072 sc1
    buffer_load_dwordx4 v[80:83], v37, s[60:63], s51 offen sc1
    buffer_load_dwordx4 v[84:87], v37, s[60:63], s51 offen offset:1024 sc1
    buffer_load_dwordx4 v[88:91], v37, s[60:63], s51 offen offset:2048 sc1
    buffer_load_dwordx4 v[92:95], v39, s[60:63], s51 offen offset:3072 sc1
    s_add_u32 s86, s55, 0x38000
    s_add_u32 s87, s56, 0x8000
    v_bfe_u32 v252, v0, 2, 2
    v_lshrrev_b32 v253, 5, v0
    v_lshl_add_u32 v253, v253, 2, v252
    v_lshlrev_b32 v253, 7, v253
    v_and_b32 v252, 2, v252
    v_lshl_or_b32 v253, v252, 5, v253
    v_and_b32 v252, 16, v0
    v_lshl_or_b32 v253, v252, 1, v253
    v_and_b32 v252, 1, v0
    v_lshl_or_b32 v253, v252, 4, v253
    v_and_b32 v252, 2, v0
    v_lshl_or_b32 v7, v252, 2, v253
    v_xor_b32 v8, 64, v7
    v_and_b32 v9, 1, v2
    v_mul_u32_u24 v9, 0x3800, v9
    v_lshl_add_u32 v9, v1, 4, v9
    v_lshrrev_b32 v252, 5, v0
    v_lshl_add_u32 v9, v252, 8, v9
    v_min_u32 v10, 6, v1
    v_lshlrev_b32 v10, 8, v10
    v_and_b32 v248, 1, v2
    v_lshl_add_u32 v10, v248, 11, v10
    s_mul_i32 s84, s0, 0x800
    s_add_u32 s84, s84, s74
    s_add_u32 s84, s84, 0xf1004
    v_add_u32 v10, s84, v10
    v_lshl_or_b32 v248, v2, 1, v248
    v_xor_b32 v248, v248, v1
    v_lshlrev_b32 v248, 4, v248
    v_lshl_add_u32 v248, v1, 8, v248
    s_lshl_b32 s84, s73, 12
    s_add_u32 s84, s84, 0x23000
    v_add_u32 v120, s84, v248
    v_xor_b32 v121, 16, v120
    v_xor_b32 v122, 0x80, v120
    v_xor_b32 v123, 0x90, v120
    s_waitcnt vmcnt(7)
    v_mfma_f32_16x16x32_bf16 v[48:51], v[128:131], v[64:67], v[48:51]
    buffer_load_dwordx4 v[96:99], v39, s[60:63], s52 offen sc1
    ds_read_b64_tr_b16 v[128:129], v11 offset:28672
    ds_read_b64_tr_b16 v[130:131], v11 offset:29696
    v_mfma_f32_16x16x32_bf16 v[52:55], v[132:135], v[64:67], v[52:55]
    ds_read_b64_tr_b16 v[132:133], v12 offset:28672
    ds_read_b64_tr_b16 v[134:135], v12 offset:29696
    v_mfma_f32_16x16x32_bf16 v[56:59], v[136:139], v[64:67], v[56:59]
    ds_read_b64_tr_b16 v[136:137], v13 offset:28672
    ds_read_b64_tr_b16 v[138:139], v13 offset:29696
    v_mfma_f32_16x16x32_bf16 v[60:63], v[140:143], v[64:67], v[60:63]
    ds_read_b64_tr_b16 v[140:141], v14 offset:28672
    ds_read_b64_tr_b16 v[142:143], v14 offset:29696
    s_waitcnt vmcnt(7)
    v_mfma_f32_16x16x32_bf16 v[48:51], v[144:147], v[68:71], v[48:51]
    buffer_load_dwordx4 v[100:103], v39, s[60:63], s52 offen offset:1024 sc1
    ds_read_b64_tr_b16 v[144:145], v11 offset:32768
    ds_read_b64_tr_b16 v[146:147], v11 offset:33792
    v_mfma_f32_16x16x32_bf16 v[52:55], v[148:151], v[68:71], v[52:55]
    ds_read_b64_tr_b16 v[148:149], v12 offset:32768
    ds_read_b64_tr_b16 v[150:151], v12 offset:33792
    v_mfma_f32_16x16x32_bf16 v[56:59], v[152:155], v[68:71], v[56:59]
    ds_read_b64_tr_b16 v[152:153], v13 offset:32768
    ds_read_b64_tr_b16 v[154:155], v13 offset:33792
    v_mfma_f32_16x16x32_bf16 v[60:63], v[156:159], v[68:71], v[60:63]
    ds_read_b64_tr_b16 v[156:157], v14 offset:32768
    ds_read_b64_tr_b16 v[158:159], v14 offset:33792
    s_waitcnt vmcnt(7)
    v_mfma_f32_16x16x32_bf16 v[48:51], v[160:163], v[72:75], v[48:51]
    buffer_load_dwordx4 v[104:107], v41, s[60:63], s52 offen offset:2048 sc1
    ds_read_b64_tr_b16 v[160:161], v11 offset:36864
    ds_read_b64_tr_b16 v[162:163], v11 offset:37888
    v_mfma_f32_16x16x32_bf16 v[52:55], v[164:167], v[72:75], v[52:55]
    ds_read_b64_tr_b16 v[164:165], v12 offset:36864
    ds_read_b64_tr_b16 v[166:167], v12 offset:37888
    v_mfma_f32_16x16x32_bf16 v[56:59], v[168:171], v[72:75], v[56:59]
    ds_read_b64_tr_b16 v[168:169], v13 offset:36864
    ds_read_b64_tr_b16 v[170:171], v13 offset:37888
    v_mfma_f32_16x16x32_bf16 v[60:63], v[172:175], v[72:75], v[60:63]
    ds_read_b64_tr_b16 v[172:173], v14 offset:36864
    ds_read_b64_tr_b16 v[174:175], v14 offset:37888
    s_waitcnt vmcnt(7)
    v_mfma_f32_16x16x32_bf16 v[48:51], v[176:179], v[76:79], v[48:51]
    buffer_load_dwordx4 v[108:111], v40, s[60:63], s52 offen offset:3072 sc1
    ds_read_b64_tr_b16 v[176:177], v11 offset:40960
    ds_read_b64_tr_b16 v[178:179], v11 offset:41984
    v_mfma_f32_16x16x32_bf16 v[52:55], v[180:183], v[76:79], v[52:55]
    ds_read_b64_tr_b16 v[180:181], v12 offset:40960
    ds_read_b64_tr_b16 v[182:183], v12 offset:41984
    v_mfma_f32_16x16x32_bf16 v[56:59], v[184:187], v[76:79], v[56:59]
    ds_read_b64_tr_b16 v[184:185], v13 offset:40960
    ds_read_b64_tr_b16 v[186:187], v13 offset:41984
    v_mfma_f32_16x16x32_bf16 v[60:63], v[188:191], v[76:79], v[60:63]
    ds_read_b64_tr_b16 v[188:189], v14 offset:40960
    ds_read_b64_tr_b16 v[190:191], v14 offset:41984
    s_waitcnt vmcnt(7)
    v_mfma_f32_16x16x32_bf16 v[48:51], v[192:195], v[80:83], v[48:51]
    buffer_load_dwordx4 v[112:115], v40, s[60:63], s53 offen sc1
    ds_read_b64_tr_b16 v[192:193], v11 offset:45056
    ds_read_b64_tr_b16 v[194:195], v11 offset:46080
    v_mfma_f32_16x16x32_bf16 v[52:55], v[196:199], v[80:83], v[52:55]
    ds_read_b64_tr_b16 v[196:197], v12 offset:45056
    ds_read_b64_tr_b16 v[198:199], v12 offset:46080
    v_mfma_f32_16x16x32_bf16 v[56:59], v[200:203], v[80:83], v[56:59]
    ds_read_b64_tr_b16 v[200:201], v13 offset:45056
    ds_read_b64_tr_b16 v[202:203], v13 offset:46080
    v_mfma_f32_16x16x32_bf16 v[60:63], v[204:207], v[80:83], v[60:63]
    ds_read_b64_tr_b16 v[204:205], v14 offset:45056
    ds_read_b64_tr_b16 v[206:207], v14 offset:46080
    s_waitcnt vmcnt(7)
    v_mfma_f32_16x16x32_bf16 v[48:51], v[208:211], v[84:87], v[48:51]
    buffer_load_dwordx4 v[116:119], v40, s[60:63], s53 offen offset:1024 sc1
    ds_read_b64_tr_b16 v[208:209], v11 offset:49152
    ds_read_b64_tr_b16 v[210:211], v11 offset:50176
    v_mfma_f32_16x16x32_bf16 v[52:55], v[212:215], v[84:87], v[52:55]
    ds_read_b64_tr_b16 v[212:213], v12 offset:49152
    ds_read_b64_tr_b16 v[214:215], v12 offset:50176
    v_mfma_f32_16x16x32_bf16 v[56:59], v[216:219], v[84:87], v[56:59]
    ds_read_b64_tr_b16 v[216:217], v13 offset:49152
    ds_read_b64_tr_b16 v[218:219], v13 offset:50176
    v_mfma_f32_16x16x32_bf16 v[60:63], v[220:223], v[84:87], v[60:63]
    ds_read_b64_tr_b16 v[220:221], v14 offset:49152
    ds_read_b64_tr_b16 v[222:223], v14 offset:50176
    s_waitcnt vmcnt(7)
    v_mfma_f32_16x16x32_bf16 v[48:51], v[224:227], v[88:91], v[48:51]
    ds_read_b64_tr_b16 v[224:225], v11 offset:53248
    ds_read_b64_tr_b16 v[226:227], v11 offset:54272
    v_mfma_f32_16x16x32_bf16 v[52:55], v[228:231], v[88:91], v[52:55]
    ds_read_b64_tr_b16 v[228:229], v12 offset:53248
    ds_read_b64_tr_b16 v[230:231], v12 offset:54272
    v_mfma_f32_16x16x32_bf16 v[56:59], v[232:235], v[88:91], v[56:59]
    ds_read_b64_tr_b16 v[232:233], v13 offset:53248
    ds_read_b64_tr_b16 v[234:235], v13 offset:54272
    v_mfma_f32_16x16x32_bf16 v[60:63], v[236:239], v[88:91], v[60:63]
    ds_read_b64_tr_b16 v[236:237], v14 offset:53248
    ds_read_b64_tr_b16 v[238:239], v14 offset:54272
    s_waitcnt vmcnt(6) lgkmcnt(15)
    v_mfma_f32_16x16x32_bf16 v[48:51], v[128:131], v[92:95], v[48:51]
    v_mfma_f32_16x16x32_bf16 v[52:55], v[132:135], v[92:95], v[52:55]
    v_mfma_f32_16x16x32_bf16 v[56:59], v[136:139], v[92:95], v[56:59]
    v_mfma_f32_16x16x32_bf16 v[60:63], v[140:143], v[92:95], v[60:63]
    s_mov_b64 exec, 1
    ds_add_u32 v35, v43 offset:44
    s_mov_b64 exec, -1
    s_waitcnt vmcnt(5)
    v_mfma_f32_16x16x32_bf16 v[48:51], v[144:147], v[96:99], v[48:51]
    v_mfma_f32_16x16x32_bf16 v[52:55], v[148:151], v[96:99], v[52:55]
    v_mfma_f32_16x16x32_bf16 v[56:59], v[152:155], v[96:99], v[56:59]
    v_mfma_f32_16x16x32_bf16 v[60:63], v[156:159], v[96:99], v[60:63]
    s_waitcnt vmcnt(4)
    v_mfma_f32_16x16x32_bf16 v[48:51], v[160:163], v[100:103], v[48:51]
    v_mfma_f32_16x16x32_bf16 v[52:55], v[164:167], v[100:103], v[52:55]
    v_mfma_f32_16x16x32_bf16 v[56:59], v[168:171], v[100:103], v[56:59]
    v_mfma_f32_16x16x32_bf16 v[60:63], v[172:175], v[100:103], v[60:63]
    s_waitcnt vmcnt(3)
    v_mfma_f32_16x16x32_bf16 v[48:51], v[176:179], v[104:107], v[48:51]
    v_mfma_f32_16x16x32_bf16 v[52:55], v[180:183], v[104:107], v[52:55]
    v_mfma_f32_16x16x32_bf16 v[56:59], v[184:187], v[104:107], v[56:59]
    v_mfma_f32_16x16x32_bf16 v[60:63], v[188:191], v[104:107], v[60:63]
    s_waitcnt vmcnt(2)
    v_mfma_f32_16x16x32_bf16 v[48:51], v[192:195], v[108:111], v[48:51]
    v_mfma_f32_16x16x32_bf16 v[52:55], v[196:199], v[108:111], v[52:55]
    v_mfma_f32_16x16x32_bf16 v[56:59], v[200:203], v[108:111], v[56:59]
    v_mfma_f32_16x16x32_bf16 v[60:63], v[204:207], v[108:111], v[60:63]
    s_waitcnt vmcnt(1) lgkmcnt(9)
    v_mfma_f32_16x16x32_bf16 v[48:51], v[208:211], v[112:115], v[48:51]
    v_mfma_f32_16x16x32_bf16 v[52:55], v[212:215], v[112:115], v[52:55]
    v_mfma_f32_16x16x32_bf16 v[56:59], v[216:219], v[112:115], v[56:59]
    v_mfma_f32_16x16x32_bf16 v[60:63], v[220:223], v[112:115], v[60:63]
    s_waitcnt vmcnt(0) lgkmcnt(1)
    v_mfma_f32_16x16x32_bf16 v[48:51], v[224:227], v[116:119], v[48:51]
    v_mfma_f32_16x16x32_bf16 v[52:55], v[228:231], v[116:119], v[52:55]
    v_mfma_f32_16x16x32_bf16 v[56:59], v[232:235], v[116:119], v[56:59]
    v_mfma_f32_16x16x32_bf16 v[60:63], v[236:239], v[116:119], v[60:63]
    s_nop 4
    v_cvt_pk_bf16_f32 v240, v48, v49
    v_cvt_pk_bf16_f32 v241, v50, v51
    v_cvt_pk_bf16_f32 v242, v52, v53
    v_cvt_pk_bf16_f32 v243, v54, v55
    v_cvt_pk_bf16_f32 v244, v56, v57
    v_cvt_pk_bf16_f32 v245, v58, v59
    v_cvt_pk_bf16_f32 v246, v60, v61
    v_cvt_pk_bf16_f32 v247, v62, v63
    s_mov_b64 exec, s[82:83]
    v_swap_b32 v240, v242
    v_swap_b32 v241, v243
    v_swap_b32 v244, v246
    v_swap_b32 v245, v247
    s_mov_b64 exec, -1
    s_cmp_eq_u32 s77, 1
    s_cbranch_scc0 Lsl_47
    buffer_store_dwordx4 v[240:243], v3, s[60:63], s86 offen
    buffer_store_dwordx4 v[244:247], v3, s[60:63], s86 offen offset:1024
    s_branch Lse_48
Lsl_47:
    buffer_store_dwordx4 v[240:243], v3, s[60:63], s86 offen sc1
    buffer_store_dwordx4 v[244:247], v3, s[60:63], s86 offen offset:1024 sc1
Lse_48:
    v_mov_b32 v248, 0
    v_mov_b32 v250, 0
    v_dot2c_f32_bf16 v248, v240, v16
    v_dot2c_f32_bf16 v250, v240, v240
    v_dot2c_f32_bf16 v248, v241, v16
    v_dot2c_f32_bf16 v250, v241, v241
    v_dot2c_f32_bf16 v248, v242, v16
    v_dot2c_f32_bf16 v250, v242, v242
    v_dot2c_f32_bf16 v248, v243, v16
    v_dot2c_f32_bf16 v250, v243, v243
    v_dot2c_f32_bf16 v248, v244, v16
    v_dot2c_f32_bf16 v250, v244, v244
    v_dot2c_f32_bf16 v248, v245, v16
    v_dot2c_f32_bf16 v250, v245, v245
    v_dot2c_f32_bf16 v248, v246, v16
    v_dot2c_f32_bf16 v250, v246, v246
    v_dot2c_f32_bf16 v248, v247, v16
    v_dot2c_f32_bf16 v250, v247, v247
    v_mov_b32 v249, v15
    v_mov_b32 v251, v15
    s_nop 0
    v_permlane32_swap_b32 v248, v250
    v_add_f32 v248, v248, v250
    v_mov_b32 v250, v248
    s_nop 1
    v_permlane16_swap_b32 v248, v250
    v_add_f32 v248, v248, v250
    v_mov_b32 v250, v248
    s_nop 1
    v_permlane32_swap_b32 v248, v250
    s_mul_i32 s101, s0, 0x3800
    s_add_u32 s101, s101, s74
    s_add_u32 s101, s101, 0x38000
    s_add_u32 s50, s101, 0x0
    s_add_u32 s51, s101, 0x1000
    s_add_u32 s52, s101, 0x2000
    s_add_u32 s53, s101, 0x3000
    s_waitcnt vmcnt(0)
    s_cmp_eq_u32 s77, 1
    s_cbranch_scc0 Lsl_49
    s_mov_b64 exec, 0xffff
    buffer_store_dwordx4 v[248:251], v3, s[60:63], s87 offen
    s_mov_b64 exec, -1
    s_branch Lse_50
Lsl_49:
    s_mov_b64 exec, 0xffff
    buffer_store_dwordx4 v[248:251], v3, s[60:63], s87 offen sc1
    s_mov_b64 exec, -1
Lse_50:
    v_mov_b32 v16, 0x27510
    v_mov_b32 v17, 1
    ds_read_b32 v18, v16 offset:68
    v_lshlrev_b32 v28, 16, v20
    v_and_b32 v29, 0xffff0000, v20
    v_lshlrev_b32 v30, 16, v21
    v_and_b32 v31, 0xffff0000, v21
    v_lshlrev_b32 v32, 16, v22
    v_and_b32 v33, 0xffff0000, v22
    v_lshlrev_b32 v34, 16, v23
    v_and_b32 v35, 0xffff0000, v23
    v_lshlrev_b32 v36, 16, v24
    v_and_b32 v37, 0xffff0000, v24
    v_lshlrev_b32 v38, 16, v25
    v_and_b32 v39, 0xffff0000, v25
    v_lshlrev_b32 v40, 16, v26
    v_and_b32 v41, 0xffff0000, v26
    v_lshlrev_b32 v42, 16, v27
    v_and_b32 v43, 0xffff0000, v27
    v_pk_add_f32 v[28:29], v[28:29], v[48:49]
    v_pk_add_f32 v[30:31], v[30:31], v[50:51]
    v_pk_add_f32 v[32:33], v[32:33], v[52:53]
    v_pk_add_f32 v[34:35], v[34:35], v[54:55]
    v_pk_add_f32 v[36:37], v[36:37], v[56:57]
    v_pk_add_f32 v[38:39], v[38:39], v[58:59]
    v_pk_add_f32 v[40:41], v[40:41], v[60:61]
    v_pk_add_f32 v[42:43], v[42:43], v[62:63]
    s_waitcnt lgkmcnt(0)
    v_cmp_gt_u32 vcc, 4, v18
    s_cbranch_vccz Lvk_51
    s_mov_b32 s97, 0x61a80
Lvl_52:
    ds_read_b32 v18, v16 offset:68
    s_sub_u32 s97, s97, 1
    s_waitcnt lgkmcnt(0)
    v_cmp_gt_u32 vcc, 4, v18
    s_cbranch_vccz Lvk_51
    s_cmp_lg_u32 s97, 0
    s_cbranch_scc1 Lvl_52
Lvk_51:
    buffer_load_dword v253, v10, s[60:63], 0 offen sc1
    v_add_u32 v11, 0xe000, v7
    ds_read_b64_tr_b16 v[176:177], v11 offset:0
    ds_read_b64_tr_b16 v[178:179], v11 offset:1024
    v_add_u32 v12, 0xe000, v8
    ds_read_b64_tr_b16 v[180:181], v12 offset:0
    ds_read_b64_tr_b16 v[182:183], v12 offset:1024
    ds_read_b64_tr_b16 v[184:185], v11 offset:2048
    ds_read_b64_tr_b16 v[186:187], v11 offset:3072
    ds_read_b64_tr_b16 v[188:189], v12 offset:2048
    ds_read_b64_tr_b16 v[190:191], v12 offset:3072
    ds_read_b64_tr_b16 v[192:193], v11 offset:4096
    ds_read_b64_tr_b16 v[194:195], v11 offset:5120
    ds_read_b64_tr_b16 v[196:197], v12 offset:4096
    ds_read_b64_tr_b16 v[198:199], v12 offset:5120
    ds_read_b64_tr_b16 v[200:201], v11 offset:6144
    ds_read_b64_tr_b16 v[202:203], v11 offset:7168
    ds_write_b128 v120, v[28:31]
    ds_write_b128 v121, v[32:35]
    ds_write_b128 v122, v[36:39]
    ds_write_b128 v123, v[40:43]
    s_mov_b64 exec, 1
    ds_add_u32 v16, v17 offset:108
    s_mov_b64 exec, -1
    s_mov_b32 s97, 0x9c40
Lpoll_53:
    s_waitcnt vmcnt(0)
    v_cmp_ne_u32 vcc, s75, v253
    s_cbranch_vccz Lpd_54
    s_sub_u32 s97, s97, 1
    s_cmp_eq_u32 s97, 0
    s_cbranch_scc1 Lpd_54
    buffer_load_dword v253, v10, s[60:63], 0 offen sc1
    s_branch Lpoll_53
Lpd_54:
    buffer_load_dwordx4 v[64:67], v9, s[60:63], s50 offen sc1
    buffer_load_dwordx4 v[68:71], v9, s[60:63], s50 offen offset:512 sc1
    buffer_load_dwordx4 v[72:75], v9, s[60:63], s50 offen offset:1024 sc1
    buffer_load_dwordx4 v[76:79], v9, s[60:63], s50 offen offset:1536 sc1
    buffer_load_dwordx4 v[80:83], v9, s[60:63], s50 offen offset:2048 sc1
    buffer_load_dwordx4 v[84:87], v9, s[60:63], s50 offen offset:2560 sc1
    s_lshl_b32 s84, s73, 12
    s_add_u32 s85, s84, 0x1c000
    v_add_u32 v245, s85, v3
    s_mul_i32 s84, s0, 0x3800
    v_add_u32 v20, s84, v9
    v_add_u32 v21, 0xfe800, v20
    v_add_u32 v10, 0x38000, v20
    v_add_u32 v13, 0x136800, v20
    s_lshl_b32 s84, s73, 2
    v_add_u32 v19, s84, v16
    s_lshl_b32 s89, s73, 10
    s_waitcnt vmcnt(5) lgkmcnt(15)
    v_mfma_f32_32x32x16_bf16 v[48:63], v[176:179], v[64:67], 0
    buffer_load_dwordx4 v[88:91], v9, s[60:63], s50 offen offset:3072 sc1
    ds_read_b64_tr_b16 v[204:205], v12 offset:6144
    ds_read_b64_tr_b16 v[206:207], v12 offset:7168
    v_mfma_f32_32x32x16_bf16 v[224:239], v[180:183], v[64:67], 0
    ds_read_b64_tr_b16 v[208:209], v11 offset:8192
    ds_read_b64_tr_b16 v[210:211], v11 offset:9216
    s_and_b32 s88, s70, 1
    s_mul_i32 s88, s88, 28
    s_waitcnt vmcnt(5) lgkmcnt(15)
    v_mfma_f32_32x32x16_bf16 v[48:63], v[184:187], v[68:71], v[48:63]
    buffer_load_dwordx4 v[92:95], v9, s[60:63], s50 offen offset:3584 sc1
    ds_read_b64_tr_b16 v[212:213], v12 offset:8192
    ds_read_b64_tr_b16 v[214:215], v12 offset:9216
    s_lshr_b32 s85, s0, 1
    s_mul_i32 s90, s85, 0x80
    v_mfma_f32_32x32x16_bf16 v[224:239], v[188:191], v[68:71], v[224:239]
    ds_read_b64_tr_b16 v[216:217], v11 offset:10240
    ds_read_b64_tr_b16 v[218:219], v11 offset:11264
    s_add_u32 s90, s90, s74
    s_add_u32 s90, s90, 0xe8800
    s_waitcnt vmcnt(5) lgkmcnt(15)
    v_mfma_f32_32x32x16_bf16 v[48:63], v[192:195], v[72:75], v[48:63]
    buffer_load_dwordx4 v[96:99], v9, s[60:63], s51 offen sc1
    ds_read_b64_tr_b16 v[220:221], v12 offset:10240
    ds_read_b64_tr_b16 v[222:223], v12 offset:11264
    s_add_u32 s84, s90, s88
    v_min_u32 v22, 6, v0
    v_mfma_f32_32x32x16_bf16 v[224:239], v[196:199], v[72:75], v[224:239]
    ds_read_b64_tr_b16 v[176:177], v11 offset:12288
    ds_read_b64_tr_b16 v[178:179], v11 offset:13312
    v_lshl_add_u32 v22, v22, 2, s84
    s_lshl_b32 s87, s95, 2
    s_waitcnt vmcnt(5) lgkmcnt(10)
    v_mfma_f32_32x32x16_bf16 v[48:63], v[200:203], v[76:79], v[48:63]
    buffer_load_dwordx4 v[100:103], v9, s[60:63], s51 offen offset:512 sc1
    ds_read_b64_tr_b16 v[180:181], v12 offset:12288
    ds_read_b64_tr_b16 v[182:183], v12 offset:13312
    s_add_u32 s87, s87, s90
    s_add_u32 s87, s87, 64
    v_mfma_f32_32x32x16_bf16 v[224:239], v[204:207], v[76:79], v[224:239]
    ds_read_b64_tr_b16 v[184:185], v11 offset:14336
    ds_read_b64_tr_b16 v[186:187], v11 offset:15360
    s_and_b32 s85, s85, 4
    v_min_u32 v244, 13, v0
    s_waitcnt vmcnt(5) lgkmcnt(10)
    v_mfma_f32_32x32x16_bf16 v[48:63], v[208:211], v[80:83], v[48:63]
    buffer_load_dwordx4 v[104:107], v9, s[60:63], s51 offen offset:1024 sc1
    ds_read_b64_tr_b16 v[188:189], v12 offset:14336
    ds_read_b64_tr_b16 v[190:191], v12 offset:15360
    v_lshl_add_u32 v244, v244, 2, s90
    s_and_b32 s84, s73, 1
    v_mfma_f32_32x32x16_bf16 v[224:239], v[212:215], v[80:83], v[224:239]
    ds_read_b64_tr_b16 v[192:193], v11 offset:16384
    ds_read_b64_tr_b16 v[194:195], v11 offset:17408
    s_lshl_b32 s84, s84, 1
    s_add_u32 s85, s85, s84
    s_waitcnt vmcnt(5) lgkmcnt(10)
    v_mfma_f32_32x32x16_bf16 v[48:63], v[216:219], v[84:87], v[48:63]
    buffer_load_dwordx4 v[108:111], v9, s[60:63], s51 offen offset:1536 sc1
    ds_read_b64_tr_b16 v[196:197], v12 offset:16384
    ds_read_b64_tr_b16 v[198:199], v12 offset:17408
    s_lshl_b32 s85, s85, 1
    s_lshl_b32 s84, s71, 10
    v_mfma_f32_32x32x16_bf16 v[224:239], v[220:223], v[84:87], v[224:239]
    ds_read_b64_tr_b16 v[200:201], v11 offset:18432
    ds_read_b64_tr_b16 v[202:203], v11 offset:19456
    s_mov_b64 exec, 1
    ds_add_u32 v19, v17 offset:128
    s_mov_b64 exec, -1
    s_mul_i32 s86, s85, 0x3800
    s_add_u32 s86, s86, s74
    s_waitcnt vmcnt(5) lgkmcnt(11)
    v_mfma_f32_32x32x16_bf16 v[48:63], v[176:179], v[88:91], v[48:63]
    buffer_load_dwordx4 v[112:115], v9, s[60:63], s51 offen offset:2048 sc1
    ds_read_b64_tr_b16 v[204:205], v12 offset:18432
    ds_read_b64_tr_b16 v[206:207], v12 offset:19456
    s_add_u32 s86, s86, s84
    s_bitcmp1_b32 s70, 0
    s_cselect_b32 s84, 0x1c00, 0
    s_cselect_b32 s85, 0, 0x1c00
    v_mfma_f32_32x32x16_bf16 v[224:239], v[180:183], v[88:91], v[224:239]
    ds_read_b64_tr_b16 v[208:209], v11 offset:20480
    ds_read_b64_tr_b16 v[210:211], v11 offset:21504
    s_add_u32 s101, s86, s85
    s_add_u32 s86, s86, s84
    s_waitcnt vmcnt(5) lgkmcnt(11)
    v_mfma_f32_32x32x16_bf16 v[48:63], v[184:187], v[92:95], v[48:63]
    buffer_load_dwordx4 v[116:119], v9, s[60:63], s51 offen offset:2560 sc1
    ds_read_b64_tr_b16 v[212:213], v12 offset:20480
    ds_read_b64_tr_b16 v[214:215], v12 offset:21504
    s_lshl_b32 s88, s95, 10
    s_add_u32 s88, s88, s74
    v_mfma_f32_32x32x16_bf16 v[224:239], v[188:191], v[92:95], v[224:239]
    ds_read_b64_tr_b16 v[216:217], v11 offset:22528
    ds_read_b64_tr_b16 v[218:219], v11 offset:23552
    v_lshrrev_b32 v246, 5, v0
    v_lshlrev_b32 v246, 6, v246
    s_waitcnt vmcnt(5) lgkmcnt(11)
    v_mfma_f32_32x32x16_bf16 v[48:63], v[192:195], v[96:99], v[48:63]
    buffer_load_dwordx4 v[120:123], v9, s[60:63], s51 offen offset:3072 sc1
    ds_read_b64_tr_b16 v[220:221], v12 offset:22528
    ds_read_b64_tr_b16 v[222:223], v12 offset:23552
    v_add_u32 v246, 0x27100, v246
    s_add_u32 s90, s89, 0x20000
    v_mfma_f32_32x32x16_bf16 v[224:239], v[196:199], v[96:99], v[224:239]
    ds_read_b64_tr_b16 v[176:177], v11 offset:24576
    ds_read_b64_tr_b16 v[178:179], v11 offset:25600
    v_add_u32 v243, s90, v3
    v_lshrrev_b32 v240, 5, v0
    s_waitcnt vmcnt(5) lgkmcnt(10)
    v_mfma_f32_32x32x16_bf16 v[48:63], v[200:203], v[100:103], v[48:63]
    buffer_load_dwordx4 v[124:127], v9, s[60:63], s51 offen offset:3584 sc1
    ds_read_b64_tr_b16 v[180:181], v12 offset:24576
    ds_read_b64_tr_b16 v[182:183], v12 offset:25600
    v_lshlrev_b32 v240, 1, v240
    v_xor_b32 v240, v240, v1
    v_mfma_f32_32x32x16_bf16 v[224:239], v[204:207], v[100:103], v[224:239]
    ds_read_b64_tr_b16 v[184:185], v11 offset:26624
    ds_read_b64_tr_b16 v[186:187], v11 offset:27648
    v_lshlrev_b32 v240, 4, v240
    v_and_b32 v241, 31, v0
    s_waitcnt vmcnt(5) lgkmcnt(10)
    v_mfma_f32_32x32x16_bf16 v[48:63], v[208:211], v[104:107], v[48:63]
    buffer_load_dwordx4 v[128:131], v9, s[60:63], s52 offen sc1
    ds_read_b64_tr_b16 v[188:189], v12 offset:26624
    ds_read_b64_tr_b16 v[190:191], v12 offset:27648
    v_lshl_add_u32 v240, v241, 8, v240
    s_and_b32 s90, s73, 1
    v_mfma_f32_32x32x16_bf16 v[224:239], v[212:215], v[104:107], v[224:239]
    v_add_u32 v11, 0x0, v7
    ds_read_b64_tr_b16 v[192:193], v11 offset:0
    ds_read_b64_tr_b16 v[194:195], v11 offset:1024
    s_lshl_b32 s90, s90, 13
    s_add_u32 s90, s90, 0x23000
    s_waitcnt vmcnt(5) lgkmcnt(10)
    v_mfma_f32_32x32x16_bf16 v[48:63], v[216:219], v[108:111], v[48:63]
    buffer_load_dwordx4 v[132:135], v9, s[60:63], s52 offen offset:512 sc1
    v_add_u32 v12, 0x0, v8
    ds_read_b64_tr_b16 v[196:197], v12 offset:0
    ds_read_b64_tr_b16 v[198:199], v12 offset:1024
    v_add_u32 v242, s90, v240
    s_lshr_b32 s90, s73, 1
    v_mfma_f32_32x32x16_bf16 v[224:239], v[220:223], v[108:111], v[224:239]
    ds_read_b64_tr_b16 v[200:201], v11 offset:2048
    ds_read_b64_tr_b16 v[202:203], v11 offset:3072
    s_xor_b32 s90, s90, s70
    s_and_b32 s90, s90, 1
    s_waitcnt vmcnt(5) lgkmcnt(10)
    v_mfma_f32_32x32x16_bf16 v[48:63], v[176:179], v[112:115], v[48:63]
    buffer_load_dwordx4 v[136:139], v9, s[60:63], s52 offen offset:1024 sc1
    ds_read_b64_tr_b16 v[204:205], v12 offset:2048
    ds_read_b64_tr_b16 v[206:207], v12 offset:3072
    v_mfma_f32_32x32x16_bf16 v[224:239], v[180:183], v[112:115], v[224:239]
    ds_read_b64_tr_b16 v[208:209], v11 offset:4096
    ds_read_b64_tr_b16 v[210:211], v11 offset:5120
    s_waitcnt vmcnt(5) lgkmcnt(10)
    v_mfma_f32_32x32x16_bf16 v[48:63], v[184:187], v[116:119], v[48:63]
    buffer_load_dwordx4 v[140:143], v9, s[60:63], s52 offen offset:1536 sc1
    ds_read_b64_tr_b16 v[212:213], v12 offset:4096
    ds_read_b64_tr_b16 v[214:215], v12 offset:5120
    v_mfma_f32_32x32x16_bf16 v[224:239], v[188:191], v[116:119], v[224:239]
    ds_read_b64_tr_b16 v[216:217], v11 offset:6144
    ds_read_b64_tr_b16 v[218:219], v11 offset:7168
    s_waitcnt vmcnt(5) lgkmcnt(10)
    v_mfma_f32_32x32x16_bf16 v[48:63], v[192:195], v[120:123], v[48:63]
    buffer_load_dwordx4 v[144:147], v9, s[60:63], s52 offen offset:2048 sc1
    ds_read_b64_tr_b16 v[220:221], v12 offset:6144
    ds_read_b64_tr_b16 v[222:223], v12 offset:7168
    v_mfma_f32_32x32x16_bf16 v[224:239], v[196:199], v[120:123], v[224:239]
    ds_read_b64_tr_b16 v[176:177], v11 offset:8192
    ds_read_b64_tr_b16 v[178:179], v11 offset:9216
    s_waitcnt vmcnt(5) lgkmcnt(10)
    v_mfma_f32_32x32x16_bf16 v[48:63], v[200:203], v[124:127], v[48:63]
    buffer_load_dwordx4 v[148:151], v9, s[60:63], s52 offen offset:2560 sc1
    ds_read_b64_tr_b16 v[180:181], v12 offset:8192
    ds_read_b64_tr_b16 v[182:183], v12 offset:9216
    v_mfma_f32_32x32x16_bf16 v[224:239], v[204:207], v[124:127], v[224:239]
    ds_read_b64_tr_b16 v[184:185], v11 offset:10240
    ds_read_b64_tr_b16 v[186:187], v11 offset:11264
    s_waitcnt vmcnt(5) lgkmcnt(10)
    v_mfma_f32_32x32x16_bf16 v[48:63], v[208:211], v[128:131], v[48:63]
    buffer_load_dwordx4 v[152:155], v9, s[60:63], s52 offen offset:3072 sc1
    ds_read_b64_tr_b16 v[188:189], v12 offset:10240
    ds_read_b64_tr_b16 v[190:191], v12 offset:11264
    ds_read_b32 v18, v16 offset:72
    v_mfma_f32_32x32x16_bf16 v[224:239], v[212:215], v[128:131], v[224:239]
    ds_read_b64_tr_b16 v[192:193], v11 offset:12288
    ds_read_b64_tr_b16 v[194:195], v11 offset:13312
    s_waitcnt vmcnt(5) lgkmcnt(11)
    v_mfma_f32_32x32x16_bf16 v[48:63], v[216:219], v[132:135], v[48:63]
    buffer_load_dwordx4 v[156:159], v9, s[60:63], s52 offen offset:3584 sc1
    ds_read_b64_tr_b16 v[196:197], v12 offset:12288
    ds_read_b64_tr_b16 v[198:199], v12 offset:13312
    v_mfma_f32_32x32x16_bf16 v[224:239], v[220:223], v[132:135], v[224:239]
    ds_read_b64_tr_b16 v[200:201], v11 offset:14336
    ds_read_b64_tr_b16 v[202:203], v11 offset:15360
    s_waitcnt lgkmcnt(6)
    v_cmp_gt_u32 vcc, 4, v18
    s_cbranch_vccz Lvk_55
    s_mov_b32 s97, 0x61a80
Lvl_56:
    ds_read_b32 v18, v16 offset:72
    s_sub_u32 s97, s97, 1
    s_waitcnt lgkmcnt(0)
    v_cmp_gt_u32 vcc, 4, v18
    s_cbranch_vccz Lvk_55
    s_cmp_lg_u32 s97, 0
    s_cbranch_scc1 Lvl_56
Lvk_55:
    s_waitcnt vmcnt(5)
    v_mfma_f32_32x32x16_bf16 v[48:63], v[176:179], v[136:139], v[48:63]
    buffer_load_dwordx4 v[160:163], v9, s[60:63], s53 offen sc1
    ds_read_b64_tr_b16 v[204:205], v12 offset:14336
    ds_read_b64_tr_b16 v[206:207], v12 offset:15360
    v_mfma_f32_32x32x16_bf16 v[224:239], v[180:183], v[136:139], v[224:239]
    ds_read_b64_tr_b16 v[208:209], v11 offset:16384
    ds_read_b64_tr_b16 v[210:211], v11 offset:17408
    s_waitcnt vmcnt(5)
    v_mfma_f32_32x32x16_bf16 v[48:63], v[184:187], v[140:143], v[48:63]
    buffer_load_dwordx4 v[164:167], v9, s[60:63], s53 offen offset:512 sc1
    ds_read_b64_tr_b16 v[212:213], v12 offset:16384
    ds_read_b64_tr_b16 v[214:215], v12 offset:17408
    v_mfma_f32_32x32x16_bf16 v[224:239], v[188:191], v[140:143], v[224:239]
    ds_read_b64_tr_b16 v[216:217], v11 offset:18432
    ds_read_b64_tr_b16 v[218:219], v11 offset:19456
    s_mov_b64 exec, 1
    ds_add_u32 v16, v17 offset:76
    s_mov_b64 exec, -1
    s_waitcnt vmcnt(5) lgkmcnt(11)
    v_mfma_f32_32x32x16_bf16 v[48:63], v[192:195], v[144:147], v[48:63]
    buffer_load_dwordx4 v[168:171], v9, s[60:63], s53 offen offset:1024 sc1
    ds_read_b64_tr_b16 v[220:221], v12 offset:18432
    ds_read_b64_tr_b16 v[222:223], v12 offset:19456
    v_mfma_f32_32x32x16_bf16 v[224:239], v[196:199], v[144:147], v[224:239]
    ds_read_b64_tr_b16 v[176:177], v11 offset:20480
    ds_read_b64_tr_b16 v[178:179], v11 offset:21504
    ds_read_b128 v[28:31], v246 offset:0
    s_waitcnt vmcnt(5) lgkmcnt(12)
    v_mfma_f32_32x32x16_bf16 v[48:63], v[200:203], v[148:151], v[48:63]
    buffer_load_dwordx4 v[172:175], v9, s[60:63], s53 offen offset:1536 sc1
    ds_read_b64_tr_b16 v[180:181], v12 offset:20480
    ds_read_b64_tr_b16 v[182:183], v12 offset:21504
    ds_read_b128 v[32:35], v246 offset:16
    v_mfma_f32_32x32x16_bf16 v[224:239], v[204:207], v[148:151], v[224:239]
    ds_read_b64_tr_b16 v[184:185], v11 offset:22528
    ds_read_b64_tr_b16 v[186:187], v11 offset:23552
    ds_read_b128 v[36:39], v246 offset:32
    s_waitcnt vmcnt(5) lgkmcnt(14)
    v_mfma_f32_32x32x16_bf16 v[48:63], v[208:211], v[152:155], v[48:63]
    ds_read_b64_tr_b16 v[188:189], v12 offset:22528
    ds_read_b64_tr_b16 v[190:191], v12 offset:23552
    ds_read_b32 v18, v19 offset:144
    ds_read_b128 v[40:43], v246 offset:48
    v_mfma_f32_32x32x16_bf16 v[224:239], v[212:215], v[152:155], v[224:239]
    ds_read_b64_tr_b16 v[192:193], v11 offset:24576
    ds_read_b64_tr_b16 v[194:195], v11 offset:25600
    s_waitcnt vmcnt(4) lgkmcnt(15)
    v_mfma_f32_32x32x16_bf16 v[48:63], v[216:219], v[156:159], v[48:63]
    ds_read_b64_tr_b16 v[196:197], v12 offset:24576
    ds_read_b64_tr_b16 v[198:199], v12 offset:25600
    v_mfma_f32_32x32x16_bf16 v[224:239], v[220:223], v[156:159], v[224:239]
    ds_read_b64_tr_b16 v[200:201], v11 offset:26624
    ds_read_b64_tr_b16 v[202:203], v11 offset:27648
    s_waitcnt lgkmcnt(7)
    v_cmp_gt_u32 vcc, 1, v18
    s_cbranch_vccz Lvk_57
    s_mov_b32 s97, 0x61a80
Lvl_58:
    ds_read_b32 v18, v19 offset:144
    s_sub_u32 s97, s97, 1
    s_waitcnt lgkmcnt(0)
    v_cmp_gt_u32 vcc, 1, v18
    s_cbranch_vccz Lvk_57
    s_cmp_lg_u32 s97, 0
    s_cbranch_scc1 Lvl_58
Lvk_57:
    ds_read_b128 v[248:251], v243
    s_waitcnt vmcnt(3)
    v_mfma_f32_32x32x16_bf16 v[48:63], v[176:179], v[160:163], v[48:63]
    ds_read_b64_tr_b16 v[204:205], v12 offset:26624
    ds_read_b64_tr_b16 v[206:207], v12 offset:27648
    s_mov_b64 exec, 1
    ds_add_u32 v16, v17 offset:84
    s_mov_b64 exec, -1
    v_mfma_f32_32x32x16_bf16 v[224:239], v[180:183], v[160:163], v[224:239]
    v_add_u32 v11, 0x7000, v7
    ds_read_b64_tr_b16 v[208:209], v11 offset:0
    ds_read_b64_tr_b16 v[210:211], v11 offset:1024
    s_waitcnt vmcnt(2)
    v_mfma_f32_32x32x16_bf16 v[48:63], v[184:187], v[164:167], v[48:63]
    v_add_u32 v12, 0x7000, v8
    ds_read_b64_tr_b16 v[212:213], v12 offset:0
    ds_read_b64_tr_b16 v[214:215], v12 offset:1024
    v_mfma_f32_32x32x16_bf16 v[224:239], v[188:191], v[164:167], v[224:239]
    ds_read_b64_tr_b16 v[216:217], v11 offset:2048
    ds_read_b64_tr_b16 v[218:219], v11 offset:3072
    s_waitcnt vmcnt(1) lgkmcnt(12)
    v_mfma_f32_32x32x16_bf16 v[48:63], v[192:195], v[168:171], v[48:63]
    ds_read_b64_tr_b16 v[220:221], v12 offset:2048
    ds_read_b64_tr_b16 v[222:223], v12 offset:3072
    v_mfma_f32_32x32x16_bf16 v[224:239], v[196:199], v[168:171], v[224:239]
    ds_read_b64_tr_b16 v[176:177], v11 offset:4096
    ds_read_b64_tr_b16 v[178:179], v11 offset:5120
    s_waitcnt vmcnt(0) lgkmcnt(11)
    v_mfma_f32_32x32x16_bf16 v[48:63], v[200:203], v[172:175], v[48:63]
    ds_read_b64_tr_b16 v[180:181], v12 offset:4096
    ds_read_b64_tr_b16 v[182:183], v12 offset:5120
    v_mfma_f32_32x32x16_bf16 v[224:239], v[204:207], v[172:175], v[224:239]
    ds_read_b64_tr_b16 v[184:185], v11 offset:6144
    ds_read_b64_tr_b16 v[186:187], v11 offset:7168
    v_mov_b32 v24, v248
    v_mov_b32 v26, v249
    v_mov_b32 v44, v250
    v_mov_b32 v14, v251
    s_nop 2
    v_pk_fma_f32 v[48:49], v[28:29], v[24:25], v[48:49] op_sel_hi:[1,0,1]
    v_pk_fma_f32 v[50:51], v[30:31], v[24:25], v[50:51] op_sel_hi:[1,0,1]
    v_pk_fma_f32 v[52:53], v[32:33], v[24:25], v[52:53] op_sel_hi:[1,0,1]
    v_pk_fma_f32 v[54:55], v[34:35], v[24:25], v[54:55] op_sel_hi:[1,0,1]
    v_pk_fma_f32 v[56:57], v[36:37], v[24:25], v[56:57] op_sel_hi:[1,0,1]
    v_pk_fma_f32 v[58:59], v[38:39], v[24:25], v[58:59] op_sel_hi:[1,0,1]
    v_pk_fma_f32 v[60:61], v[40:41], v[24:25], v[60:61] op_sel_hi:[1,0,1]
    v_pk_fma_f32 v[62:63], v[42:43], v[24:25], v[62:63] op_sel_hi:[1,0,1]
    v_pk_mul_f32 v[28:29], v[48:49], v[48:49]
    ds_write_b128 v245, v[224:227] offset:0
    v_pk_mul_f32 v[30:31], v[50:51], v[50:51]
    v_pk_mul_f32 v[32:33], v[52:53], v[52:53]
    v_pk_mul_f32 v[34:35], v[54:55], v[54:55]
    v_pk_mul_f32 v[36:37], v[56:57], v[56:57]
    ds_write_b128 v245, v[228:231] offset:1024
    v_pk_mul_f32 v[38:39], v[58:59], v[58:59]
    v_pk_mul_f32 v[40:41], v[60:61], v[60:61]
    v_pk_mul_f32 v[42:43], v[62:63], v[62:63]
    v_pk_fma_f32 v[28:29], v[28:29], v[44:45], v[26:27] op_sel_hi:[1,0,0]
    ds_write_b128 v245, v[232:235] offset:2048
    v_pk_fma_f32 v[30:31], v[30:31], v[44:45], v[26:27] op_sel_hi:[1,0,0]
    v_pk_fma_f32 v[32:33], v[32:33], v[44:45], v[26:27] op_sel_hi:[1,0,0]
    v_pk_fma_f32 v[34:35], v[34:35], v[44:45], v[26:27] op_sel_hi:[1,0,0]
    v_pk_fma_f32 v[36:37], v[36:37], v[44:45], v[26:27] op_sel_hi:[1,0,0]
    ds_write_b128 v245, v[236:239] offset:3072
    v_pk_fma_f32 v[38:39], v[38:39], v[44:45], v[26:27] op_sel_hi:[1,0,0]
    v_pk_fma_f32 v[40:41], v[40:41], v[44:45], v[26:27] op_sel_hi:[1,0,0]
    v_pk_fma_f32 v[42:43], v[42:43], v[44:45], v[26:27] op_sel_hi:[1,0,0]
    v_pk_mul_f32 v[28:29], v[28:29], v[48:49]
    s_mov_b64 exec, 1
    ds_add_u32 v19, v17 offset:128
    s_mov_b64 exec, -1
    v_pk_mul_f32 v[30:31], v[30:31], v[50:51]
    v_pk_mul_f32 v[32:33], v[32:33], v[52:53]
    v_pk_mul_f32 v[34:35], v[34:35], v[54:55]
    v_pk_mul_f32 v[36:37], v[36:37], v[56:57]
    v_pk_mul_f32 v[38:39], v[38:39], v[58:59]
    v_pk_mul_f32 v[40:41], v[40:41], v[60:61]
    v_pk_mul_f32 v[42:43], v[42:43], v[62:63]
    v_exp_f32 v28, v28
    v_exp_f32 v29, v29
    v_exp_f32 v30, v30
    v_exp_f32 v31, v31
    v_exp_f32 v32, v32
    v_exp_f32 v33, v33
    v_exp_f32 v34, v34
    v_exp_f32 v35, v35
    v_exp_f32 v36, v36
    v_exp_f32 v37, v37
    v_exp_f32 v38, v38
    v_exp_f32 v39, v39
    v_exp_f32 v40, v40
    v_exp_f32 v41, v41
    v_exp_f32 v42, v42
    v_exp_f32 v43, v43
    v_pk_fma_f32 v[28:29], v[28:29], v[14:15], v[14:15] op_sel_hi:[1,0,0]
    v_pk_fma_f32 v[30:31], v[30:31], v[14:15], v[14:15] op_sel_hi:[1,0,0]
    v_pk_fma_f32 v[32:33], v[32:33], v[14:15], v[14:15] op_sel_hi:[1,0,0]
    v_pk_fma_f32 v[34:35], v[34:35], v[14:15], v[14:15] op_sel_hi:[1,0,0]
    v_pk_fma_f32 v[36:37], v[36:37], v[14:15], v[14:15] op_sel_hi:[1,0,0]
    v_pk_fma_f32 v[38:39], v[38:39], v[14:15], v[14:15] op_sel_hi:[1,0,0]
    v_pk_fma_f32 v[40:41], v[40:41], v[14:15], v[14:15] op_sel_hi:[1,0,0]
    v_pk_fma_f32 v[42:43], v[42:43], v[14:15], v[14:15] op_sel_hi:[1,0,0]
    v_rcp_f32 v28, v28
    v_rcp_f32 v29, v29
    v_rcp_f32 v30, v30
    v_rcp_f32 v31, v31
    v_rcp_f32 v32, v32
    v_rcp_f32 v33, v33
    v_rcp_f32 v34, v34
    v_rcp_f32 v35, v35
    v_rcp_f32 v36, v36
    v_rcp_f32 v37, v37
    v_rcp_f32 v38, v38
    v_rcp_f32 v39, v39
    v_rcp_f32 v40, v40
    v_rcp_f32 v41, v41
    v_rcp_f32 v42, v42
    v_rcp_f32 v43, v43
    v_pk_mul_f32 v[48:49], v[48:49], v[28:29]
    v_pk_mul_f32 v[50:51], v[50:51], v[30:31]
    v_pk_mul_f32 v[52:53], v[52:53], v[32:33]
    v_pk_mul_f32 v[54:55], v[54:55], v[34:35]
    v_pk_mul_f32 v[56:57], v[56:57], v[36:37]
    v_pk_mul_f32 v[58:59], v[58:59], v[38:39]
    v_pk_mul_f32 v[60:61], v[60:61], v[40:41]
    v_pk_mul_f32 v[62:63], v[62:63], v[42:43]
    v_cvt_pk_bf16_f32 v36, v48, v49
    v_cvt_pk_bf16_f32 v37, v50, v51
    v_cvt_pk_bf16_f32 v38, v52, v53
    v_cvt_pk_bf16_f32 v39, v54, v55
    v_cvt_pk_bf16_f32 v40, v56, v57
    v_cvt_pk_bf16_f32 v41, v58, v59
    v_cvt_pk_bf16_f32 v42, v60, v61
    v_cvt_pk_bf16_f32 v43, v62, v63
    s_cmp_eq_u32 s77, 1
    s_cbranch_scc0 Lsl_59
    buffer_store_dwordx4 v[36:39], v20, s[60:63], s88 offen
    buffer_store_dwordx4 v[40:43], v20, s[60:63], s88 offen offset:512
    s_branch Lse_60
Lsl_59:
    buffer_store_dwordx4 v[36:39], v20, s[60:63], s88 offen sc1
    buffer_store_dwordx4 v[40:43], v20, s[60:63], s88 offen offset:512 sc1
Lse_60:
    s_waitcnt lgkmcnt(0)
    v_mfma_f32_32x32x16_bf16 v[48:63], v[208:211], v[64:67], 0
    ds_read_b64_tr_b16 v[188:189], v12 offset:6144
    ds_read_b64_tr_b16 v[190:191], v12 offset:7168
    v_mfma_f32_32x32x16_bf16 v[224:239], v[212:215], v[64:67], 0
    ds_read_b64_tr_b16 v[192:193], v11 offset:8192
    ds_read_b64_tr_b16 v[194:195], v11 offset:9216
    v_mfma_f32_32x32x16_bf16 v[48:63], v[216:219], v[68:71], v[48:63]
    ds_read_b64_tr_b16 v[196:197], v12 offset:8192
    ds_read_b64_tr_b16 v[198:199], v12 offset:9216
    v_mfma_f32_32x32x16_bf16 v[224:239], v[220:223], v[68:71], v[224:239]
    ds_read_b64_tr_b16 v[200:201], v11 offset:10240
    ds_read_b64_tr_b16 v[202:203], v11 offset:11264
    v_mfma_f32_32x32x16_bf16 v[48:63], v[176:179], v[72:75], v[48:63]
    ds_read_b64_tr_b16 v[204:205], v12 offset:10240
    ds_read_b64_tr_b16 v[206:207], v12 offset:11264
    v_mfma_f32_32x32x16_bf16 v[224:239], v[180:183], v[72:75], v[224:239]
    ds_read_b64_tr_b16 v[208:209], v11 offset:12288
    ds_read_b64_tr_b16 v[210:211], v11 offset:13312
    s_waitcnt lgkmcnt(10)
    v_mfma_f32_32x32x16_bf16 v[48:63], v[184:187], v[76:79], v[48:63]
    ds_read_b64_tr_b16 v[212:213], v12 offset:12288
    ds_read_b64_tr_b16 v[214:215], v12 offset:13312
    v_mfma_f32_32x32x16_bf16 v[224:239], v[188:191], v[76:79], v[224:239]
    ds_read_b64_tr_b16 v[216:217], v11 offset:14336
    ds_read_b64_tr_b16 v[218:219], v11 offset:15360
    s_waitcnt lgkmcnt(10)
    v_mfma_f32_32x32x16_bf16 v[48:63], v[192:195], v[80:83], v[48:63]
    ds_read_b64_tr_b16 v[220:221], v12 offset:14336
    ds_read_b64_tr_b16 v[222:223], v12 offset:15360
    v_mfma_f32_32x32x16_bf16 v[224:239], v[196:199], v[80:83], v[224:239]
    ds_read_b64_tr_b16 v[176:177], v11 offset:16384
    ds_read_b64_tr_b16 v[178:179], v11 offset:17408
    s_waitcnt lgkmcnt(10)
    v_mfma_f32_32x32x16_bf16 v[48:63], v[200:203], v[84:87], v[48:63]
    ds_read_b64_tr_b16 v[180:181], v12 offset:16384
    ds_read_b64_tr_b16 v[182:183], v12 offset:17408
    v_mfma_f32_32x32x16_bf16 v[224:239], v[204:207], v[84:87], v[224:239]
    ds_read_b64_tr_b16 v[184:185], v11 offset:18432
    ds_read_b64_tr_b16 v[186:187], v11 offset:19456
    s_waitcnt lgkmcnt(10)
    v_mfma_f32_32x32x16_bf16 v[48:63], v[208:211], v[88:91], v[48:63]
    ds_read_b64_tr_b16 v[188:189], v12 offset:18432
    ds_read_b64_tr_b16 v[190:191], v12 offset:19456
    v_mfma_f32_32x32x16_bf16 v[224:239], v[212:215], v[88:91], v[224:239]
    ds_read_b64_tr_b16 v[192:193], v11 offset:20480
    ds_read_b64_tr_b16 v[194:195], v11 offset:21504
    s_waitcnt lgkmcnt(10)
    v_mfma_f32_32x32x16_bf16 v[48:63], v[216:219], v[92:95], v[48:63]
    ds_read_b64_tr_b16 v[196:197], v12 offset:20480
    ds_read_b64_tr_b16 v[198:199], v12 offset:21504
    v_mfma_f32_32x32x16_bf16 v[224:239], v[220:223], v[92:95], v[224:239]
    ds_read_b64_tr_b16 v[200:201], v11 offset:22528
    ds_read_b64_tr_b16 v[202:203], v11 offset:23552
    s_waitcnt lgkmcnt(10)
    v_mfma_f32_32x32x16_bf16 v[48:63], v[176:179], v[96:99], v[48:63]
    ds_read_b64_tr_b16 v[204:205], v12 offset:22528
    ds_read_b64_tr_b16 v[206:207], v12 offset:23552
    v_mfma_f32_32x32x16_bf16 v[224:239], v[180:183], v[96:99], v[224:239]
    ds_read_b64_tr_b16 v[208:209], v11 offset:24576
    ds_read_b64_tr_b16 v[210:211], v11 offset:25600
    v_add_u32 v247, 0, v15
    s_waitcnt vmcnt(0)
    s_cmp_eq_u32 s77, 1
    s_cbranch_scc0 Lsl_61
    s_mov_b64 exec, 1
    buffer_store_dword v247, off, s[60:63], s87
    s_mov_b64 exec, -1
    s_branch Lse_62
Lsl_61:
    s_mov_b64 exec, 1
    buffer_store_dword v247, off, s[60:63], s87 sc1
    s_mov_b64 exec, -1
Lse_62:
    s_waitcnt lgkmcnt(10)
    v_mfma_f32_32x32x16_bf16 v[48:63], v[184:187], v[100:103], v[48:63]
    ds_read_b64_tr_b16 v[212:213], v12 offset:24576
    ds_read_b64_tr_b16 v[214:215], v12 offset:25600
    v_mfma_f32_32x32x16_bf16 v[224:239], v[188:191], v[100:103], v[224:239]
    ds_read_b64_tr_b16 v[216:217], v11 offset:26624
    ds_read_b64_tr_b16 v[218:219], v11 offset:27648
    s_waitcnt lgkmcnt(10)
    v_mfma_f32_32x32x16_bf16 v[48:63], v[192:195], v[104:107], v[48:63]
    ds_read_b64_tr_b16 v[220:221], v12 offset:26624
    ds_read_b64_tr_b16 v[222:223], v12 offset:27648
    v_mfma_f32_32x32x16_bf16 v[224:239], v[196:199], v[104:107], v[224:239]
    v_add_u32 v11, 0x15000, v7
    ds_read_b64_tr_b16 v[176:177], v11 offset:0
    ds_read_b64_tr_b16 v[178:179], v11 offset:1024
    s_waitcnt lgkmcnt(10)
    v_mfma_f32_32x32x16_bf16 v[48:63], v[200:203], v[108:111], v[48:63]
    v_add_u32 v12, 0x15000, v8
    ds_read_b64_tr_b16 v[180:181], v12 offset:0
    ds_read_b64_tr_b16 v[182:183], v12 offset:1024
    v_mfma_f32_32x32x16_bf16 v[224:239], v[204:207], v[108:111], v[224:239]
    ds_read_b64_tr_b16 v[184:185], v11 offset:2048
    ds_read_b64_tr_b16 v[186:187], v11 offset:3072
    s_waitcnt lgkmcnt(10)
    v_mfma_f32_32x32x16_bf16 v[48:63], v[208:211], v[112:115], v[48:63]
    ds_read_b64_tr_b16 v[188:189], v12 offset:2048
    ds_read_b64_tr_b16 v[190:191], v12 offset:3072
    v_mfma_f32_32x32x16_bf16 v[224:239], v[212:215], v[112:115], v[224:239]
    ds_read_b64_tr_b16 v[192:193], v11 offset:4096
    ds_read_b64_tr_b16 v[194:195], v11 offset:5120
    s_waitcnt lgkmcnt(10)
    v_mfma_f32_32x32x16_bf16 v[48:63], v[216:219], v[116:119], v[48:63]
    ds_read_b64_tr_b16 v[196:197], v12 offset:4096
    ds_read_b64_tr_b16 v[198:199], v12 offset:5120
    v_mfma_f32_32x32x16_bf16 v[224:239], v[220:223], v[116:119], v[224:239]
    ds_read_b64_tr_b16 v[200:201], v11 offset:6144
    ds_read_b64_tr_b16 v[202:203], v11 offset:7168
    s_waitcnt lgkmcnt(10)
    v_mfma_f32_32x32x16_bf16 v[48:63], v[176:179], v[120:123], v[48:63]
    ds_read_b64_tr_b16 v[204:205], v12 offset:6144
    ds_read_b64_tr_b16 v[206:207], v12 offset:7168
    v_mfma_f32_32x32x16_bf16 v[224:239], v[180:183], v[120:123], v[224:239]
    ds_read_b64_tr_b16 v[208:209], v11 offset:8192
    ds_read_b64_tr_b16 v[210:211], v11 offset:9216
    s_waitcnt lgkmcnt(10)
    v_mfma_f32_32x32x16_bf16 v[48:63], v[184:187], v[124:127], v[48:63]
    ds_read_b64_tr_b16 v[212:213], v12 offset:8192
    ds_read_b64_tr_b16 v[214:215], v12 offset:9216
    v_mfma_f32_32x32x16_bf16 v[224:239], v[188:191], v[124:127], v[224:239]
    ds_read_b64_tr_b16 v[216:217], v11 offset:10240
    ds_read_b64_tr_b16 v[218:219], v11 offset:11264
    s_waitcnt lgkmcnt(10)
    v_mfma_f32_32x32x16_bf16 v[48:63], v[192:195], v[128:131], v[48:63]
    ds_read_b64_tr_b16 v[220:221], v12 offset:10240
    ds_read_b64_tr_b16 v[222:223], v12 offset:11264
    v_mfma_f32_32x32x16_bf16 v[224:239], v[196:199], v[128:131], v[224:239]
    ds_read_b64_tr_b16 v[176:177], v11 offset:12288
    ds_read_b64_tr_b16 v[178:179], v11 offset:13312
    buffer_load_dword v23, v244, s[60:63], 0 offen offset:64 sc1
    s_waitcnt lgkmcnt(10)
    v_mfma_f32_32x32x16_bf16 v[48:63], v[200:203], v[132:135], v[48:63]
    ds_read_b64_tr_b16 v[180:181], v12 offset:12288
    ds_read_b64_tr_b16 v[182:183], v12 offset:13312
    v_mfma_f32_32x32x16_bf16 v[224:239], v[204:207], v[132:135], v[224:239]
    ds_read_b64_tr_b16 v[184:185], v11 offset:14336
    ds_read_b64_tr_b16 v[186:187], v11 offset:15360
    s_waitcnt lgkmcnt(10)
    v_mfma_f32_32x32x16_bf16 v[48:63], v[208:211], v[136:139], v[48:63]
    ds_read_b64_tr_b16 v[188:189], v12 offset:14336
    ds_read_b64_tr_b16 v[190:191], v12 offset:15360
    v_mfma_f32_32x32x16_bf16 v[224:239], v[212:215], v[136:139], v[224:239]
    ds_read_b64_tr_b16 v[192:193], v11 offset:16384
    ds_read_b64_tr_b16 v[194:195], v11 offset:17408
    s_waitcnt lgkmcnt(10)
    v_mfma_f32_32x32x16_bf16 v[48:63], v[216:219], v[140:143], v[48:63]
    ds_read_b64_tr_b16 v[196:197], v12 offset:16384
    ds_read_b64_tr_b16 v[198:199], v12 offset:17408
    v_mfma_f32_32x32x16_bf16 v[224:239], v[220:223], v[140:143], v[224:239]
    ds_read_b64_tr_b16 v[200:201], v11 offset:18432
    ds_read_b64_tr_b16 v[202:203], v11 offset:19456
    s_waitcnt lgkmcnt(10)
    v_mfma_f32_32x32x16_bf16 v[48:63], v[176:179], v[144:147], v[48:63]
    ds_read_b64_tr_b16 v[204:205], v12 offset:18432
    ds_read_b64_tr_b16 v[206:207], v12 offset:19456
    ds_read_b32 v18, v19 offset:144
    v_mfma_f32_32x32x16_bf16 v[224:239], v[180:183], v[144:147], v[224:239]
    ds_read_b64_tr_b16 v[208:209], v11 offset:20480
    ds_read_b64_tr_b16 v[210:211], v11 offset:21504
    s_add_u32 s84, s75, 0
    s_waitcnt vmcnt(0)
    s_mov_b32 s97, 0x9c40
Lrl_64:
    v_subrev_u32 v23, s84, v23
    v_cmp_le_u32 vcc, 4, v23
    s_cbranch_vccz Lrk_63
    s_sub_u32 s97, s97, 1
    s_cmp_eq_u32 s97, 0
    s_cbranch_scc1 Lrk_63
    buffer_load_dword v23, v244, s[60:63], 0 offen offset:64 sc1
    s_waitcnt vmcnt(0)
    s_branch Lrl_64
Lrk_63:
    s_waitcnt lgkmcnt(11)
    v_mfma_f32_32x32x16_bf16 v[48:63], v[184:187], v[148:151], v[48:63]
    v_mov_b64 v[64:65], v[36:37]
    v_mov_b64 v[66:67], v[38:39]
    ds_read_b64_tr_b16 v[212:213], v12 offset:20480
    ds_read_b64_tr_b16 v[214:215], v12 offset:21504
    v_mfma_f32_32x32x16_bf16 v[224:239], v[188:191], v[148:151], v[224:239]
    ds_read_b64_tr_b16 v[216:217], v11 offset:22528
    ds_read_b64_tr_b16 v[218:219], v11 offset:23552
    s_waitcnt lgkmcnt(6)
    v_cmp_gt_u32 vcc, 2, v18
    s_cbranch_vccz Lvk_65
    s_mov_b32 s97, 0x61a80
Lvl_66:
    ds_read_b32 v18, v19 offset:144
    s_sub_u32 s97, s97, 1
    s_waitcnt lgkmcnt(0)
    v_cmp_gt_u32 vcc, 2, v18
    s_cbranch_vccz Lvk_65
    s_cmp_lg_u32 s97, 0
    s_cbranch_scc1 Lvl_66
Lvk_65:
    v_mfma_f32_32x32x16_bf16 v[48:63], v[192:195], v[152:155], v[48:63]
    v_mov_b64 v[68:69], v[40:41]
    v_mov_b64 v[70:71], v[42:43]
    ds_read_b64_tr_b16 v[220:221], v12 offset:22528
    ds_read_b64_tr_b16 v[222:223], v12 offset:23552
    v_mfma_f32_32x32x16_bf16 v[224:239], v[196:199], v[152:155], v[224:239]
    ds_read_b64_tr_b16 v[176:177], v11 offset:24576
    ds_read_b64_tr_b16 v[178:179], v11 offset:25600
    ds_read_b128 v[28:31], v246 offset:256
    v_mfma_f32_32x32x16_bf16 v[48:63], v[200:203], v[156:159], v[48:63]
    buffer_load_dwordx4 v[72:75], v20, s[60:63], s19 offen sc1
    ds_read_b64_tr_b16 v[180:181], v12 offset:24576
    ds_read_b64_tr_b16 v[182:183], v12 offset:25600
    ds_read_b128 v[32:35], v246 offset:272
    v_mfma_f32_32x32x16_bf16 v[224:239], v[204:207], v[156:159], v[224:239]
    ds_read_b64_tr_b16 v[184:185], v11 offset:26624
    ds_read_b64_tr_b16 v[186:187], v11 offset:27648
    ds_read_b128 v[36:39], v246 offset:288
    s_waitcnt lgkmcnt(13)
    v_mfma_f32_32x32x16_bf16 v[48:63], v[208:211], v[160:163], v[48:63]
    buffer_load_dwordx4 v[76:79], v20, s[60:63], s19 offen offset:512 sc1
    ds_read_b64_tr_b16 v[188:189], v12 offset:26624
    ds_read_b64_tr_b16 v[190:191], v12 offset:27648
    s_mov_b64 exec, 1
    ds_add_u32 v16, v17 offset:92
    s_mov_b64 exec, -1
    ds_read_b128 v[40:43], v246 offset:304
    v_mfma_f32_32x32x16_bf16 v[224:239], v[212:215], v[160:163], v[224:239]
    s_waitcnt lgkmcnt(13)
    v_mfma_f32_32x32x16_bf16 v[48:63], v[216:219], v[164:167], v[48:63]
    buffer_load_dwordx4 v[80:83], v20, s[60:63], s20 offen sc1
    v_mfma_f32_32x32x16_bf16 v[224:239], v[220:223], v[164:167], v[224:239]
    s_waitcnt lgkmcnt(8)
    v_mfma_f32_32x32x16_bf16 v[48:63], v[176:179], v[168:171], v[48:63]
    buffer_load_dwordx4 v[84:87], v20, s[60:63], s20 offen offset:512 sc1
    v_mfma_f32_32x32x16_bf16 v[224:239], v[180:183], v[168:171], v[224:239]
    s_waitcnt lgkmcnt(2)
    v_mfma_f32_32x32x16_bf16 v[48:63], v[184:187], v[172:175], v[48:63]
    buffer_load_dwordx4 v[88:91], v20, s[60:63], s21 offen sc1
    v_mfma_f32_32x32x16_bf16 v[224:239], v[188:191], v[172:175], v[224:239]
    s_nop 9
    v_pk_fma_f32 v[48:49], v[28:29], v[24:25], v[48:49] op_sel_hi:[1,0,1]
    v_pk_fma_f32 v[50:51], v[30:31], v[24:25], v[50:51] op_sel_hi:[1,0,1]
    v_pk_fma_f32 v[52:53], v[32:33], v[24:25], v[52:53] op_sel_hi:[1,0,1]
    v_pk_fma_f32 v[54:55], v[34:35], v[24:25], v[54:55] op_sel_hi:[1,0,1]
    v_pk_fma_f32 v[56:57], v[36:37], v[24:25], v[56:57] op_sel_hi:[1,0,1]
    v_pk_fma_f32 v[58:59], v[38:39], v[24:25], v[58:59] op_sel_hi:[1,0,1]
    v_pk_fma_f32 v[60:61], v[40:41], v[24:25], v[60:61] op_sel_hi:[1,0,1]
    v_pk_fma_f32 v[62:63], v[42:43], v[24:25], v[62:63] op_sel_hi:[1,0,1]
    v_pk_mul_f32 v[28:29], v[48:49], v[48:49]
    ds_write_b128 v245, v[224:227] offset:0
    v_pk_mul_f32 v[30:31], v[50:51], v[50:51]
    v_pk_mul_f32 v[32:33], v[52:53], v[52:53]
    v_pk_mul_f32 v[34:35], v[54:55], v[54:55]
    v_pk_mul_f32 v[36:37], v[56:57], v[56:57]
    ds_write_b128 v245, v[228:231] offset:1024
    v_pk_mul_f32 v[38:39], v[58:59], v[58:59]
    v_pk_mul_f32 v[40:41], v[60:61], v[60:61]
    v_pk_mul_f32 v[42:43], v[62:63], v[62:63]
    v_pk_fma_f32 v[28:29], v[28:29], v[44:45], v[26:27] op_sel_hi:[1,0,0]
    ds_write_b128 v245, v[232:235] offset:2048
    v_pk_fma_f32 v[30:31], v[30:31], v[44:45], v[26:27] op_sel_hi:[1,0,0]
    v_pk_fma_f32 v[32:33], v[32:33], v[44:45], v[26:27] op_sel_hi:[1,0,0]
    v_pk_fma_f32 v[34:35], v[34:35], v[44:45], v[26:27] op_sel_hi:[1,0,0]
    v_pk_fma_f32 v[36:37], v[36:37], v[44:45], v[26:27] op_sel_hi:[1,0,0]
    ds_write_b128 v245, v[236:239] offset:3072
    v_pk_fma_f32 v[38:39], v[38:39], v[44:45], v[26:27] op_sel_hi:[1,0,0]
    v_pk_fma_f32 v[40:41], v[40:41], v[44:45], v[26:27] op_sel_hi:[1,0,0]
    v_pk_fma_f32 v[42:43], v[42:43], v[44:45], v[26:27] op_sel_hi:[1,0,0]
    v_pk_mul_f32 v[28:29], v[28:29], v[48:49]
    s_mov_b64 exec, 1
    ds_add_u32 v19, v17 offset:128
    s_mov_b64 exec, -1
    v_pk_mul_f32 v[30:31], v[30:31], v[50:51]
    v_pk_mul_f32 v[32:33], v[32:33], v[52:53]
    v_pk_mul_f32 v[34:35], v[34:35], v[54:55]
    v_pk_mul_f32 v[36:37], v[36:37], v[56:57]
    buffer_load_dwordx4 v[92:95], v20, s[60:63], s21 offen offset:512 sc1
    v_pk_mul_f32 v[38:39], v[38:39], v[58:59]
    v_pk_mul_f32 v[40:41], v[40:41], v[60:61]
    v_pk_mul_f32 v[42:43], v[42:43], v[62:63]
    v_exp_f32 v28, v28
    v_exp_f32 v29, v29
    v_exp_f32 v30, v30
    v_exp_f32 v31, v31
    v_exp_f32 v32, v32
    v_exp_f32 v33, v33
    v_exp_f32 v34, v34
    v_exp_f32 v35, v35
    v_exp_f32 v36, v36
    v_exp_f32 v37, v37
    v_exp_f32 v38, v38
    v_exp_f32 v39, v39
    v_exp_f32 v40, v40
    v_exp_f32 v41, v41
    v_exp_f32 v42, v42
    v_exp_f32 v43, v43
    v_pk_fma_f32 v[28:29], v[28:29], v[14:15], v[14:15] op_sel_hi:[1,0,0]
    v_pk_fma_f32 v[30:31], v[30:31], v[14:15], v[14:15] op_sel_hi:[1,0,0]
    v_pk_fma_f32 v[32:33], v[32:33], v[14:15], v[14:15] op_sel_hi:[1,0,0]
    v_pk_fma_f32 v[34:35], v[34:35], v[14:15], v[14:15] op_sel_hi:[1,0,0]
    v_pk_fma_f32 v[36:37], v[36:37], v[14:15], v[14:15] op_sel_hi:[1,0,0]
    v_pk_fma_f32 v[38:39], v[38:39], v[14:15], v[14:15] op_sel_hi:[1,0,0]
    v_pk_fma_f32 v[40:41], v[40:41], v[14:15], v[14:15] op_sel_hi:[1,0,0]
    v_pk_fma_f32 v[42:43], v[42:43], v[14:15], v[14:15] op_sel_hi:[1,0,0]
    v_rcp_f32 v28, v28
    ds_read_b32 v18, v16 offset:108
    v_rcp_f32 v29, v29
    v_rcp_f32 v30, v30
    v_rcp_f32 v31, v31
    v_rcp_f32 v32, v32
    v_rcp_f32 v33, v33
    v_rcp_f32 v34, v34
    v_rcp_f32 v35, v35
    v_rcp_f32 v36, v36
    s_waitcnt lgkmcnt(0)
    v_cmp_gt_u32 vcc, 8, v18
    s_cbranch_vccz Lvk_67
    s_mov_b32 s97, 0x61a80
Lvl_68:
    ds_read_b32 v18, v16 offset:108
    s_sub_u32 s97, s97, 1
    s_waitcnt lgkmcnt(0)
    v_cmp_gt_u32 vcc, 8, v18
    s_cbranch_vccz Lvk_67
    s_cmp_lg_u32 s97, 0
    s_cbranch_scc1 Lvl_68
Lvk_67:
    s_cmp_eq_u32 s90, 0
    s_cbranch_scc1 Lin_69
    v_mov_b64 v[224:225], 0
    v_mov_b64 v[226:227], 0
    v_mov_b64 v[228:229], 0
    v_mov_b64 v[230:231], 0
    v_mov_b64 v[232:233], 0
    v_mov_b64 v[234:235], 0
    v_mov_b64 v[236:237], 0
    v_mov_b64 v[238:239], 0
    s_branch Lin_70
Lin_69:
    v_xor_b32 v248, 0x80, v242
    ds_read_b128 v[224:227], v248
    v_xor_b32 v249, 0x90, v242
    ds_read_b128 v[228:231], v249
    v_xor_b32 v250, 0xc0, v242
    ds_read_b128 v[232:235], v250
    v_xor_b32 v251, 0xd0, v242
    ds_read_b128 v[236:239], v251
Lin_70:
    v_add_u32 v11, 0xe000, v7
    ds_read_b64_tr_b16 v[192:193], v11 offset:0
    ds_read_b64_tr_b16 v[194:195], v11 offset:1024
    v_add_u32 v12, 0xe000, v8
    ds_read_b64_tr_b16 v[196:197], v12 offset:0
    ds_read_b64_tr_b16 v[198:199], v12 offset:1024
    ds_read_b64_tr_b16 v[200:201], v11 offset:2048
    ds_read_b64_tr_b16 v[202:203], v11 offset:3072
    ds_read_b64_tr_b16 v[204:205], v12 offset:2048
    ds_read_b64_tr_b16 v[206:207], v12 offset:3072
    ds_read_b64_tr_b16 v[208:209], v11 offset:4096
    ds_read_b64_tr_b16 v[210:211], v11 offset:5120
    ds_read_b64_tr_b16 v[212:213], v12 offset:4096
    ds_read_b64_tr_b16 v[214:215], v12 offset:5120
    ds_read_b64_tr_b16 v[216:217], v11 offset:6144
    ds_read_b64_tr_b16 v[218:219], v11 offset:7168
    v_rcp_f32 v37, v37
    v_rcp_f32 v38, v38
    v_rcp_f32 v39, v39
    v_rcp_f32 v40, v40
    v_rcp_f32 v41, v41
    v_rcp_f32 v42, v42
    v_rcp_f32 v43, v43
    v_pk_mul_f32 v[48:49], v[48:49], v[28:29]
    v_pk_mul_f32 v[50:51], v[50:51], v[30:31]
    v_pk_mul_f32 v[52:53], v[52:53], v[32:33]
    v_pk_mul_f32 v[54:55], v[54:55], v[34:35]
    v_pk_mul_f32 v[56:57], v[56:57], v[36:37]
    v_pk_mul_f32 v[58:59], v[58:59], v[38:39]
    v_pk_mul_f32 v[60:61], v[60:61], v[40:41]
    v_pk_mul_f32 v[62:63], v[62:63], v[42:43]
    v_cvt_pk_bf16_f32 v36, v48, v49
    v_cvt_pk_bf16_f32 v37, v50, v51
    v_cvt_pk_bf16_f32 v38, v52, v53
    v_cvt_pk_bf16_f32 v39, v54, v55
    v_cvt_pk_bf16_f32 v40, v56, v57
    v_cvt_pk_bf16_f32 v41, v58, v59
    v_cvt_pk_bf16_f32 v42, v60, v61
    v_cvt_pk_bf16_f32 v43, v62, v63
    s_cmp_eq_u32 s90, 0
    s_cbranch_scc1 Lin_71
    v_mov_b64 v[48:49], 0
    v_mov_b64 v[50:51], 0
    v_mov_b64 v[52:53], 0
    v_mov_b64 v[54:55], 0
    v_mov_b64 v[56:57], 0
    v_mov_b64 v[58:59], 0
    v_mov_b64 v[60:61], 0
    v_mov_b64 v[62:63], 0
    s_branch Lin_72
Lin_71:
    v_xor_b32 v248, 0x0, v242
    ds_read_b128 v[48:51], v248
    v_xor_b32 v249, 0x10, v242
    ds_read_b128 v[52:55], v249
    v_xor_b32 v250, 0x40, v242
    ds_read_b128 v[56:59], v250
    v_xor_b32 v251, 0x50, v242
    ds_read_b128 v[60:63], v251
Lin_72:
    s_cmp_eq_u32 s77, 1
    s_cbranch_scc0 Lsl_73
    buffer_store_dwordx4 v[36:39], v10, s[60:63], s88 offen
    buffer_store_dwordx4 v[40:43], v10, s[60:63], s88 offen offset:512
    s_branch Lse_74
Lsl_73:
    buffer_store_dwordx4 v[36:39], v10, s[60:63], s88 offen sc1
    buffer_store_dwordx4 v[40:43], v10, s[60:63], s88 offen offset:512 sc1
Lse_74:
    s_waitcnt lgkmcnt(0)
    v_mfma_f32_32x32x16_bf16 v[48:63], v[192:195], v[64:67], v[48:63]
    buffer_load_dwordx4 v[96:99], v20, s[60:63], s22 offen sc1
    ds_read_b64_tr_b16 v[220:221], v12 offset:6144
    ds_read_b64_tr_b16 v[222:223], v12 offset:7168
    v_mfma_f32_32x32x16_bf16 v[224:239], v[196:199], v[64:67], v[224:239]
    buffer_load_dwordx4 v[100:103], v20, s[60:63], s22 offen offset:512 sc1
    ds_read_b64_tr_b16 v[176:177], v11 offset:8192
    ds_read_b64_tr_b16 v[178:179], v11 offset:9216
    buffer_load_dword v23, v22, s[60:63], 0 offen sc1
    v_mfma_f32_32x32x16_bf16 v[48:63], v[200:203], v[68:71], v[48:63]
    buffer_load_dwordx4 v[104:107], v20, s[60:63], s23 offen sc1
    ds_read_b64_tr_b16 v[180:181], v12 offset:8192
    ds_read_b64_tr_b16 v[182:183], v12 offset:9216
    v_mfma_f32_32x32x16_bf16 v[224:239], v[204:207], v[68:71], v[224:239]
    buffer_load_dwordx4 v[108:111], v20, s[60:63], s23 offen offset:512 sc1
    ds_read_b64_tr_b16 v[184:185], v11 offset:10240
    ds_read_b64_tr_b16 v[186:187], v11 offset:11264
    s_waitcnt vmcnt(12)
    v_mfma_f32_32x32x16_bf16 v[48:63], v[208:211], v[72:75], v[48:63]
    buffer_load_dwordx4 v[112:115], v20, s[60:63], s3 offen sc1
    ds_read_b64_tr_b16 v[188:189], v12 offset:10240
    ds_read_b64_tr_b16 v[190:191], v12 offset:11264
    v_mfma_f32_32x32x16_bf16 v[224:239], v[212:215], v[72:75], v[224:239]
    buffer_load_dwordx4 v[116:119], v20, s[60:63], s3 offen offset:512 sc1
    ds_read_b64_tr_b16 v[192:193], v11 offset:12288
    ds_read_b64_tr_b16 v[194:195], v11 offset:13312
    s_waitcnt vmcnt(13) lgkmcnt(10)
    v_mfma_f32_32x32x16_bf16 v[48:63], v[216:219], v[76:79], v[48:63]
    ds_read_b64_tr_b16 v[196:197], v12 offset:12288
    ds_read_b64_tr_b16 v[198:199], v12 offset:13312
    v_mfma_f32_32x32x16_bf16 v[224:239], v[220:223], v[76:79], v[224:239]
    ds_read_b64_tr_b16 v[200:201], v11 offset:14336
    ds_read_b64_tr_b16 v[202:203], v11 offset:15360
    s_add_u32 s84, s75, 0
    s_waitcnt vmcnt(4)
    s_mov_b32 s97, 0x9c40
Lrl_76:
    v_subrev_u32 v23, s84, v23
    v_cmp_le_u32 vcc, 4, v23
    s_cbranch_vccz Lrk_75
    s_sub_u32 s97, s97, 1
    s_cmp_eq_u32 s97, 0
    s_cbranch_scc1 Lrk_75
    buffer_load_dword v23, v22, s[60:63], 0 offen sc1
    s_waitcnt vmcnt(0)
    s_branch Lrl_76
Lrk_75:
    s_waitcnt lgkmcnt(10)
    v_mfma_f32_32x32x16_bf16 v[48:63], v[176:179], v[80:83], v[48:63]
    buffer_load_dwordx4 v[120:123], v21, s[60:63], s18 offen sc1
    ds_read_b64_tr_b16 v[204:205], v12 offset:14336
    ds_read_b64_tr_b16 v[206:207], v12 offset:15360
    v_mfma_f32_32x32x16_bf16 v[224:239], v[180:183], v[80:83], v[224:239]
    buffer_load_dwordx4 v[124:127], v21, s[60:63], s18 offen offset:512 sc1
    ds_read_b64_tr_b16 v[208:209], v11 offset:16384
    ds_read_b64_tr_b16 v[210:211], v11 offset:17408
    s_waitcnt lgkmcnt(10)
    v_mfma_f32_32x32x16_bf16 v[48:63], v[184:187], v[84:87], v[48:63]
    buffer_load_dwordx4 v[128:131], v21, s[60:63], s19 offen sc1
    ds_read_b64_tr_b16 v[212:213], v12 offset:16384
    ds_read_b64_tr_b16 v[214:215], v12 offset:17408
    v_mfma_f32_32x32x16_bf16 v[224:239], v[188:191], v[84:87], v[224:239]
    buffer_load_dwordx4 v[132:135], v21, s[60:63], s19 offen offset:512 sc1
    ds_read_b64_tr_b16 v[216:217], v11 offset:18432
    ds_read_b64_tr_b16 v[218:219], v11 offset:19456
    v_add_u32 v247, 1, v15
    s_cmp_eq_u32 s77, 1
    s_cbranch_scc0 Lsl_77
    s_mov_b64 exec, 1
    buffer_store_dword v247, off, s[60:63], s87
    s_mov_b64 exec, -1
    s_branch Lse_78
Lsl_77:
    s_mov_b64 exec, 1
    buffer_store_dword v247, off, s[60:63], s87 sc1
    s_mov_b64 exec, -1
Lse_78:
    s_waitcnt lgkmcnt(10)
    v_mfma_f32_32x32x16_bf16 v[48:63], v[192:195], v[88:91], v[48:63]
    buffer_load_dwordx4 v[136:139], v21, s[60:63], s20 offen sc1
    ds_read_b64_tr_b16 v[220:221], v12 offset:18432
    ds_read_b64_tr_b16 v[222:223], v12 offset:19456
    v_mfma_f32_32x32x16_bf16 v[224:239], v[196:199], v[88:91], v[224:239]
    buffer_load_dwordx4 v[140:143], v21, s[60:63], s20 offen offset:512 sc1
    ds_read_b64_tr_b16 v[176:177], v11 offset:20480
    ds_read_b64_tr_b16 v[178:179], v11 offset:21504
    s_waitcnt lgkmcnt(10)
    v_mfma_f32_32x32x16_bf16 v[48:63], v[200:203], v[92:95], v[48:63]
    buffer_load_dwordx4 v[144:147], v21, s[60:63], s21 offen sc1
    ds_read_b64_tr_b16 v[180:181], v12 offset:20480
    ds_read_b64_tr_b16 v[182:183], v12 offset:21504
    v_mfma_f32_32x32x16_bf16 v[224:239], v[204:207], v[92:95], v[224:239]
    buffer_load_dwordx4 v[148:151], v21, s[60:63], s21 offen offset:512 sc1
    ds_read_b64_tr_b16 v[184:185], v11 offset:22528
    ds_read_b64_tr_b16 v[186:187], v11 offset:23552
    s_waitcnt lgkmcnt(10)
    v_mfma_f32_32x32x16_bf16 v[48:63], v[208:211], v[96:99], v[48:63]
    buffer_load_dwordx4 v[152:155], v21, s[60:63], s22 offen sc1
    ds_read_b64_tr_b16 v[188:189], v12 offset:22528
    ds_read_b64_tr_b16 v[190:191], v12 offset:23552
    v_mfma_f32_32x32x16_bf16 v[224:239], v[212:215], v[96:99], v[224:239]
    buffer_load_dwordx4 v[156:159], v21, s[60:63], s22 offen offset:512 sc1
    ds_read_b64_tr_b16 v[192:193], v11 offset:24576
    ds_read_b64_tr_b16 v[194:195], v11 offset:25600
    s_waitcnt lgkmcnt(10)
    v_mfma_f32_32x32x16_bf16 v[48:63], v[216:219], v[100:103], v[48:63]
    buffer_load_dwordx4 v[160:163], v21, s[60:63], s23 offen sc1
    ds_read_b64_tr_b16 v[196:197], v12 offset:24576
    ds_read_b64_tr_b16 v[198:199], v12 offset:25600
    v_mfma_f32_32x32x16_bf16 v[224:239], v[220:223], v[100:103], v[224:239]
    ds_read_b64_tr_b16 v[200:201], v11 offset:26624
    ds_read_b64_tr_b16 v[202:203], v11 offset:27648
    s_waitcnt vmcnt(15) lgkmcnt(10)
    v_mfma_f32_32x32x16_bf16 v[48:63], v[176:179], v[104:107], v[48:63]
    buffer_load_dwordx4 v[164:167], v21, s[60:63], s23 offen offset:512 sc1
    ds_read_b64_tr_b16 v[204:205], v12 offset:26624
    ds_read_b64_tr_b16 v[206:207], v12 offset:27648
    v_mfma_f32_32x32x16_bf16 v[224:239], v[180:183], v[104:107], v[224:239]
    v_add_u32 v11, 0x0, v7
    ds_read_b64_tr_b16 v[208:209], v11 offset:0
    ds_read_b64_tr_b16 v[210:211], v11 offset:1024
    s_waitcnt vmcnt(15) lgkmcnt(10)
    v_mfma_f32_32x32x16_bf16 v[48:63], v[184:187], v[108:111], v[48:63]
    buffer_load_dwordx4 v[168:171], v21, s[60:63], s3 offen sc1
    v_add_u32 v12, 0x0, v8
    ds_read_b64_tr_b16 v[212:213], v12 offset:0
    ds_read_b64_tr_b16 v[214:215], v12 offset:1024
    v_mfma_f32_32x32x16_bf16 v[224:239], v[188:191], v[108:111], v[224:239]
    ds_read_b64_tr_b16 v[216:217], v11 offset:2048
    ds_read_b64_tr_b16 v[218:219], v11 offset:3072
    buffer_load_dword v23, v22, s[60:63], 0 offen offset:64 sc1
    s_waitcnt vmcnt(16) lgkmcnt(10)
    v_mfma_f32_32x32x16_bf16 v[48:63], v[192:195], v[112:115], v[48:63]
    buffer_load_dwordx4 v[172:175], v21, s[60:63], s3 offen offset:512 sc1
    ds_read_b64_tr_b16 v[220:221], v12 offset:2048
    ds_read_b64_tr_b16 v[222:223], v12 offset:3072
    v_mfma_f32_32x32x16_bf16 v[224:239], v[196:199], v[112:115], v[224:239]
    ds_read_b64_tr_b16 v[176:177], v11 offset:4096
    ds_read_b64_tr_b16 v[178:179], v11 offset:5120
    s_waitcnt vmcnt(16) lgkmcnt(10)
    v_mfma_f32_32x32x16_bf16 v[48:63], v[200:203], v[116:119], v[48:63]
    ds_read_b64_tr_b16 v[180:181], v12 offset:4096
    ds_read_b64_tr_b16 v[182:183], v12 offset:5120
    v_mfma_f32_32x32x16_bf16 v[224:239], v[204:207], v[116:119], v[224:239]
    ds_read_b64_tr_b16 v[184:185], v11 offset:6144
    ds_read_b64_tr_b16 v[186:187], v11 offset:7168
    s_waitcnt vmcnt(15) lgkmcnt(10)
    v_mfma_f32_32x32x16_bf16 v[48:63], v[208:211], v[120:123], v[48:63]
    ds_read_b64_tr_b16 v[188:189], v12 offset:6144
    ds_read_b64_tr_b16 v[190:191], v12 offset:7168
    v_mfma_f32_32x32x16_bf16 v[224:239], v[212:215], v[120:123], v[224:239]
    ds_read_b64_tr_b16 v[192:193], v11 offset:8192
    ds_read_b64_tr_b16 v[194:195], v11 offset:9216
    s_waitcnt vmcnt(14) lgkmcnt(10)
    v_mfma_f32_32x32x16_bf16 v[48:63], v[216:219], v[124:127], v[48:63]
    ds_read_b64_tr_b16 v[196:197], v12 offset:8192
    ds_read_b64_tr_b16 v[198:199], v12 offset:9216
    v_mfma_f32_32x32x16_bf16 v[224:239], v[220:223], v[124:127], v[224:239]
    ds_read_b64_tr_b16 v[200:201], v11 offset:10240
    ds_read_b64_tr_b16 v[202:203], v11 offset:11264
    s_add_u32 s84, s75, 1
    s_waitcnt vmcnt(1)
    s_mov_b32 s97, 0x9c40
Lrl_80:
    v_subrev_u32 v23, s84, v23
    v_cmp_le_u32 vcc, 4, v23
    s_cbranch_vccz Lrk_79
    s_sub_u32 s97, s97, 1
    s_cmp_eq_u32 s97, 0
    s_cbranch_scc1 Lrk_79
    buffer_load_dword v23, v22, s[60:63], 0 offen offset:64 sc1
    s_waitcnt vmcnt(0)
    s_branch Lrl_80
Lrk_79:
    s_waitcnt lgkmcnt(10)
    v_mfma_f32_32x32x16_bf16 v[48:63], v[176:179], v[128:131], v[48:63]
    v_mov_b64 v[64:65], v[36:37]
    v_mov_b64 v[66:67], v[38:39]
    ds_read_b64_tr_b16 v[204:205], v12 offset:10240
    ds_read_b64_tr_b16 v[206:207], v12 offset:11264
    v_mfma_f32_32x32x16_bf16 v[224:239], v[180:183], v[128:131], v[224:239]
    v_mov_b64 v[68:69], v[40:41]
    v_mov_b64 v[70:71], v[42:43]
    ds_read_b64_tr_b16 v[208:209], v11 offset:12288
    ds_read_b64_tr_b16 v[210:211], v11 offset:13312
    s_waitcnt lgkmcnt(10)
    v_mfma_f32_32x32x16_bf16 v[48:63], v[184:187], v[132:135], v[48:63]
    buffer_load_dwordx4 v[72:75], v10, s[60:63], s19 offen sc1
    ds_read_b64_tr_b16 v[212:213], v12 offset:12288
    ds_read_b64_tr_b16 v[214:215], v12 offset:13312
    v_mfma_f32_32x32x16_bf16 v[224:239], v[188:191], v[132:135], v[224:239]
    buffer_load_dwordx4 v[76:79], v10, s[60:63], s19 offen offset:512 sc1
    ds_read_b64_tr_b16 v[216:217], v11 offset:14336
    ds_read_b64_tr_b16 v[218:219], v11 offset:15360
    s_waitcnt lgkmcnt(10)
    v_mfma_f32_32x32x16_bf16 v[48:63], v[192:195], v[136:139], v[48:63]
    buffer_load_dwordx4 v[80:83], v10, s[60:63], s20 offen sc1
    ds_read_b64_tr_b16 v[220:221], v12 offset:14336
    ds_read_b64_tr_b16 v[222:223], v12 offset:15360
    v_mfma_f32_32x32x16_bf16 v[224:239], v[196:199], v[136:139], v[224:239]
    buffer_load_dwordx4 v[84:87], v10, s[60:63], s20 offen offset:512 sc1
    ds_read_b64_tr_b16 v[176:177], v11 offset:16384
    ds_read_b64_tr_b16 v[178:179], v11 offset:17408
    s_waitcnt lgkmcnt(10)
    v_mfma_f32_32x32x16_bf16 v[48:63], v[200:203], v[140:143], v[48:63]
    buffer_load_dwordx4 v[88:91], v10, s[60:63], s21 offen sc1
    ds_read_b64_tr_b16 v[180:181], v12 offset:16384
    ds_read_b64_tr_b16 v[182:183], v12 offset:17408
    v_mfma_f32_32x32x16_bf16 v[224:239], v[204:207], v[140:143], v[224:239]
    ds_read_b64_tr_b16 v[184:185], v11 offset:18432
    ds_read_b64_tr_b16 v[186:187], v11 offset:19456
    s_waitcnt lgkmcnt(10)
    v_mfma_f32_32x32x16_bf16 v[48:63], v[208:211], v[144:147], v[48:63]
    buffer_load_dwordx4 v[92:95], v10, s[60:63], s21 offen offset:512 sc1
    ds_read_b64_tr_b16 v[188:189], v12 offset:18432
    ds_read_b64_tr_b16 v[190:191], v12 offset:19456
    v_mfma_f32_32x32x16_bf16 v[224:239], v[212:215], v[144:147], v[224:239]
    ds_read_b64_tr_b16 v[192:193], v11 offset:20480
    ds_read_b64_tr_b16 v[194:195], v11 offset:21504
    s_waitcnt lgkmcnt(10)
    v_mfma_f32_32x32x16_bf16 v[48:63], v[216:219], v[148:151], v[48:63]
    buffer_load_dwordx4 v[96:99], v10, s[60:63], s22 offen sc1
    ds_read_b64_tr_b16 v[196:197], v12 offset:20480
    ds_read_b64_tr_b16 v[198:199], v12 offset:21504
    v_mfma_f32_32x32x16_bf16 v[224:239], v[220:223], v[148:151], v[224:239]
    ds_read_b64_tr_b16 v[200:201], v11 offset:22528
    ds_read_b64_tr_b16 v[202:203], v11 offset:23552
    s_waitcnt lgkmcnt(10)
    v_mfma_f32_32x32x16_bf16 v[48:63], v[176:179], v[152:155], v[48:63]
    buffer_load_dwordx4 v[100:103], v10, s[60:63], s22 offen offset:512 sc1
    ds_read_b64_tr_b16 v[204:205], v12 offset:22528
    ds_read_b64_tr_b16 v[206:207], v12 offset:23552
    v_mfma_f32_32x32x16_bf16 v[224:239], v[180:183], v[152:155], v[224:239]
    ds_read_b64_tr_b16 v[208:209], v11 offset:24576
    ds_read_b64_tr_b16 v[210:211], v11 offset:25600
    ds_read_b32 v18, v16 offset:104
    s_waitcnt lgkmcnt(11)
    v_mfma_f32_32x32x16_bf16 v[48:63], v[184:187], v[156:159], v[48:63]
    buffer_load_dwordx4 v[104:107], v10, s[60:63], s23 offen sc1
    ds_read_b64_tr_b16 v[212:213], v12 offset:24576
    ds_read_b64_tr_b16 v[214:215], v12 offset:25600
    v_mfma_f32_32x32x16_bf16 v[224:239], v[188:191], v[156:159], v[224:239]
    ds_read_b64_tr_b16 v[216:217], v11 offset:26624
    ds_read_b64_tr_b16 v[218:219], v11 offset:27648
    s_waitcnt lgkmcnt(11)
    v_mfma_f32_32x32x16_bf16 v[48:63], v[192:195], v[160:163], v[48:63]
    buffer_load_dwordx4 v[108:111], v10, s[60:63], s23 offen offset:512 sc1
    ds_read_b64_tr_b16 v[220:221], v12 offset:26624
    ds_read_b64_tr_b16 v[222:223], v12 offset:27648
    s_waitcnt lgkmcnt(6)
    v_cmp_gt_u32 vcc, 4, v18
    s_cbranch_vccz Lvk_81
    s_mov_b32 s97, 0x61a80
Lvl_82:
    ds_read_b32 v18, v16 offset:104
    s_sub_u32 s97, s97, 1
    s_waitcnt lgkmcnt(0)
    v_cmp_gt_u32 vcc, 4, v18
    s_cbranch_vccz Lvk_81
    s_cmp_lg_u32 s97, 0
    s_cbranch_scc1 Lvl_82
Lvk_81:
    v_mfma_f32_32x32x16_bf16 v[224:239], v[196:199], v[160:163], v[224:239]
    v_add_u32 v11, 0x7000, v7
    ds_read_b64_tr_b16 v[176:177], v11 offset:0
    ds_read_b64_tr_b16 v[178:179], v11 offset:1024
    v_mfma_f32_32x32x16_bf16 v[48:63], v[200:203], v[164:167], v[48:63]
    buffer_load_dwordx4 v[112:115], v10, s[60:63], s3 offen sc1
    v_add_u32 v12, 0x7000, v8
    ds_read_b64_tr_b16 v[180:181], v12 offset:0
    ds_read_b64_tr_b16 v[182:183], v12 offset:1024
    v_mfma_f32_32x32x16_bf16 v[224:239], v[204:207], v[164:167], v[224:239]
    ds_read_b64_tr_b16 v[184:185], v11 offset:2048
    ds_read_b64_tr_b16 v[186:187], v11 offset:3072
    s_waitcnt lgkmcnt(10)
    v_mfma_f32_32x32x16_bf16 v[48:63], v[208:211], v[168:171], v[48:63]
    buffer_load_dwordx4 v[116:119], v10, s[60:63], s3 offen offset:512 sc1
    ds_read_b64_tr_b16 v[188:189], v12 offset:2048
    ds_read_b64_tr_b16 v[190:191], v12 offset:3072
    v_mfma_f32_32x32x16_bf16 v[224:239], v[212:215], v[168:171], v[224:239]
    ds_read_b64_tr_b16 v[192:193], v11 offset:4096
    ds_read_b64_tr_b16 v[194:195], v11 offset:5120
    s_waitcnt vmcnt(12) lgkmcnt(10)
    v_mfma_f32_32x32x16_bf16 v[48:63], v[216:219], v[172:175], v[48:63]
    ds_read_b64_tr_b16 v[196:197], v12 offset:4096
    ds_read_b64_tr_b16 v[198:199], v12 offset:5120
    v_mfma_f32_32x32x16_bf16 v[224:239], v[220:223], v[172:175], v[224:239]
    ds_read_b64_tr_b16 v[200:201], v11 offset:6144
    ds_read_b64_tr_b16 v[202:203], v11 offset:7168
    buffer_load_dword v23, v22, s[60:63], 0 offen sc1
    s_waitcnt lgkmcnt(10)
    v_mfma_f32_32x32x16_bf16 v[48:63], v[176:179], v[64:67], v[48:63]
    ds_read_b64_tr_b16 v[204:205], v12 offset:6144
    ds_read_b64_tr_b16 v[206:207], v12 offset:7168
    v_mfma_f32_32x32x16_bf16 v[224:239], v[180:183], v[64:67], v[224:239]
    ds_read_b64_tr_b16 v[208:209], v11 offset:8192
    ds_read_b64_tr_b16 v[210:211], v11 offset:9216
    s_waitcnt lgkmcnt(10)
    v_mfma_f32_32x32x16_bf16 v[48:63], v[184:187], v[68:71], v[48:63]
    ds_read_b64_tr_b16 v[212:213], v12 offset:8192
    ds_read_b64_tr_b16 v[214:215], v12 offset:9216
    v_mfma_f32_32x32x16_bf16 v[224:239], v[188:191], v[68:71], v[224:239]
    ds_read_b64_tr_b16 v[216:217], v11 offset:10240
    ds_read_b64_tr_b16 v[218:219], v11 offset:11264
    s_waitcnt vmcnt(12) lgkmcnt(10)
    v_mfma_f32_32x32x16_bf16 v[48:63], v[192:195], v[72:75], v[48:63]
    ds_read_b64_tr_b16 v[220:221], v12 offset:10240
    ds_read_b64_tr_b16 v[222:223], v12 offset:11264
    v_mfma_f32_32x32x16_bf16 v[224:239], v[196:199], v[72:75], v[224:239]
    ds_read_b64_tr_b16 v[176:177], v11 offset:12288
    ds_read_b64_tr_b16 v[178:179], v11 offset:13312
    s_waitcnt vmcnt(11) lgkmcnt(10)
    v_mfma_f32_32x32x16_bf16 v[48:63], v[200:203], v[76:79], v[48:63]
    ds_read_b64_tr_b16 v[180:181], v12 offset:12288
    ds_read_b64_tr_b16 v[182:183], v12 offset:13312
    v_mfma_f32_32x32x16_bf16 v[224:239], v[204:207], v[76:79], v[224:239]
    ds_read_b64_tr_b16 v[184:185], v11 offset:14336
    ds_read_b64_tr_b16 v[186:187], v11 offset:15360
    s_waitcnt vmcnt(1)
    s_mov_b64 exec, 1
    ds_add_u32 v19, v17 offset:128
    s_mov_b64 exec, -1
    s_add_u32 s84, s75, 1
    s_waitcnt vmcnt(0)
    s_mov_b32 s97, 0x9c40
Lrl_84:
    v_subrev_u32 v23, s84, v23
    v_cmp_le_u32 vcc, 4, v23
    s_cbranch_vccz Lrk_83
    s_sub_u32 s97, s97, 1
    s_cmp_eq_u32 s97, 0
    s_cbranch_scc1 Lrk_83
    buffer_load_dword v23, v22, s[60:63], 0 offen sc1
    s_waitcnt vmcnt(0)
    s_branch Lrl_84
Lrk_83:
    s_waitcnt lgkmcnt(11)
    v_mfma_f32_32x32x16_bf16 v[48:63], v[208:211], v[80:83], v[48:63]
    buffer_load_dwordx4 v[120:123], v13, s[60:63], s18 offen sc1
    ds_read_b64_tr_b16 v[188:189], v12 offset:14336
    ds_read_b64_tr_b16 v[190:191], v12 offset:15360
    v_mfma_f32_32x32x16_bf16 v[224:239], v[212:215], v[80:83], v[224:239]
    buffer_load_dwordx4 v[124:127], v13, s[60:63], s18 offen offset:512 sc1
    ds_read_b64_tr_b16 v[192:193], v11 offset:16384
    ds_read_b64_tr_b16 v[194:195], v11 offset:17408
    s_waitcnt lgkmcnt(11)
    v_mfma_f32_32x32x16_bf16 v[48:63], v[216:219], v[84:87], v[48:63]
    buffer_load_dwordx4 v[128:131], v13, s[60:63], s19 offen sc1
    ds_read_b64_tr_b16 v[196:197], v12 offset:16384
    ds_read_b64_tr_b16 v[198:199], v12 offset:17408
    v_mfma_f32_32x32x16_bf16 v[224:239], v[220:223], v[84:87], v[224:239]
    buffer_load_dwordx4 v[132:135], v13, s[60:63], s19 offen offset:512 sc1
    ds_read_b64_tr_b16 v[200:201], v11 offset:18432
    ds_read_b64_tr_b16 v[202:203], v11 offset:19456
    s_waitcnt lgkmcnt(11)
    v_mfma_f32_32x32x16_bf16 v[48:63], v[176:179], v[88:91], v[48:63]
    buffer_load_dwordx4 v[136:139], v13, s[60:63], s20 offen sc1
    ds_read_b64_tr_b16 v[204:205], v12 offset:18432
    ds_read_b64_tr_b16 v[206:207], v12 offset:19456
    v_mfma_f32_32x32x16_bf16 v[224:239], v[180:183], v[88:91], v[224:239]
    buffer_load_dwordx4 v[140:143], v13, s[60:63], s20 offen offset:512 sc1
    ds_read_b64_tr_b16 v[208:209], v11 offset:20480
    ds_read_b64_tr_b16 v[210:211], v11 offset:21504
    s_waitcnt lgkmcnt(10)
    v_mfma_f32_32x32x16_bf16 v[48:63], v[184:187], v[92:95], v[48:63]
    buffer_load_dwordx4 v[144:147], v13, s[60:63], s21 offen sc1
    ds_read_b64_tr_b16 v[212:213], v12 offset:20480
    ds_read_b64_tr_b16 v[214:215], v12 offset:21504
    v_mfma_f32_32x32x16_bf16 v[224:239], v[188:191], v[92:95], v[224:239]
    buffer_load_dwordx4 v[148:151], v13, s[60:63], s21 offen offset:512 sc1
    ds_read_b64_tr_b16 v[216:217], v11 offset:22528
    ds_read_b64_tr_b16 v[218:219], v11 offset:23552
    s_waitcnt lgkmcnt(10)
    v_mfma_f32_32x32x16_bf16 v[48:63], v[192:195], v[96:99], v[48:63]
    buffer_load_dwordx4 v[152:155], v13, s[60:63], s22 offen sc1
    ds_read_b64_tr_b16 v[220:221], v12 offset:22528
    ds_read_b64_tr_b16 v[222:223], v12 offset:23552
    v_mfma_f32_32x32x16_bf16 v[224:239], v[196:199], v[96:99], v[224:239]
    buffer_load_dwordx4 v[156:159], v13, s[60:63], s22 offen offset:512 sc1
    ds_read_b64_tr_b16 v[176:177], v11 offset:24576
    ds_read_b64_tr_b16 v[178:179], v11 offset:25600
    s_waitcnt lgkmcnt(10)
    v_mfma_f32_32x32x16_bf16 v[48:63], v[200:203], v[100:103], v[48:63]
    buffer_load_dwordx4 v[160:163], v13, s[60:63], s23 offen sc1
    ds_read_b64_tr_b16 v[180:181], v12 offset:24576
    ds_read_b64_tr_b16 v[182:183], v12 offset:25600
    v_mfma_f32_32x32x16_bf16 v[224:239], v[204:207], v[100:103], v[224:239]
    ds_read_b64_tr_b16 v[184:185], v11 offset:26624
    ds_read_b64_tr_b16 v[186:187], v11 offset:27648
    s_waitcnt lgkmcnt(10)
    v_mfma_f32_32x32x16_bf16 v[48:63], v[208:211], v[104:107], v[48:63]
    buffer_load_dwordx4 v[164:167], v13, s[60:63], s23 offen offset:512 sc1
    ds_read_b64_tr_b16 v[188:189], v12 offset:26624
    ds_read_b64_tr_b16 v[190:191], v12 offset:27648
    v_mfma_f32_32x32x16_bf16 v[224:239], v[212:215], v[104:107], v[224:239]
    v_add_u32 v11, 0x15000, v7
    ds_read_b64_tr_b16 v[192:193], v11 offset:0
    ds_read_b64_tr_b16 v[194:195], v11 offset:1024
    s_waitcnt lgkmcnt(10)
    v_mfma_f32_32x32x16_bf16 v[48:63], v[216:219], v[108:111], v[48:63]
    buffer_load_dwordx4 v[168:171], v13, s[60:63], s3 offen sc1
    v_add_u32 v12, 0x15000, v8
    ds_read_b64_tr_b16 v[196:197], v12 offset:0
    ds_read_b64_tr_b16 v[198:199], v12 offset:1024
    v_mfma_f32_32x32x16_bf16 v[224:239], v[220:223], v[108:111], v[224:239]
    ds_read_b64_tr_b16 v[200:201], v11 offset:2048
    ds_read_b64_tr_b16 v[202:203], v11 offset:3072
    s_waitcnt lgkmcnt(10)
    v_mfma_f32_32x32x16_bf16 v[48:63], v[176:179], v[112:115], v[48:63]
    buffer_load_dwordx4 v[172:175], v13, s[60:63], s3 offen offset:512 sc1
    ds_read_b64_tr_b16 v[204:205], v12 offset:2048
    ds_read_b64_tr_b16 v[206:207], v12 offset:3072
    v_mfma_f32_32x32x16_bf16 v[224:239], v[180:183], v[112:115], v[224:239]
    ds_read_b64_tr_b16 v[208:209], v11 offset:4096
    ds_read_b64_tr_b16 v[210:211], v11 offset:5120
    s_waitcnt lgkmcnt(10)
    v_mfma_f32_32x32x16_bf16 v[48:63], v[184:187], v[116:119], v[48:63]
    ds_read_b64_tr_b16 v[212:213], v12 offset:4096
    ds_read_b64_tr_b16 v[214:215], v12 offset:5120
    v_mfma_f32_32x32x16_bf16 v[224:239], v[188:191], v[116:119], v[224:239]
    ds_read_b64_tr_b16 v[216:217], v11 offset:6144
    ds_read_b64_tr_b16 v[218:219], v11 offset:7168
    s_waitcnt vmcnt(13) lgkmcnt(10)
    v_mfma_f32_32x32x16_bf16 v[48:63], v[192:195], v[120:123], v[48:63]
    ds_read_b64_tr_b16 v[220:221], v12 offset:6144
    ds_read_b64_tr_b16 v[222:223], v12 offset:7168
    v_mfma_f32_32x32x16_bf16 v[224:239], v[196:199], v[120:123], v[224:239]
    ds_read_b64_tr_b16 v[176:177], v11 offset:8192
    ds_read_b64_tr_b16 v[178:179], v11 offset:9216
    v_mov_b32 v65, v15
    v_mov_b32 v67, v15
    v_mov_b32 v69, v15
    s_waitcnt vmcnt(12) lgkmcnt(10)
    v_mfma_f32_32x32x16_bf16 v[48:63], v[200:203], v[124:127], v[48:63]
    ds_read_b64_tr_b16 v[180:181], v12 offset:8192
    ds_read_b64_tr_b16 v[182:183], v12 offset:9216
    v_mov_b32 v71, v15
    v_mov_b32 v73, v15
    v_mov_b32 v75, v15
    v_mfma_f32_32x32x16_bf16 v[224:239], v[204:207], v[124:127], v[224:239]
    ds_read_b64_tr_b16 v[184:185], v11 offset:10240
    ds_read_b64_tr_b16 v[186:187], v11 offset:11264
    v_mov_b32 v77, v15
    v_mov_b32 v79, v15
    v_mov_b32 v81, v15
    s_waitcnt vmcnt(11) lgkmcnt(10)
    v_mfma_f32_32x32x16_bf16 v[48:63], v[208:211], v[128:131], v[48:63]
    ds_read_b64_tr_b16 v[188:189], v12 offset:10240
    ds_read_b64_tr_b16 v[190:191], v12 offset:11264
    v_mov_b32 v83, v15
    v_mov_b32 v85, v15
    v_mov_b32 v87, v15
    v_mfma_f32_32x32x16_bf16 v[224:239], v[212:215], v[128:131], v[224:239]
    ds_read_b64_tr_b16 v[192:193], v11 offset:12288
    ds_read_b64_tr_b16 v[194:195], v11 offset:13312
    v_mov_b32 v89, v15
    v_mov_b32 v91, v15
    v_mov_b32 v93, v15
    s_waitcnt vmcnt(10) lgkmcnt(10)
    v_mfma_f32_32x32x16_bf16 v[48:63], v[216:219], v[132:135], v[48:63]
    ds_read_b64_tr_b16 v[196:197], v12 offset:12288
    ds_read_b64_tr_b16 v[198:199], v12 offset:13312
    v_mov_b32 v95, v15
    v_lshrrev_b32 v248, 1, v1
    v_lshrrev_b32 v249, 5, v0
    v_mfma_f32_32x32x16_bf16 v[224:239], v[220:223], v[132:135], v[224:239]
    ds_read_b64_tr_b16 v[200:201], v11 offset:14336
    ds_read_b64_tr_b16 v[202:203], v11 offset:15360
    v_xor_b32 v248, v248, v249
    v_lshlrev_b32 v248, 4, v248
    v_and_b32 v249, 31, v0
    s_waitcnt vmcnt(9) lgkmcnt(10)
    v_mfma_f32_32x32x16_bf16 v[48:63], v[176:179], v[136:139], v[48:63]
    ds_read_b64_tr_b16 v[204:205], v12 offset:14336
    ds_read_b64_tr_b16 v[206:207], v12 offset:15360
    v_lshl_add_u32 v248, v249, 7, v248
    s_lshl_b32 s88, s73, 12
    s_add_u32 s88, s88, 0x1c000
    v_mfma_f32_32x32x16_bf16 v[224:239], v[180:183], v[136:139], v[224:239]
    ds_read_b64_tr_b16 v[208:209], v11 offset:16384
    ds_read_b64_tr_b16 v[210:211], v11 offset:17408
    v_add_u32 v96, s88, v248
    v_xor_b32 v97, 0x20, v96
    v_xor_b32 v98, 0x40, v96
    s_waitcnt vmcnt(8) lgkmcnt(10)
    v_mfma_f32_32x32x16_bf16 v[48:63], v[184:187], v[140:143], v[48:63]
    ds_read_b64_tr_b16 v[212:213], v12 offset:16384
    ds_read_b64_tr_b16 v[214:215], v12 offset:17408
    v_xor_b32 v99, 0x60, v96
    v_lshrrev_b32 v104, 3, v0
    v_and_b32 v249, 7, v0
    v_mfma_f32_32x32x16_bf16 v[224:239], v[188:191], v[140:143], v[224:239]
    ds_read_b64_tr_b16 v[216:217], v11 offset:18432
    ds_read_b64_tr_b16 v[218:219], v11 offset:19456
    v_xor_b32 v249, v249, v2
    v_mul_u32_u24 v104, 0x380, v104
    v_lshl_add_u32 v104, v249, 4, v104
    s_waitcnt vmcnt(7) lgkmcnt(10)
    v_mfma_f32_32x32x16_bf16 v[48:63], v[192:195], v[144:147], v[48:63]
    ds_read_b64_tr_b16 v[220:221], v12 offset:18432
    ds_read_b64_tr_b16 v[222:223], v12 offset:19456
    v_xor_b32 v249, 4, v249
    v_lshrrev_b32 v105, 3, v0
    v_mul_u32_u24 v105, 0x380, v105
    v_mfma_f32_32x32x16_bf16 v[224:239], v[196:199], v[144:147], v[224:239]
    ds_read_b64_tr_b16 v[176:177], v11 offset:20480
    ds_read_b64_tr_b16 v[178:179], v11 offset:21504
    v_lshl_add_u32 v105, v249, 4, v105
    v_add_u32 v106, 0x38000, v3
    s_lshl_b32 s88, s68, 4
    s_waitcnt vmcnt(6) lgkmcnt(10)
    v_mfma_f32_32x32x16_bf16 v[48:63], v[200:203], v[148:151], v[48:63]
    ds_read_b64_tr_b16 v[180:181], v12 offset:20480
    ds_read_b64_tr_b16 v[182:183], v12 offset:21504
    s_add_u32 s88, s88, s0
    s_mul_i32 s85, s88, 0x3800
    s_add_u32 s85, s85, s78
    v_mfma_f32_32x32x16_bf16 v[224:239], v[204:207], v[148:151], v[224:239]
    ds_read_b64_tr_b16 v[184:185], v11 offset:22528
    ds_read_b64_tr_b16 v[186:187], v11 offset:23552
    s_add_u32 s4, s86, 0x0
    s_add_u32 s8, s101, 0x0
    s_add_u32 s12, s85, 0x0
    s_waitcnt vmcnt(5) lgkmcnt(10)
    v_mfma_f32_32x32x16_bf16 v[48:63], v[208:211], v[152:155], v[48:63]
    ds_read_b64_tr_b16 v[188:189], v12 offset:22528
    ds_read_b64_tr_b16 v[190:191], v12 offset:23552
    s_add_u32 s5, s86, 0x3800
    s_add_u32 s9, s101, 0x3800
    s_add_u32 s13, s85, 0x1c00
    v_mfma_f32_32x32x16_bf16 v[224:239], v[212:215], v[152:155], v[224:239]
    ds_read_b64_tr_b16 v[192:193], v11 offset:24576
    ds_read_b64_tr_b16 v[194:195], v11 offset:25600
    s_add_u32 s6, s86, 0x7000
    s_add_u32 s10, s101, 0x7000
    s_add_u32 s14, s85, 0x3800
    s_waitcnt vmcnt(4) lgkmcnt(10)
    v_mfma_f32_32x32x16_bf16 v[48:63], v[216:219], v[156:159], v[48:63]
    ds_read_b64_tr_b16 v[196:197], v12 offset:24576
    ds_read_b64_tr_b16 v[198:199], v12 offset:25600
    s_add_u32 s7, s86, 0xa800
    s_add_u32 s11, s101, 0xa800
    s_add_u32 s15, s85, 0x5400
    v_mfma_f32_32x32x16_bf16 v[224:239], v[220:223], v[156:159], v[224:239]
    ds_read_b64_tr_b16 v[200:201], v11 offset:26624
    ds_read_b64_tr_b16 v[202:203], v11 offset:27648
    s_waitcnt vmcnt(3) lgkmcnt(10)
    v_mfma_f32_32x32x16_bf16 v[48:63], v[176:179], v[160:163], v[48:63]
    ds_read_b64_tr_b16 v[204:205], v12 offset:26624
    ds_read_b64_tr_b16 v[206:207], v12 offset:27648
    ds_read_b32 v18, v19 offset:144
    v_mfma_f32_32x32x16_bf16 v[224:239], v[180:183], v[160:163], v[224:239]
    s_waitcnt vmcnt(2) lgkmcnt(9)
    v_mfma_f32_32x32x16_bf16 v[48:63], v[184:187], v[164:167], v[48:63]
    v_mfma_f32_32x32x16_bf16 v[224:239], v[188:191], v[164:167], v[224:239]
    s_waitcnt lgkmcnt(0)
    v_cmp_gt_u32 vcc, 3, v18
    s_cbranch_vccz Lvk_85
    s_mov_b32 s97, 0x61a80
Lvl_86:
    ds_read_b32 v18, v19 offset:144
    s_sub_u32 s97, s97, 1
    s_waitcnt lgkmcnt(0)
    v_cmp_gt_u32 vcc, 3, v18
    s_cbranch_vccz Lvk_85
    s_cmp_lg_u32 s97, 0
    s_cbranch_scc1 Lvl_86
Lvk_85:
    s_waitcnt vmcnt(1)
    v_mfma_f32_32x32x16_bf16 v[48:63], v[192:195], v[168:171], v[48:63]
    v_mfma_f32_32x32x16_bf16 v[224:239], v[196:199], v[168:171], v[224:239]
    s_waitcnt vmcnt(0)
    v_mfma_f32_32x32x16_bf16 v[48:63], v[200:203], v[172:175], v[48:63]
    v_mfma_f32_32x32x16_bf16 v[224:239], v[204:207], v[172:175], v[224:239]
    s_cmp_eq_u32 s90, 0
    s_cbranch_scc1 Lown_87
    s_cmp_eq_u32 s77, 1
    s_cbranch_scc0 Lsl_89
    s_nop 6
    v_cvt_pk_bf16_f32 v64, v48, v49
    v_cvt_pk_bf16_f32 v66, v50, v51
    buffer_store_dwordx4 v[64:67], v3, s[60:63], s4 offen
    v_cvt_pk_bf16_f32 v68, v52, v53
    v_cvt_pk_bf16_f32 v70, v54, v55
    buffer_store_dwordx4 v[68:71], v106, s[60:63], s4 offen
    v_cvt_pk_bf16_f32 v72, v56, v57
    v_cvt_pk_bf16_f32 v74, v58, v59
    buffer_store_dwordx4 v[72:75], v3, s[60:63], s5 offen
    v_cvt_pk_bf16_f32 v76, v60, v61
    v_cvt_pk_bf16_f32 v78, v62, v63
    buffer_store_dwordx4 v[76:79], v106, s[60:63], s5 offen
    v_cvt_pk_bf16_f32 v80, v224, v225
    v_cvt_pk_bf16_f32 v82, v226, v227
    buffer_store_dwordx4 v[80:83], v3, s[60:63], s6 offen
    v_cvt_pk_bf16_f32 v84, v228, v229
    v_cvt_pk_bf16_f32 v86, v230, v231
    buffer_store_dwordx4 v[84:87], v106, s[60:63], s6 offen
    v_cvt_pk_bf16_f32 v88, v232, v233
    v_cvt_pk_bf16_f32 v90, v234, v235
    buffer_store_dwordx4 v[88:91], v3, s[60:63], s7 offen
    v_cvt_pk_bf16_f32 v92, v236, v237
    v_cvt_pk_bf16_f32 v94, v238, v239
    buffer_store_dwordx4 v[92:95], v106, s[60:63], s7 offen
    s_branch Lse_90
Lsl_89:
    s_nop 6
    v_cvt_pk_bf16_f32 v64, v48, v49
    v_cvt_pk_bf16_f32 v66, v50, v51
    buffer_store_dwordx4 v[64:67], v3, s[60:63], s4 offen sc1
    v_cvt_pk_bf16_f32 v68, v52, v53
    v_cvt_pk_bf16_f32 v70, v54, v55
    buffer_store_dwordx4 v[68:71], v106, s[60:63], s4 offen sc1
    v_cvt_pk_bf16_f32 v72, v56, v57
    v_cvt_pk_bf16_f32 v74, v58, v59
    buffer_store_dwordx4 v[72:75], v3, s[60:63], s5 offen sc1
    v_cvt_pk_bf16_f32 v76, v60, v61
    v_cvt_pk_bf16_f32 v78, v62, v63
    buffer_store_dwordx4 v[76:79], v106, s[60:63], s5 offen sc1
    v_cvt_pk_bf16_f32 v80, v224, v225
    v_cvt_pk_bf16_f32 v82, v226, v227
    buffer_store_dwordx4 v[80:83], v3, s[60:63], s6 offen sc1
    v_cvt_pk_bf16_f32 v84, v228, v229
    v_cvt_pk_bf16_f32 v86, v230, v231
    buffer_store_dwordx4 v[84:87], v106, s[60:63], s6 offen sc1
    v_cvt_pk_bf16_f32 v88, v232, v233
    v_cvt_pk_bf16_f32 v90, v234, v235
    buffer_store_dwordx4 v[88:91], v3, s[60:63], s7 offen sc1
    v_cvt_pk_bf16_f32 v92, v236, v237
    v_cvt_pk_bf16_f32 v94, v238, v239
    buffer_store_dwordx4 v[92:95], v106, s[60:63], s7 offen sc1
Lse_90:
    s_branch Lend_88
Lown_87:
    s_mov_b32 s97, 0x9c40
    s_mov_b64 exec, 1
Lpoll_91:
    buffer_load_dword v248, off, s[60:63], s8 offset:4 sc1
    s_sub_u32 s97, s97, 1
    s_waitcnt vmcnt(0)
    v_cmp_ne_u32 vcc, s75, v248
    s_cbranch_vccz Lpd_92
    s_cmp_lg_u32 s97, 0
    s_cbranch_scc1 Lpoll_91
Lpd_92:
    s_mov_b64 exec, -1
Lpoll_93:
    buffer_load_dwordx4 v[120:123], v3, s[60:63], s8 offen sc1
    buffer_load_dwordx4 v[124:127], v106, s[60:63], s8 offen sc1
    buffer_load_dwordx4 v[128:131], v3, s[60:63], s9 offen sc1
    buffer_load_dwordx4 v[132:135], v106, s[60:63], s9 offen sc1
    buffer_load_dwordx4 v[136:139], v3, s[60:63], s10 offen sc1
    buffer_load_dwordx4 v[140:143], v106, s[60:63], s10 offen sc1
    buffer_load_dwordx4 v[144:147], v3, s[60:63], s11 offen sc1
    buffer_load_dwordx4 v[148:151], v106, s[60:63], s11 offen sc1
    v_mov_b32 v248, v15
    v_mov_b32 v249, v15
    s_sub_u32 s97, s97, 1
    s_waitcnt vmcnt(7)
    v_min3_u32 v248, v248, v121, v123
    v_max3_u32 v249, v249, v121, v123
    v_and_b32 v121, 0xffff0000, v120
    v_lshlrev_b32 v120, 16, v120
    v_and_b32 v123, 0xffff0000, v122
    v_lshlrev_b32 v122, 16, v122
    s_waitcnt vmcnt(6)
    v_min3_u32 v248, v248, v125, v127
    v_max3_u32 v249, v249, v125, v127
    v_and_b32 v125, 0xffff0000, v124
    v_lshlrev_b32 v124, 16, v124
    v_and_b32 v127, 0xffff0000, v126
    v_lshlrev_b32 v126, 16, v126
    s_waitcnt vmcnt(5)
    v_min3_u32 v248, v248, v129, v131
    v_max3_u32 v249, v249, v129, v131
    v_and_b32 v129, 0xffff0000, v128
    v_lshlrev_b32 v128, 16, v128
    v_and_b32 v131, 0xffff0000, v130
    v_lshlrev_b32 v130, 16, v130
    s_waitcnt vmcnt(4)
    v_min3_u32 v248, v248, v133, v135
    v_max3_u32 v249, v249, v133, v135
    v_and_b32 v133, 0xffff0000, v132
    v_lshlrev_b32 v132, 16, v132
    v_and_b32 v135, 0xffff0000, v134
    v_lshlrev_b32 v134, 16, v134
    s_waitcnt vmcnt(3)
    v_min3_u32 v248, v248, v137, v139
    v_max3_u32 v249, v249, v137, v139
    v_and_b32 v137, 0xffff0000, v136
    v_lshlrev_b32 v136, 16, v136
    v_and_b32 v139, 0xffff0000, v138
    v_lshlrev_b32 v138, 16, v138
    s_waitcnt vmcnt(2)
    v_min3_u32 v248, v248, v141, v143
    v_max3_u32 v249, v249, v141, v143
    v_and_b32 v141, 0xffff0000, v140
    v_lshlrev_b32 v140, 16, v140
    v_and_b32 v143, 0xffff0000, v142
    v_lshlrev_b32 v142, 16, v142
    s_waitcnt vmcnt(1)
    v_min3_u32 v248, v248, v145, v147
    v_max3_u32 v249, v249, v145, v147
    v_and_b32 v145, 0xffff0000, v144
    v_lshlrev_b32 v144, 16, v144
    v_and_b32 v147, 0xffff0000, v146
    v_lshlrev_b32 v146, 16, v146
    s_waitcnt vmcnt(0)
    v_min3_u32 v248, v248, v149, v151
    v_max3_u32 v249, v249, v149, v151
    v_and_b32 v149, 0xffff0000, v148
    v_lshlrev_b32 v148, 16, v148
    v_and_b32 v151, 0xffff0000, v150
    v_lshlrev_b32 v150, 16, v150
    v_cmp_ne_u32 vcc, v248, v249
    s_cbranch_vccz Lpd_94
    s_cmp_gt_i32 s97, 0
    s_cbranch_scc1 Lpoll_93
Lpd_94:
    v_pk_add_f32 v[48:49], v[48:49], v[120:121]
    v_pk_add_f32 v[50:51], v[50:51], v[122:123]
    v_pk_add_f32 v[52:53], v[52:53], v[124:125]
    v_pk_add_f32 v[54:55], v[54:55], v[126:127]
    v_cvt_pk_bf16_f32 v64, v48, v49
    v_cvt_pk_bf16_f32 v65, v50, v51
    v_cvt_pk_bf16_f32 v66, v52, v53
    v_cvt_pk_bf16_f32 v67, v54, v55
    ds_write_b128 v96, v[64:67]
    v_pk_add_f32 v[56:57], v[56:57], v[128:129]
    v_pk_add_f32 v[58:59], v[58:59], v[130:131]
    v_pk_add_f32 v[60:61], v[60:61], v[132:133]
    v_pk_add_f32 v[62:63], v[62:63], v[134:135]
    v_cvt_pk_bf16_f32 v68, v56, v57
    v_cvt_pk_bf16_f32 v69, v58, v59
    v_cvt_pk_bf16_f32 v70, v60, v61
    v_cvt_pk_bf16_f32 v71, v62, v63
    ds_write_b128 v97, v[68:71]
    v_pk_add_f32 v[224:225], v[224:225], v[136:137]
    v_pk_add_f32 v[226:227], v[226:227], v[138:139]
    v_pk_add_f32 v[228:229], v[228:229], v[140:141]
    v_pk_add_f32 v[230:231], v[230:231], v[142:143]
    v_cvt_pk_bf16_f32 v72, v224, v225
    v_cvt_pk_bf16_f32 v73, v226, v227
    v_cvt_pk_bf16_f32 v74, v228, v229
    v_cvt_pk_bf16_f32 v75, v230, v231
    ds_write_b128 v98, v[72:75]
    v_pk_add_f32 v[232:233], v[232:233], v[144:145]
    v_pk_add_f32 v[234:235], v[234:235], v[146:147]
    v_pk_add_f32 v[236:237], v[236:237], v[148:149]
    v_pk_add_f32 v[238:239], v[238:239], v[150:151]
    v_cvt_pk_bf16_f32 v76, v232, v233
    v_cvt_pk_bf16_f32 v77, v234, v235
    v_cvt_pk_bf16_f32 v78, v236, v237
    v_cvt_pk_bf16_f32 v79, v238, v239
    ds_write_b128 v99, v[76:79]
    ds_read_b128 v[48:51], v245 offset:0
    ds_read_b128 v[52:55], v245 offset:1024
    ds_read_b128 v[56:59], v245 offset:2048
    ds_read_b128 v[60:63], v245 offset:3072
    s_waitcnt lgkmcnt(3)
    buffer_store_dwordx4 v[48:51], v104, s[32:35], s12 offen
    s_waitcnt lgkmcnt(2)
    buffer_store_dwordx4 v[52:55], v105, s[32:35], s13 offen
    s_waitcnt lgkmcnt(1)
    buffer_store_dwordx4 v[56:59], v104, s[32:35], s14 offen
    s_waitcnt lgkmcnt(0)
    buffer_store_dwordx4 v[60:63], v105, s[32:35], s15 offen
Lend_88:
    s_endpgm
Lx0_10:
    s_waitcnt lgkmcnt(0)
    v_readfirstlane_b32 s77, v31
    v_and_b32 v72, v28, v72
    v_and_b32 v73, v28, v73
    v_and_b32 v74, v29, v74
    v_and_b32 v75, v29, v75
    v_and_b32 v76, v28, v76
    v_and_b32 v77, v28, v77
    v_and_b32 v78, v29, v78
    v_and_b32 v79, v29, v79
    s_cmp_lg_u32 s96, 14
    s_cbranch_scc1 Lnx_95
    ds_read_b128 v[88:91], v32 offset:2048
    ds_read_b128 v[92:95], v32 offset:3072
    ds_read_b128 v[80:83], v32 offset:4096
    ds_read_b128 v[84:87], v32 offset:5120
    s_branch Lst_11
Lnx_95:
    s_cmp_lg_u32 s96, 12
    s_cbranch_scc1 Lnx_96
    ds_read_b128 v[80:83], v32 offset:4096
    ds_read_b128 v[84:87], v32 offset:5120
    ds_read_b128 v[88:91], v32 offset:6144
    ds_read_b128 v[92:95], v32 offset:7168
    s_branch Lst_12
Lnx_96:
    s_cmp_lg_u32 s96, 10
    s_cbranch_scc1 Lnx_97
    ds_read_b128 v[88:91], v32 offset:6144
    ds_read_b128 v[92:95], v32 offset:7168
    ds_read_b128 v[80:83], v32 offset:8192
    ds_read_b128 v[84:87], v32 offset:9216
    s_branch Lst_13
Lnx_97:
    s_cmp_lg_u32 s96, 8
    s_cbranch_scc1 Lnx_98
    ds_read_b128 v[80:83], v32 offset:8192
    ds_read_b128 v[84:87], v32 offset:9216
    ds_read_b128 v[88:91], v32 offset:10240
    ds_read_b128 v[92:95], v32 offset:11264
    s_branch Lst_14
Lnx_98:
    s_cmp_lg_u32 s96, 6
    s_cbranch_scc1 Lnx_99
    ds_read_b128 v[88:91], v32 offset:10240
    ds_read_b128 v[92:95], v32 offset:11264
    ds_read_b128 v[80:83], v32 offset:12288
    ds_read_b128 v[84:87], v32 offset:13312
    s_branch Lst_15
Lnx_99:
    s_cmp_lg_u32 s96, 4
    s_cbranch_scc1 Lnx_100
    ds_read_b128 v[80:83], v32 offset:12288
    ds_read_b128 v[84:87], v32 offset:13312
    ds_read_b128 v[88:91], v32 offset:14336
    ds_read_b128 v[92:95], v32 offset:15360
    s_branch Lst_16
Lnx_100:
    s_cmp_lg_u32 s96, 2
    s_cbranch_scc1 Lnx_101
    ds_read_b128 v[88:91], v32 offset:14336
    ds_read_b128 v[92:95], v32 offset:15360
    ds_read_b128 v[80:83], v32 offset:16384
    ds_read_b128 v[84:87], v32 offset:17408
    s_branch Lst_17
Lnx_101:
    ds_read_b128 v[80:83], v32 offset:16384
    ds_read_b128 v[84:87], v32 offset:17408
    s_branch Lst_18
Lnx_102:
L_spare:
    v_mov_b32 v244, 0
    v_and_b32 v1, 15, v0
    s_sub_u32 s84, s69, 28
    s_lshl_b32 s85, s72, 2
    s_add_u32 s84, s84, s85
    s_lshl_b32 s84, s84, 13
    v_lshl_add_u32 v248, v0, 7, s84
    v_mov_b32 v249, 0x40000000
    s_getpc_b64 s[64:65]
L_pc:
    s_sub_u32 s64, s64, L_pc-sequential_preLN__sliding_block__mixer_s_mlp__prompt_kernel
    s_subb_u32 s65, s65, 0
    s_and_b32 s65, s65, 0xffff
    s_mov_b32 s66, L_codeend-sequential_preLN__sliding_block__mixer_s_mlp__prompt_kernel
    s_mov_b32 s67, 0x20000
    s_sub_u32 s84, s69, 28
    s_lshl_b32 s85, s72, 2
    s_add_u32 s84, s84, s85
    s_lshl_b32 s87, s84, 11
    v_lshlrev_b32 v252, 7, v1
    buffer_load_dword v254, v252, s[64:67], s87 offen
    s_waitcnt lgkmcnt(0)
    s_add_u32 s58, s56, 0x1000000
    s_addc_u32 s59, s57, 0
    s_cmp_lg_u32 s72, 4
    s_cbranch_scc1 Lel_103
    s_load_dword s75, s[58:59], 0
Lel_103:
    s_mov_b32 s60, s56
    s_and_b32 s61, s57, 0xffff
    s_mov_b32 s62, 0x1085000
    s_mov_b32 s63, 0x20000
    s_mov_b32 s8, s38
    s_and_b32 s9, s39, 0xffff
    s_mov_b32 s10, 0x126000
    s_mov_b32 s11, 0x20000
    s_mov_b32 s4, s36
    s_and_b32 s5, s37, 0xffff
    s_mov_b32 s6, 0x1c0000
    s_mov_b32 s7, 0x20000
    s_mov_b32 s12, s40
    s_and_b32 s13, s41, 0xffff
    s_mov_b32 s14, 0x62000
    s_mov_b32 s15, 0x20000
    s_mov_b32 s16, s44
    s_and_b32 s17, s45, 0xffff
    s_mov_b32 s18, 0x62000
    s_mov_b32 s19, 0x20000
    s_mov_b32 s20, s46
    s_and_b32 s21, s47, 0xffff
    s_mov_b32 s22, 0x62000
    s_mov_b32 s23, 0x20000
    s_mov_b32 s24, s48
    s_and_b32 s25, s49, 0xffff
    s_mov_b32 s26, 0x188000
    s_mov_b32 s27, 0x20000
    s_mov_b32 s28, s50
    s_and_b32 s29, s51, 0xffff
    s_mov_b32 s30, 0x188000
    s_mov_b32 s31, 0x20000
    s_mov_b32 s32, s52
    s_and_b32 s33, s53, 0xffff
    s_mov_b32 s34, 0x1c0000
    s_mov_b32 s35, 0x20000
    v_lshlrev_b32 v251, 7, v0
    s_sub_u32 s84, 31, s69
    s_lshl_b32 s84, s84, 3
    s_add_u32 s84, s84, s68
    s_lshl_b32 s85, s72, 5
    s_add_u32 s88, s84, s85
    s_cmp_ge_u32 s88, 0x62
    s_cbranch_scc1 Lmq_104
    s_lshl_b32 s84, s88, 6
    v_add_u32 v250, s84, v0
    v_mul_u32_u24 v253, 0x124a, v250
    v_lshrrev_b32 v253, 16, v253
    v_mul_u32_u24 v253, 7, v253
    v_add_u32 v250, v250, v253
    v_lshlrev_b32 v250, 7, v250
    s_mov_b32 s84, 0x700
    buffer_load_dword v254, v250, s[8:11], s84 offen
Lmq_104:
    s_sub_u32 s84, s88, 0x62
    s_and_b32 s84, s84, 0xff
    s_cmp_ge_u32 s84, 0x31
    s_cbranch_scc1 Lml_105
    s_lshl_b32 s84, s84, 13
    buffer_load_dword v254, v251, s[20:23], s84 offen
Lml_105:
    s_sub_u32 s84, s88, 0x93
    s_and_b32 s84, s84, 0xff
    s_cmp_ge_u32 s84, 0x31
    s_cbranch_scc1 Lml_106
    s_lshl_b32 s84, s84, 13
    buffer_load_dword v254, v251, s[12:15], s84 offen
Lml_106:
    s_sub_u32 s84, s88, 0xc4
    s_and_b32 s84, s84, 0xff
    s_cmp_ge_u32 s84, 0x31
    s_cbranch_scc1 Lml_107
    s_lshl_b32 s84, s84, 13
    buffer_load_dword v254, v251, s[16:19], s84 offen
Lml_107:
    s_lshl_b32 s90, s87, 2
    s_add_u32 s90, s90, s74
    s_mov_b32 s84, s90
    s_cmp_ge_u32 s87, 0xe000
    s_cmov_b32 s84, 0x40000000
    s_add_u32 s85, s74, 0xe7000
    s_cmp_eq_u32 s87, 0xf800
    s_cmov_b32 s84, s85
    buffer_load_dword v254, v251, s[60:63], s84 offen
    s_getreg_b32 s81, hwreg(HW_REG_XCC_ID)
    s_and_b32 s81, s81, 15
    s_cmp_lg_u32 s72, 4
    s_cbranch_scc1 Lpx_108
    s_lshl_b32 s86, s69, 7
    s_add_u32 s86, s86, s74
    s_add_u32 s86, s86, 0xfd800
    v_mov_b32 v252, 0x27504
    s_waitcnt lgkmcnt(0)
    s_mul_i32 s75, s75, 0x19660d
    s_add_u32 s75, s75, 0x3c6ef35f
    v_mov_b32 v15, s75
    s_add_u32 s84, s75, s81
    v_mov_b32 v253, s84
    ds_write_b32 v252, v15
    s_mov_b64 exec, 1
    buffer_store_dword v253, off, s[60:63], s86 sc1
    s_mov_b64 exec, -1
    s_waitcnt lgkmcnt(0)
Lpx_108:
    v_and_b32 v1, 15, v0
    v_lshlrev_b32 v3, 4, v0
    s_mov_b32 s82, 0xffff0000
    s_mov_b32 s83, 0xffff0000
    s_mov_b32 s77, 0
    v_mov_b32 v16, 0x3f803f80
    v_mov_b32 v17, 0x3f803f80
    v_mov_b32 v18, 0x3f803f80
    v_mov_b32 v19, 0x3f803f80
    s_lshr_b32 s84, s70, 1
    s_mul_i32 s95, s84, 14
    s_sub_u32 s95, s69, s95
    v_bfe_u32 v240, v0, 2, 2
    v_and_b32 v241, 1, v2
    v_lshl_add_u32 v242, v241, 2, v240
    v_lshrrev_b32 v243, 1, v2
    v_lshl_add_u32 v242, v243, 4, v242
    v_lshrrev_b32 v240, 1, v240
    v_lshl_or_b32 v240, v241, 2, v240
    v_and_b32 v241, 3, v0
    v_xor_b32 v240, v240, v241
    v_lshlrev_b32 v240, 4, v240
    v_lshl_add_u32 v240, v242, 7, v240
    v_and_b32 v241, 1, v241
    v_lshl_or_b32 v7, v241, 3, v240
    v_xor_b32 v8, 8, v7
    v_xor_b32 v9, 64, v7
    v_xor_b32 v10, 64, v8
    v_mov_b32 v36, 0
    v_mov_b32 v37, 0
    v_mov_b32 v38, 0
    v_mov_b32 v39, 0
    v_mov_b32 v40, 0
    v_mov_b32 v41, 0
    v_mov_b32 v42, 0
    v_mov_b32 v43, 0
    v_bfe_u32 v240, v0, 3, 2
    v_lshrrev_b32 v241, 5, v0
    v_lshl_add_u32 v242, v241, 3, v240
    s_and_b32 s84, s73, 1
    s_lshl_b32 s84, s84, 2
    s_and_b32 s85, s73, 2
    s_lshl_b32 s85, s85, 3
    s_add_u32 s84, s84, s85
    v_add_u32 v242, s84, v242
    v_lshrrev_b32 v240, 1, v240
    v_lshl_or_b32 v240, v241, 2, v240
    v_and_b32 v241, 7, v0
    v_xor_b32 v240, v240, v241
    v_lshlrev_b32 v240, 4, v240
    v_mul_u32_u24 v4, 0x380, v242
    v_add_u32 v4, v4, v240
    v_mul_u32_u24 v5, 0xa80, v242
    v_add_u32 v5, v5, v240
    v_and_b32 v240, 16, v0
    v_lshrrev_b32 v240, 2, v240
    v_xor_b32 v240, v240, v241
    v_lshlrev_b32 v240, 4, v240
    v_mul_u32_u24 v44, 0x380, v242
    v_add_u32 v44, v44, v240
    v_mul_u32_u24 v6, 0xe00, v242
    v_add_u32 v6, v6, v240
    s_barrier
    v_mov_b32 v15, 0x27504
    ds_read_b32 v15, v15
    s_waitcnt lgkmcnt(0)
    v_readfirstlane_b32 s75, v15
    s_sub_u32 s84, s69, 28
    s_lshl_b32 s85, s72, 2
    s_add_u32 s84, s84, s85
    s_lshl_b32 s87, s84, 11
    s_lshl_b32 s90, s87, 2
    s_add_u32 s90, s90, s74
    v_lshlrev_b32 v251, 7, v0
    s_add_u32 s84, s90, 0x38000
    s_add_u32 s85, s90, 0xb1000
    s_cmp_ge_u32 s87, 0xe000
    s_cmov_b32 s84, s85
    buffer_load_dword v254, v251, s[60:63], s84 offen
    s_add_u32 s84, s85, 0x8000
    s_cmp_lt_u32 s87, 0xe000
    s_cmov_b32 s84, 0x40000000
    buffer_load_dword v254, v251, s[60:63], s84 offen
    v_and_b32 v246, 31, v0
    s_add_u32 s84, s74, 0xfd800
    v_lshl_add_u32 v246, v246, 7, s84
    s_cmp_lg_u32 s72, 4
    s_cbranch_scc1 Lmi_109
    buffer_load_dword v247, v246, s[60:63], 0 offen sc1
Lmi_109:
    s_waitcnt vmcnt(0)
    s_and_b32 s92, s69, 15
    s_lshr_b32 s84, s69, 4
    s_lshl_b32 s84, s84, 3
    s_lshl_b32 s93, s68, 4
    s_add_u32 s93, s93, s84
    s_mul_i32 s94, s92, 7
    s_lshr_b32 s94, s94, 1
    s_lshl_b32 s84, s73, 1
    s_add_u32 s96, s93, s84
    s_cmp_ge_u32 s72, 4
    s_cbranch_scc1 L_sp4
    s_and_b32 s84, s92, 1
    s_cmp_eq_u32 s84, 1
    s_cselect_b32 s85, 0, 9
    s_cselect_b32 s88, 9, 3
    v_mov_b32 v248, -1
    v_cmp_ne_u32 vcc, s85, v2
    s_nop 1
    v_cndmask_b32 v28, 0, v248, vcc
    v_cmp_ne_u32 vcc, s88, v2
    s_nop 1
    v_cndmask_b32 v29, 0, v248, vcc
    s_lshl_b32 s84, s73, 11
    s_add_u32 s85, s84, 0x7000
    v_add_u32 v32, s85, v3
    v_and_b32 v248, 3, v0
    v_lshrrev_b32 v249, 2, v0
    v_and_b32 v250, 2, v248
    v_lshlrev_b32 v250, 2, v250
    v_xor_b32 v249, v249, v250
    v_lshlrev_b32 v249, 4, v249
    v_lshl_add_u32 v249, v248, 8, v249
    v_and_b32 v248, 1, v248
    v_lshl_or_b32 v249, v248, 3, v249
    s_add_u32 s85, s84, 0xe000
    v_add_u32 v33, s85, v249
    v_xor_b32 v34, 8, v33
    s_add_u32 s85, s84, 0x23000
    v_add_u32 v30, s85, v3
    v_mov_b32 v31, 0x27500
    v_lshlrev_b32 v248, 2, v2
    v_add_u32 v249, 0, v248
    v_cmp_gt_u32 s[36:37], v249, v1
    v_add_u32 v249, 1, v248
    v_cmp_gt_u32 s[38:39], v249, v1
    v_add_u32 v249, 2, v248
    v_cmp_gt_u32 s[50:51], v249, v1
    v_add_u32 v249, 3, v248
    v_cmp_gt_u32 s[52:53], v249, v1
    s_and_b32 s85, s96, 15
    s_lshl_b32 s84, s94, 8
    s_mul_i32 s44, s85, 0x3800
    s_add_u32 s44, s44, s74
    s_add_u32 s44, s44, s84
    s_lshl_b32 s84, s92, 2
    s_mul_i32 s59, s85, 0x80
    s_add_u32 s59, s59, s74
    s_add_u32 s59, s59, 0xe7000
    s_add_u32 s59, s59, s84
    s_bitcmp1_b32 s92, 0
    s_cselect_b32 s42, 0xffff, 0
    s_cselect_b32 s43, 0, 0xffff0000
    s_cselect_b32 s46, 8, 0
    s_mov_b32 s48, 0xffff
    s_mov_b32 s49, 0
    s_not_b64 s[40:41], s[42:43]
    s_add_u32 s46, s46, s44
    s_add_u32 s45, s44, 0x3800
    s_add_u32 s47, s46, 0x3800
    s_branch L_att
L_sp4:
    s_cmp_lg_u32 s72, 4
    s_cbranch_scc1 Lmc_110
    s_mov_b32 s97, 0x9c40
Lpoll_111:
    v_subrev_u32 v247, s75, v247
    v_cmp_le_u32 vcc, 16, v247
    s_cbranch_vccz Lpd_112
    s_sub_u32 s97, s97, 1
    s_cmp_eq_u32 s97, 0
    s_cbranch_scc1 Lpd_112
    s_sleep 4
    buffer_load_dword v247, v246, s[60:63], 0 offen sc1
    s_waitcnt vmcnt(0)
    s_branch Lpoll_111
Lpd_112:
    v_cmp_ne_u32 vcc, s81, v247
    s_nop 0
    s_cmp_eq_u64 vcc, 0
    s_cselect_b32 s84, 1, 0
    v_mov_b32 v240, s84
    v_mov_b32 v241, 0x27500
    ds_write_b32 v241, v240
    s_waitcnt lgkmcnt(0)
Lmc_110:
    v_and_b32 v96, 32, v0
    v_lshlrev_b32 v96, 2, v96
    v_xor_b32 v96, v96, v3
    s_lshr_b32 s84, s94, 3
    s_add_u32 s85, s94, 3
    s_lshr_b32 s85, s85, 3
    s_sub_u32 s85, s85, s84
    v_and_b32 v240, s85, v0
    v_add_u32 v240, s84, v240
    v_lshrrev_b32 v242, 1, v0
    v_lshlrev_b32 v240, 7, v240
    s_mul_i32 s84, s73, 6
    s_add_u32 s84, s84, s93
    s_sub_u32 s84, s84, 16
    v_min_u32 v242, 5, v242
    v_add_u32 v243, s84, v242
    v_max_i32 v243, 0, v243
    v_lshrrev_b32 v244, 4, v243
    v_lshlrev_b32 v244, 21, v244
    v_add_u32 v244, v244, v240
    v_and_b32 v240, 15, v243
    v_lshl_add_u32 v244, v240, 10, v244
    v_add_u32 v244, 0xf9000, v244
    s_branch L_attpre
L_aload:
    v_bfe_u32 v240, v0, 3, 2
    v_lshrrev_b32 v241, 5, v0
    v_lshl_add_u32 v242, v241, 3, v240
    s_and_b32 s84, s73, 1
    s_lshl_b32 s84, s84, 2
    s_and_b32 s85, s73, 2
    s_lshl_b32 s85, s85, 3
    s_add_u32 s84, s84, s85
    v_add_u32 v242, s84, v242
    v_lshrrev_b32 v240, 1, v240
    v_lshl_or_b32 v240, v241, 2, v240
    v_and_b32 v241, 7, v0
    v_xor_b32 v240, v240, v241
    v_lshlrev_b32 v240, 4, v240
    v_mul_u32_u24 v4, 0x380, v242
    v_add_u32 v4, v4, v240
    v_mul_u32_u24 v5, 0xa80, v242
    v_add_u32 v5, v5, v240
    v_and_b32 v240, 16, v0
    v_lshrrev_b32 v240, 2, v240
    v_xor_b32 v240, v240, v241
    v_lshlrev_b32 v240, 4, v240
    v_mul_u32_u24 v44, 0x380, v242
    v_add_u32 v44, v44, v240
    v_mul_u32_u24 v6, 0xe00, v242
    v_add_u32 v6, v6, v240
    s_bitcmp1_b32 s70, 0
    s_cselect_b32 s85, 0x93000, 0
    s_cselect_b32 s88, 0, 0x93000
    s_add_u32 s85, s85, s78
    s_add_u32 s88, s88, s78
    s_waitcnt lgkmcnt(0)
    s_add_u32 s58, s56, 0x1000000
    s_addc_u32 s59, s57, 0
    s_cmp_lg_u32 s72, 4
    s_cbranch_scc1 Lel_113
    s_load_dword s75, s[58:59], 0
Lel_113:
    s_mov_b32 s8, s38
    s_and_b32 s9, s39, 0xffff
    s_mov_b32 s10, 0x126000
    s_mov_b32 s11, 0x20000
    s_mov_b32 s60, s56
    s_and_b32 s61, s57, 0xffff
    s_mov_b32 s62, 0x1085000
    s_mov_b32 s63, 0x20000
    s_mov_b32 s4, s36
    s_and_b32 s5, s37, 0xffff
    s_mov_b32 s6, 0x1c0000
    s_mov_b32 s7, 0x20000
    s_mov_b32 s12, s40
    s_and_b32 s13, s41, 0xffff
    s_mov_b32 s14, 0x62000
    s_mov_b32 s15, 0x20000
    s_mov_b32 s16, s44
    s_and_b32 s17, s45, 0xffff
    s_mov_b32 s18, 0x62000
    s_mov_b32 s19, 0x20000
    s_mov_b32 s20, s46
    s_and_b32 s21, s47, 0xffff
    s_mov_b32 s22, 0x62000
    s_mov_b32 s23, 0x20000
    s_mov_b32 s24, s48
    s_and_b32 s25, s49, 0xffff
    s_mov_b32 s26, 0x188000
    s_mov_b32 s27, 0x20000
    s_mov_b32 s28, s50
    s_and_b32 s29, s51, 0xffff
    s_mov_b32 s30, 0x188000
    s_mov_b32 s31, 0x20000
    s_mov_b32 s32, s52
    s_and_b32 s33, s53, 0xffff
    s_mov_b32 s34, 0x1c0000
    s_mov_b32 s35, 0x20000
    v_and_b32 v1, 15, v0
    v_lshlrev_b32 v3, 4, v0
    s_mov_b32 s82, 0xffff0000
    s_mov_b32 s83, 0xffff0000
    s_mov_b32 s77, 0
    v_mov_b32 v16, 0x3f803f80
    v_mov_b32 v17, 0x3f803f80
    v_mov_b32 v18, 0x3f803f80
    v_mov_b32 v19, 0x3f803f80
    s_lshr_b32 s84, s70, 1
    s_mul_i32 s95, s84, 14
    s_sub_u32 s95, s69, s95
    v_bfe_u32 v240, v0, 2, 2
    v_and_b32 v241, 1, v2
    v_lshl_add_u32 v242, v241, 2, v240
    v_lshrrev_b32 v243, 1, v2
    v_lshl_add_u32 v242, v243, 4, v242
    v_lshrrev_b32 v240, 1, v240
    v_lshl_or_b32 v240, v241, 2, v240
    v_and_b32 v241, 3, v0
    v_xor_b32 v240, v240, v241
    v_lshlrev_b32 v240, 4, v240
    v_lshl_add_u32 v240, v242, 7, v240
    v_and_b32 v241, 1, v241
    v_lshl_or_b32 v7, v241, 3, v240
    v_xor_b32 v8, 8, v7
    v_xor_b32 v9, 64, v7
    v_xor_b32 v10, 64, v8
    v_mov_b32 v36, 0
    v_mov_b32 v37, 0
    v_mov_b32 v38, 0
    v_mov_b32 v39, 0
    v_mov_b32 v40, 0
    v_mov_b32 v41, 0
    v_mov_b32 v42, 0
    v_mov_b32 v43, 0
    s_barrier
    s_mov_b32 s79, s80
    s_lshl_b32 s89, s73, 10
    s_add_u32 s89, s89, 0x0
    s_add_u32 s90, s78, 0x380
    s_mov_b32 s97, 4
Ldma_114:
    s_lshl_b32 s91, s79, 12
    s_add_u32 m0, s91, s89
    s_mul_i32 s91, s79, 0x15000
    s_add_u32 s91, s91, s90
    buffer_load_dwordx4 v5, s[8:11], s91 offen lds
    s_add_u32 s79, s79, 1
    s_cmp_eq_u32 s79, 14
    s_cmov_b32 s79, 0
    s_sub_u32 s97, s97, 1
    s_cmp_lg_u32 s97, 0
    s_cbranch_scc1 Ldma_114
    s_getreg_b32 s81, hwreg(HW_REG_XCC_ID)
    s_and_b32 s81, s81, 15
    s_cmp_lg_u32 s72, 4
    s_cbranch_scc1 Lpx_115
    s_lshl_b32 s86, s69, 7
    s_add_u32 s86, s86, s74
    s_add_u32 s86, s86, 0xfd800
    v_mov_b32 v252, 0x27504
    s_waitcnt lgkmcnt(0)
    s_mul_i32 s75, s75, 0x19660d
    s_add_u32 s75, s75, 0x3c6ef35f
    v_mov_b32 v15, s75
    s_add_u32 s84, s75, s81
    v_mov_b32 v253, s84
    ds_write_b32 v252, v15
    s_mov_b64 exec, 1
    buffer_store_dword v253, off, s[60:63], s86 sc1
    s_mov_b64 exec, -1
    s_waitcnt lgkmcnt(0)
Lpx_115:
    s_lshl_b32 s89, s73, 10
    s_add_u32 s89, s89, 0x0
    s_add_u32 s90, s78, 0x380
    s_mov_b32 s97, 10
Ldma_116:
    s_lshl_b32 s91, s79, 12
    s_add_u32 m0, s91, s89
    s_mul_i32 s91, s79, 0x15000
    s_add_u32 s91, s91, s90
    buffer_load_dwordx4 v5, s[8:11], s91 offen lds
    s_add_u32 s79, s79, 1
    s_cmp_eq_u32 s79, 14
    s_cmov_b32 s79, 0
    s_sub_u32 s97, s97, 1
    s_cmp_lg_u32 s97, 0
    s_cbranch_scc1 Ldma_116
    s_mov_b32 s79, 0
    s_lshl_b32 s89, s73, 10
    s_add_u32 s89, s89, 0xe000
    s_add_u32 s90, s85, 0x700
    s_mov_b32 s97, 7
Ldma_117:
    s_lshl_b32 s91, s79, 12
    s_add_u32 m0, s91, s89
    s_mul_i32 s91, s79, 0x15000
    s_add_u32 s91, s91, s90
    buffer_load_dwordx4 v5, s[8:11], s91 offen lds
    s_add_u32 s79, s79, 1
    s_sub_u32 s97, s97, 1
    s_cmp_lg_u32 s97, 0
    s_cbranch_scc1 Ldma_117
    s_waitcnt vmcnt(7)
    s_barrier
    s_mov_b32 s79, 0
    s_lshl_b32 s89, s73, 10
    s_add_u32 s89, s89, 0x15000
    s_add_u32 s90, s88, 0x700
    s_mov_b32 s97, 7
Ldma_118:
    s_lshl_b32 s91, s79, 12
    s_add_u32 m0, s91, s89
    s_mul_i32 s91, s79, 0x15000
    s_add_u32 s91, s91, s90
    buffer_load_dwordx4 v5, s[8:11], s91 offen lds
    s_add_u32 s79, s79, 1
    s_sub_u32 s97, s97, 1
    s_cmp_lg_u32 s97, 0
    s_cbranch_scc1 Ldma_118
    s_mov_b32 s79, 0
    s_lshl_b32 s89, s73, 10
    s_add_u32 s89, s89, 0x1c000
    s_mov_b32 s90, s85
    s_mov_b32 s97, 7
Ldma_119:
    s_lshl_b32 s91, s79, 12
    s_add_u32 m0, s91, s89
    s_mul_i32 s91, s79, 0x15000
    s_add_u32 s91, s91, s90
    buffer_load_dwordx4 v5, s[8:11], s91 offen lds
    s_add_u32 s79, s79, 1
    s_sub_u32 s97, s97, 1
    s_cmp_lg_u32 s97, 0
    s_cbranch_scc1 Ldma_119
    v_mov_b32 v15, 0x27504
    ds_read_b32 v15, v15
    s_waitcnt lgkmcnt(0)
    v_readfirstlane_b32 s75, v15
    s_waitcnt vmcnt(7)
    s_barrier
    s_mov_b32 s79, 0
    s_lshl_b32 s89, s73, 10
    s_add_u32 s89, s89, 0x0
    s_mov_b32 s90, s88
    s_mov_b32 s97, 7
Ldma_120:
    s_lshl_b32 s91, s79, 12
    s_add_u32 m0, s91, s89
    s_mul_i32 s91, s79, 0x15000
    s_add_u32 s91, s91, s90
    buffer_load_dwordx4 v5, s[8:11], s91 offen lds
    s_add_u32 s79, s79, 1
    s_sub_u32 s97, s97, 1
    s_cmp_lg_u32 s97, 0
    s_cbranch_scc1 Ldma_120
    s_and_b32 s92, s69, 15
    s_lshr_b32 s84, s69, 4
    s_lshl_b32 s84, s84, 3
    s_lshl_b32 s93, s68, 4
    s_add_u32 s93, s93, s84
    s_mul_i32 s94, s92, 7
    s_lshr_b32 s94, s94, 1
    s_lshl_b32 s84, s73, 1
    s_add_u32 s96, s93, s84
    v_and_b32 v96, 32, v0
    v_lshlrev_b32 v96, 2, v96
    v_xor_b32 v96, v96, v3
    s_lshr_b32 s84, s94, 3
    s_add_u32 s85, s94, 3
    s_lshr_b32 s85, s85, 3
    s_sub_u32 s85, s85, s84
    v_and_b32 v240, s85, v0
    v_add_u32 v240, s84, v240
    v_lshrrev_b32 v242, 1, v0
    v_lshlrev_b32 v240, 7, v240
    s_mul_i32 s84, s73, 6
    s_add_u32 s84, s84, s93
    s_sub_u32 s84, s84, 16
    v_min_u32 v242, 5, v242
    v_add_u32 v243, s84, v242
    v_max_i32 v243, 0, v243
    v_lshrrev_b32 v244, 4, v243
    v_lshlrev_b32 v244, 21, v244
    v_add_u32 v244, v244, v240
    v_and_b32 v240, 15, v243
    v_lshl_add_u32 v244, v240, 10, v244
    v_add_u32 v244, 0xf9000, v244
    v_mov_b32 v23, 0x27510
    v_mov_b32 v24, 1
    s_waitcnt vmcnt(0)
    s_mov_b64 exec, 1
    ds_add_u32 v23, v24 offset:112
    s_mov_b64 exec, -1
    v_and_b32 v246, 31, v0
    s_add_u32 s84, s74, 0xfd800
    v_lshl_add_u32 v246, v246, 7, s84
    s_cmp_lg_u32 s72, 4
    s_cbranch_scc1 Lmi_121
    buffer_load_dword v247, v246, s[60:63], 0 offen sc1
Lmi_121:
    s_waitcnt vmcnt(0)
    s_cmp_lg_u32 s72, 4
    s_cbranch_scc1 Lmc_122
    s_mov_b32 s97, 0x9c40
Lpoll_123:
    v_subrev_u32 v247, s75, v247
    v_cmp_le_u32 vcc, 16, v247
    s_cbranch_vccz Lpd_124
    s_sub_u32 s97, s97, 1
    s_cmp_eq_u32 s97, 0
    s_cbranch_scc1 Lpd_124
    s_sleep 4
    buffer_load_dword v247, v246, s[60:63], 0 offen sc1
    s_waitcnt vmcnt(0)
    s_branch Lpoll_123
Lpd_124:
    v_cmp_ne_u32 vcc, s81, v247
    s_nop 0
    s_cmp_eq_u64 vcc, 0
    s_cselect_b32 s84, 1, 0
    v_mov_b32 v240, s84
    v_mov_b32 v241, 0x27500
    ds_write_b32 v241, v240
    s_waitcnt lgkmcnt(0)
Lmc_122:
    s_mov_b64 exec, 1
    ds_add_u32 v23, v24 offset:120
    s_mov_b64 exec, -1
    s_mov_b32 s84, s78
    buffer_load_dwordx4 v[184:187], v4, s[20:23], s84 offen
    s_add_u32 s84, s84, 0x7000
    buffer_load_dwordx4 v[188:191], v4, s[20:23], s84 offen
    s_add_u32 s84, s84, 0x7000
    buffer_load_dwordx4 v[192:195], v4, s[20:23], s84 offen
    s_add_u32 s84, s84, 0x7000
    buffer_load_dwordx4 v[196:199], v4, s[20:23], s84 offen
    s_add_u32 s84, s84, 0x7000
    buffer_load_dwordx4 v[200:203], v4, s[20:23], s84 offen
    s_add_u32 s84, s84, 0x7000
    buffer_load_dwordx4 v[204:207], v4, s[20:23], s84 offen
    s_add_u32 s84, s84, 0x7000
    buffer_load_dwordx4 v[208:211], v4, s[20:23], s84 offen
    s_add_u32 s84, s84, 0x7000
L_attpre:
    s_mov_b32 s97, 0x9c40
Lpoll_125:
    buffer_load_dword v255, v244, s[60:63], 0 offen sc1
    s_waitcnt vmcnt(0)
    v_cmp_ne_u32 vcc, s75, v255
    s_cbranch_vccz Lpd_126
    s_sleep 2
    s_sub_u32 s97, s97, 1
    s_cmp_lg_u32 s97, 0
    s_cbranch_scc1 Lpoll_125
Lpd_126:
    s_mul_i32 s86, s73, 6
    s_lshl_b32 s89, s86, 10
    s_add_u32 s89, s89, 0x7000
    s_add_u32 s86, s86, s93
    s_sub_u32 s86, s86, 16
    s_lshl_b32 s88, s94, 8
    s_add_u32 s88, s88, 0x70000
    s_add_u32 m0, s89, 0x0
    s_add_u32 s84, s86, 0
    s_lshr_b32 s85, s84, 4
    s_lshl_b32 s85, s85, 21
    s_and_b32 s90, s84, 15
    s_mul_i32 s90, s90, 0x3800
    s_add_u32 s85, s85, s90
    s_add_u32 s85, s85, s88
    s_cmp_lt_i32 s84, 0
    s_cmov_b32 s85, 0x40000000
    buffer_load_dwordx4 v3, s[60:63], s85 offen sc1 lds
    s_add_u32 m0, s89, 0x400
    s_add_u32 s84, s86, 1
    s_lshr_b32 s85, s84, 4
    s_lshl_b32 s85, s85, 21
    s_and_b32 s90, s84, 15
    s_mul_i32 s90, s90, 0x3800
    s_add_u32 s85, s85, s90
    s_add_u32 s85, s85, s88
    s_cmp_lt_i32 s84, 0
    s_cmov_b32 s85, 0x40000000
    buffer_load_dwordx4 v3, s[60:63], s85 offen sc1 lds
    s_add_u32 m0, s89, 0x800
    s_add_u32 s84, s86, 2
    s_lshr_b32 s85, s84, 4
    s_lshl_b32 s85, s85, 21
    s_and_b32 s90, s84, 15
    s_mul_i32 s90, s90, 0x3800
    s_add_u32 s85, s85, s90
    s_add_u32 s85, s85, s88
    s_cmp_lt_i32 s84, 0
    s_cmov_b32 s85, 0x40000000
    buffer_load_dwordx4 v3, s[60:63], s85 offen sc1 lds
    s_add_u32 m0, s89, 0xc00
    s_add_u32 s84, s86, 3
    s_lshr_b32 s85, s84, 4
    s_lshl_b32 s85, s85, 21
    s_and_b32 s90, s84, 15
    s_mul_i32 s90, s90, 0x3800
    s_add_u32 s85, s85, s90
    s_add_u32 s85, s85, s88
    s_cmp_lt_i32 s84, 0
    s_cmov_b32 s85, 0x40000000
    buffer_load_dwordx4 v3, s[60:63], s85 offen sc1 lds
    s_add_u32 m0, s89, 0x1000
    s_add_u32 s84, s86, 4
    s_lshr_b32 s85, s84, 4
    s_lshl_b32 s85, s85, 21
    s_and_b32 s90, s84, 15
    s_mul_i32 s90, s90, 0x3800
    s_add_u32 s85, s85, s90
    s_add_u32 s85, s85, s88
    s_cmp_lt_i32 s84, 0
    s_cmov_b32 s85, 0x40000000
    buffer_load_dwordx4 v3, s[60:63], s85 offen sc1 lds
    s_add_u32 m0, s89, 0x1400
    s_add_u32 s84, s86, 5
    s_lshr_b32 s85, s84, 4
    s_lshl_b32 s85, s85, 21
    s_and_b32 s90, s84, 15
    s_mul_i32 s90, s90, 0x3800
    s_add_u32 s85, s85, s90
    s_add_u32 s85, s85, s88
    s_cmp_lt_i32 s84, 0
    s_cmov_b32 s85, 0x40000000
    buffer_load_dwordx4 v3, s[60:63], s85 offen sc1 lds
    s_lshr_b32 s84, s94, 3
    s_add_u32 s85, s94, 3
    s_lshr_b32 s85, s85, 3
    s_sub_u32 s85, s85, s84
    v_and_b32 v240, s85, v0
    v_add_u32 v240, s84, v240
    v_lshrrev_b32 v242, 1, v0
    s_and_b32 s84, s93, 15
    s_lshl_b32 s85, s73, 1
    s_add_u32 s84, s84, s85
    v_and_b32 v242, 1, v242
    v_add_u32 v242, s84, v242
    v_lshlrev_b32 v240, 2, v240
    v_lshl_add_u32 v240, v242, 7, v240
    s_add_u32 s84, s74, 0xe8000
    v_add_u32 v245, s84, v240
    v_add_u32 v244, 4, v244
    s_and_b32 s84, s93, 15
    s_lshl_b32 s85, s73, 1
    s_add_u32 s84, s84, s85
    s_lshl_b32 s88, s94, 8
    s_mul_i32 s86, s84, 0x3800
    s_add_u32 s86, s86, s74
    s_add_u32 s86, s86, s88
    s_lshl_b32 s85, s85, 10
    s_add_u32 m0, s85, 0x23000
    s_add_u32 s88, s86, 0x3400
    s_mov_b32 s97, 0x9c40
Lpoll_127:
    buffer_load_dword v255, v245, s[60:63], 0 offen sc1
    s_waitcnt vmcnt(0)
    v_cmp_ne_u32 vcc, s75, v255
    s_cbranch_vccz Lpd_128
    s_sub_u32 s97, s97, 1
    s_cmp_lg_u32 s97, 0
    s_cbranch_scc1 Lpoll_127
Lpd_128:
    buffer_load_dwordx4 v3, s[60:63], s86 offen sc1 lds
    buffer_load_dwordx4 v3, s[60:63], s88 offen offset:1024 sc1 lds
    s_waitcnt vmcnt(0)
    s_barrier
    v_mov_b32 v246, 0x27500
    ds_read_b32 v246, v246
    s_mov_b32 s97, 0x9c40
Lpoll_129:
    buffer_load_dword v255, v244, s[60:63], 0 offen sc1
    s_waitcnt vmcnt(0)
    v_cmp_ne_u32 vcc, s75, v255
    s_cbranch_vccz Lpd_130
    s_sleep 1
    s_sub_u32 s97, s97, 1
    s_cmp_lg_u32 s97, 0
    s_cbranch_scc1 Lpoll_129
Lpd_130:
    s_mul_i32 s86, s73, 6
    s_lshl_b32 s89, s86, 10
    s_add_u32 s89, s89, 0xe000
    s_add_u32 s86, s86, s93
    s_sub_u32 s86, s86, 16
    s_lshl_b32 s88, s94, 8
    s_add_u32 s88, s88, 0xa8000
    s_add_u32 m0, s89, 0x0
    s_add_u32 s84, s86, 0
    s_lshr_b32 s85, s84, 4
    s_lshl_b32 s85, s85, 21
    s_and_b32 s90, s84, 15
    s_mul_i32 s90, s90, 0x3800
    s_add_u32 s85, s85, s90
    s_add_u32 s85, s85, s88
    s_cmp_lt_i32 s84, 0
    s_cmov_b32 s85, 0x40000000
    buffer_load_dwordx4 v96, s[60:63], s85 offen sc1 lds
    s_add_u32 m0, s89, 0x400
    s_add_u32 s84, s86, 1
    s_lshr_b32 s85, s84, 4
    s_lshl_b32 s85, s85, 21
    s_and_b32 s90, s84, 15
    s_mul_i32 s90, s90, 0x3800
    s_add_u32 s85, s85, s90
    s_add_u32 s85, s85, s88
    s_cmp_lt_i32 s84, 0
    s_cmov_b32 s85, 0x40000000
    buffer_load_dwordx4 v96, s[60:63], s85 offen sc1 lds
    s_add_u32 m0, s89, 0x800
    s_add_u32 s84, s86, 2
    s_lshr_b32 s85, s84, 4
    s_lshl_b32 s85, s85, 21
    s_and_b32 s90, s84, 15
    s_mul_i32 s90, s90, 0x3800
    s_add_u32 s85, s85, s90
    s_add_u32 s85, s85, s88
    s_cmp_lt_i32 s84, 0
    s_cmov_b32 s85, 0x40000000
    buffer_load_dwordx4 v96, s[60:63], s85 offen sc1 lds
    s_add_u32 m0, s89, 0xc00
    s_add_u32 s84, s86, 3
    s_lshr_b32 s85, s84, 4
    s_lshl_b32 s85, s85, 21
    s_and_b32 s90, s84, 15
    s_mul_i32 s90, s90, 0x3800
    s_add_u32 s85, s85, s90
    s_add_u32 s85, s85, s88
    s_cmp_lt_i32 s84, 0
    s_cmov_b32 s85, 0x40000000
    buffer_load_dwordx4 v96, s[60:63], s85 offen sc1 lds
    s_add_u32 m0, s89, 0x1000
    s_add_u32 s84, s86, 4
    s_lshr_b32 s85, s84, 4
    s_lshl_b32 s85, s85, 21
    s_and_b32 s90, s84, 15
    s_mul_i32 s90, s90, 0x3800
    s_add_u32 s85, s85, s90
    s_add_u32 s85, s85, s88
    s_cmp_lt_i32 s84, 0
    s_cmov_b32 s85, 0x40000000
    buffer_load_dwordx4 v96, s[60:63], s85 offen sc1 lds
    s_add_u32 m0, s89, 0x1400
    s_add_u32 s84, s86, 5
    s_lshr_b32 s85, s84, 4
    s_lshl_b32 s85, s85, 21
    s_and_b32 s90, s84, 15
    s_mul_i32 s90, s90, 0x3800
    s_add_u32 s85, s85, s90
    s_add_u32 s85, s85, s88
    s_cmp_lt_i32 s84, 0
    s_cmov_b32 s85, 0x40000000
    buffer_load_dwordx4 v96, s[60:63], s85 offen sc1 lds
    s_waitcnt lgkmcnt(0)
    v_readfirstlane_b32 s77, v246
    s_cmp_ge_u32 s69, 28
    s_cbranch_scc1 Lbs_131
    s_mov_b32 s79, 0
    s_lshl_b32 s89, s73, 10
    s_add_u32 s89, s89, 0x15000
    s_mov_b32 s90, s78
    s_mov_b32 s97, 8
Ldma_133:
    s_lshl_b32 s91, s79, 12
    s_add_u32 m0, s91, s89
    s_mul_i32 s91, s79, 0x7000
    s_add_u32 s91, s91, s90
    buffer_load_dwordx4 v4, s[12:15], s91 offen lds
    s_add_u32 s79, s79, 1
    s_sub_u32 s97, s97, 1
    s_cmp_lg_u32 s97, 0
    s_cbranch_scc1 Ldma_133
    s_waitcnt vmcnt(8)
    s_barrier
    s_lshl_b32 s89, s73, 10
    s_add_u32 s89, s89, 0x15000
    s_mov_b32 s90, s78
    s_mov_b32 s97, 6
Ldma_134:
    s_lshl_b32 s91, s79, 12
    s_add_u32 m0, s91, s89
    s_mul_i32 s91, s79, 0x7000
    s_add_u32 s91, s91, s90
    buffer_load_dwordx4 v4, s[12:15], s91 offen lds
    s_add_u32 s79, s79, 1
    s_sub_u32 s97, s97, 1
    s_cmp_lg_u32 s97, 0
    s_cbranch_scc1 Ldma_134
    s_mov_b32 s79, 0
    s_lshl_b32 s89, s73, 10
    s_add_u32 s89, s89, 0x0
    s_mov_b32 s90, s78
    s_mov_b32 s97, 14
Ldma_135:
    s_lshl_b32 s91, s79, 12
    s_add_u32 m0, s91, s89
    s_mul_i32 s91, s79, 0x7000
    s_add_u32 s91, s91, s90
    buffer_load_dwordx4 v4, s[16:19], s91 offen lds
    s_add_u32 s79, s79, 1
    s_sub_u32 s97, s97, 1
    s_cmp_lg_u32 s97, 0
    s_cbranch_scc1 Ldma_135
    s_add_u32 s84, s78, 0x31000
    buffer_load_dwordx4 v[212:215], v4, s[20:23], s84 offen
    s_add_u32 s84, s84, 0x7000
    buffer_load_dwordx4 v[216:219], v4, s[20:23], s84 offen
    s_add_u32 s84, s84, 0x7000
    buffer_load_dwordx4 v[220:223], v4, s[20:23], s84 offen
    s_add_u32 s84, s84, 0x7000
    buffer_load_dwordx4 v[224:227], v4, s[20:23], s84 offen
    s_add_u32 s84, s84, 0x7000
    buffer_load_dwordx4 v[228:231], v4, s[20:23], s84 offen
    s_add_u32 s84, s84, 0x7000
    buffer_load_dwordx4 v[232:235], v4, s[20:23], s84 offen
    s_add_u32 s84, s84, 0x7000
    buffer_load_dwordx4 v[236:239], v4, s[20:23], s84 offen
    s_add_u32 s84, s84, 0x7000
    v_mov_b32 v23, 0x27510
    v_mov_b32 v24, 1
    s_waitcnt vmcnt(7)
    s_mov_b64 exec, 1
    ds_add_u32 v23, v24 offset:52
    s_mov_b64 exec, -1
    s_waitcnt vmcnt(0)
    s_branch L_cload
Lbs_131:
    s_waitcnt vmcnt(0)
    s_sub_u32 s88, s69, 28
    s_lshl_b32 s88, s88, 3
    s_add_u32 s88, s88, s68
    s_lshl_b32 s88, s88, 7
    s_cmp_ge_u32 s88, 0xe00
    s_cbranch_scc1 Lsa_136
    s_mov_b32 s79, 0
    s_lshl_b32 s89, s73, 10
    s_add_u32 s89, s89, 0x15000
    s_mov_b32 s90, s88
    s_mov_b32 s97, 5
Ldma_137:
    s_lshl_b32 s91, s79, 12
    s_add_u32 m0, s91, s89
    s_mul_i32 s91, s79, 0x1c000
    s_add_u32 s91, s91, s90
    buffer_load_dwordx4 v6, s[24:27], s91 offen lds
    s_add_u32 s79, s79, 1
    s_sub_u32 s97, s97, 1
    s_cmp_lg_u32 s97, 0
    s_cbranch_scc1 Ldma_137
Lsa_136:
    s_barrier
    s_sub_u32 s88, s69, 28
    s_lshl_b32 s88, s88, 3
    s_add_u32 s88, s88, s68
    s_lshl_b32 s88, s88, 7
    s_cmp_ge_u32 s88, 0xe00
    s_cbranch_scc1 Lsa_138
    s_mov_b32 s79, 5
    s_lshl_b32 s89, s73, 10
    s_add_u32 s89, s89, 0x15000
    s_mov_b32 s90, s88
    s_mov_b32 s97, 9
Ldma_139:
    s_lshl_b32 s91, s79, 12
    s_add_u32 m0, s91, s89
    s_mul_i32 s91, s79, 0x1c000
    s_add_u32 s91, s91, s90
    buffer_load_dwordx4 v6, s[24:27], s91 offen lds
    s_add_u32 s79, s79, 1
    s_sub_u32 s97, s97, 1
    s_cmp_lg_u32 s97, 0
    s_cbranch_scc1 Ldma_139
Lsa_138:
    s_waitcnt vmcnt(0)
    s_barrier
    s_cmp_ge_u32 s88, 0xe00
    s_cbranch_scc1 Lsc_140
    v_bfe_u32 v240, v0, 2, 2
    v_and_b32 v241, 1, v2
    v_lshl_add_u32 v241, v241, 2, v240
    v_lshrrev_b32 v242, 1, v2
    v_lshl_add_u32 v241, v242, 4, v241
    v_and_b32 v240, 2, v240
    v_lshlrev_b32 v240, 5, v240
    s_lshl_b32 s84, s73, 5
    v_xor_b32 v240, s84, v240
    v_lshl_add_u32 v240, v241, 7, v240
    v_and_b32 v241, 3, v0
    v_lshl_add_u32 v20, v241, 3, v240
    v_add_u32 v240, 0x15000, v20
    ds_read_b64_tr_b16 v[128:129], v240 offset:0
    ds_read_b64_tr_b16 v[130:131], v240 offset:1024
    ds_read_b64_tr_b16 v[132:133], v240 offset:4096
    ds_read_b64_tr_b16 v[134:135], v240 offset:5120
    ds_read_b64_tr_b16 v[136:137], v240 offset:8192
    ds_read_b64_tr_b16 v[138:139], v240 offset:9216
    ds_read_b64_tr_b16 v[140:141], v240 offset:12288
    ds_read_b64_tr_b16 v[142:143], v240 offset:13312
    ds_read_b64_tr_b16 v[144:145], v240 offset:16384
    ds_read_b64_tr_b16 v[146:147], v240 offset:17408
    ds_read_b64_tr_b16 v[148:149], v240 offset:20480
    ds_read_b64_tr_b16 v[150:151], v240 offset:21504
    ds_read_b64_tr_b16 v[152:153], v240 offset:24576
    ds_read_b64_tr_b16 v[154:155], v240 offset:25600
    ds_read_b64_tr_b16 v[156:157], v240 offset:28672
    ds_read_b64_tr_b16 v[158:159], v240 offset:29696
    ds_read_b64_tr_b16 v[160:161], v240 offset:32768
    ds_read_b64_tr_b16 v[162:163], v240 offset:33792
    ds_read_b64_tr_b16 v[164:165], v240 offset:36864
    ds_read_b64_tr_b16 v[166:167], v240 offset:37888
    ds_read_b64_tr_b16 v[168:169], v240 offset:40960
    ds_read_b64_tr_b16 v[170:171], v240 offset:41984
    ds_read_b64_tr_b16 v[172:173], v240 offset:45056
    ds_read_b64_tr_b16 v[174:175], v240 offset:46080
    ds_read_b64_tr_b16 v[176:177], v240 offset:49152
    ds_read_b64_tr_b16 v[178:179], v240 offset:50176
    ds_read_b64_tr_b16 v[180:181], v240 offset:53248
    ds_read_b64_tr_b16 v[182:183], v240 offset:54272
    v_lshlrev_b32 v241, 5, v2
    v_lshl_add_u32 v241, v1, 4, v241
    s_lshl_b32 s84, s88, 2
    s_lshl_b32 s85, s73, 7
    s_add_u32 s84, s84, s85
    s_add_u32 s84, s84, 0x1001000
    v_mov_b32 v245, v15
    v_mov_b32 v247, v15
    v_cmp_eq_u32 vcc, 0, v1
    s_waitcnt lgkmcnt(0)
    v_mfma_f32_16x16x32_bf16 v[48:51], v[128:131], v[16:19], 0
    v_mfma_f32_16x16x32_bf16 v[48:51], v[132:135], v[16:19], v[48:51]
    v_mfma_f32_16x16x32_bf16 v[48:51], v[136:139], v[16:19], v[48:51]
    v_mfma_f32_16x16x32_bf16 v[48:51], v[140:143], v[16:19], v[48:51]
    v_mfma_f32_16x16x32_bf16 v[48:51], v[144:147], v[16:19], v[48:51]
    v_mfma_f32_16x16x32_bf16 v[48:51], v[148:151], v[16:19], v[48:51]
    v_mfma_f32_16x16x32_bf16 v[48:51], v[152:155], v[16:19], v[48:51]
    v_mfma_f32_16x16x32_bf16 v[48:51], v[156:159], v[16:19], v[48:51]
    v_mfma_f32_16x16x32_bf16 v[48:51], v[160:163], v[16:19], v[48:51]
    v_mfma_f32_16x16x32_bf16 v[48:51], v[164:167], v[16:19], v[48:51]
    v_mfma_f32_16x16x32_bf16 v[48:51], v[168:171], v[16:19], v[48:51]
    v_mfma_f32_16x16x32_bf16 v[48:51], v[172:175], v[16:19], v[48:51]
    v_mfma_f32_16x16x32_bf16 v[48:51], v[176:179], v[16:19], v[48:51]
    v_mfma_f32_16x16x32_bf16 v[48:51], v[180:183], v[16:19], v[48:51]
    s_nop 7
    v_cndmask_b32 v244, v50, v48, vcc
    v_cndmask_b32 v246, v51, v49, vcc
    s_mov_b32 exec_lo, 0x30003
    s_mov_b32 exec_hi, 0x30003
    buffer_store_dwordx4 v[244:247], v241, s[60:63], s84 offen sc1
    s_mov_b64 exec, -1
Lsc_140:
    s_branch L_spare2
L_cload:
    s_lshl_b32 s88, s95, 8
    s_lshr_b32 s84, s70, 1
    s_mul_i32 s79, s84, 0
    s_lshl_b32 s84, s84, 3
    s_lshl_b32 s85, s73, 1
    s_add_u32 s0, s84, s85
    s_add_u32 s79, s79, s71
    s_cmp_ge_u32 s79, 7
    s_cselect_b32 s84, 7, 0
    s_sub_u32 s79, s79, s84
    s_bitcmp1_b32 s70, 0
    s_cselect_b32 s84, 0xc4000, 0
    s_add_u32 s84, s84, s78
    s_mul_i32 s36, s79, 0x1c000
    s_add_u32 s36, s36, s84
    s_add_u32 s79, s79, 1
    s_cmp_eq_u32 s79, 7
    s_cmov_b32 s79, 0
    s_mul_i32 s37, s79, 0x1c000
    s_add_u32 s37, s37, s84
    s_add_u32 s79, s79, 1
    s_cmp_eq_u32 s79, 7
    s_cmov_b32 s79, 0
    s_mul_i32 s38, s79, 0x1c000
    s_add_u32 s38, s38, s84
    s_add_u32 s79, s79, 1
    s_cmp_eq_u32 s79, 7
    s_cmov_b32 s79, 0
    s_mul_i32 s39, s79, 0x1c000
    s_add_u32 s39, s39, s84
    s_add_u32 s79, s79, 1
    s_cmp_eq_u32 s79, 7
    s_cmov_b32 s79, 0
    s_mul_i32 s40, s79, 0x1c000
    s_add_u32 s40, s40, s84
    s_add_u32 s79, s79, 1
    s_cmp_eq_u32 s79, 7
    s_cmov_b32 s79, 0
    s_mul_i32 s41, s79, 0x1c000
    s_add_u32 s41, s41, s84
    s_add_u32 s79, s79, 1
    s_cmp_eq_u32 s79, 7
    s_cmov_b32 s79, 0
    s_mul_i32 s42, s79, 0x1c000
    s_add_u32 s42, s42, s84
    s_lshl_b32 s84, s73, 10
    s_add_u32 s84, s84, 0x15000
    v_add_u32 v36, s84, v3
    s_mov_b32 s97, 0x61a80
    s_mov_b64 exec, 1
Lsp_141:
    ds_read_b32 v25, v23 offset:20
    s_sub_u32 s97, s97, 1
    s_waitcnt lgkmcnt(0)
    v_cmp_gt_u32 vcc, 4, v25
    s_cbranch_vccz Lsd_142
    s_sleep 1
    s_cmp_lg_u32 s97, 0
    s_cbranch_scc1 Lsp_141
Lsd_142:
    s_mov_b64 exec, -1
    s_and_b32 s84, s73, 2
    s_lshl_b32 s84, s84, 5
    s_and_b32 s85, s73, 1
    s_lshl_b32 s85, s85, 3
    s_or_b32 s84, s84, s85
    v_xor_b32 v240, s84, v7
    v_add_u32 v241, 0x7000, v240
    v_add_u32 v240, 0x0, v240
    ds_read_b64_tr_b16 v[128:129], v240 offset:0
    ds_read_b64_tr_b16 v[130:131], v240 offset:1024
    ds_read_b64_tr_b16 v[132:133], v240 offset:4096
    ds_read_b64_tr_b16 v[134:135], v240 offset:5120
    ds_read_b64_tr_b16 v[136:137], v240 offset:8192
    ds_read_b64_tr_b16 v[138:139], v240 offset:9216
    ds_read_b64_tr_b16 v[140:141], v240 offset:12288
    ds_read_b64_tr_b16 v[142:143], v240 offset:13312
    ds_read_b64_tr_b16 v[144:145], v240 offset:16384
    ds_read_b64_tr_b16 v[146:147], v240 offset:17408
    ds_read_b64_tr_b16 v[148:149], v240 offset:20480
    ds_read_b64_tr_b16 v[150:151], v240 offset:21504
    ds_read_b64_tr_b16 v[152:153], v240 offset:24576
    ds_read_b64_tr_b16 v[154:155], v240 offset:25600
    ds_read_b64_tr_b16 v[156:157], v241 offset:0
    ds_read_b64_tr_b16 v[158:159], v241 offset:1024
    ds_read_b64_tr_b16 v[160:161], v241 offset:4096
    ds_read_b64_tr_b16 v[162:163], v241 offset:5120
    ds_read_b64_tr_b16 v[164:165], v241 offset:8192
    ds_read_b64_tr_b16 v[166:167], v241 offset:9216
    ds_read_b64_tr_b16 v[168:169], v241 offset:12288
    ds_read_b64_tr_b16 v[170:171], v241 offset:13312
    ds_read_b64_tr_b16 v[172:173], v241 offset:16384
    ds_read_b64_tr_b16 v[174:175], v241 offset:17408
    ds_read_b64_tr_b16 v[176:177], v241 offset:20480
    ds_read_b64_tr_b16 v[178:179], v241 offset:21504
    ds_read_b64_tr_b16 v[180:181], v241 offset:24576
    ds_read_b64_tr_b16 v[182:183], v241 offset:25600
    s_waitcnt lgkmcnt(0)
    v_mfma_f32_16x16x32_bf16 v[48:51], v[128:131], v[16:19], 0
    v_mfma_f32_16x16x32_bf16 v[48:51], v[132:135], v[16:19], v[48:51]
    v_mfma_f32_16x16x32_bf16 v[48:51], v[136:139], v[16:19], v[48:51]
    v_mfma_f32_16x16x32_bf16 v[48:51], v[140:143], v[16:19], v[48:51]
    v_mfma_f32_16x16x32_bf16 v[48:51], v[144:147], v[16:19], v[48:51]
    v_mfma_f32_16x16x32_bf16 v[48:51], v[148:151], v[16:19], v[48:51]
    v_mfma_f32_16x16x32_bf16 v[48:51], v[152:155], v[16:19], v[48:51]
    v_mfma_f32_16x16x32_bf16 v[48:51], v[156:159], v[16:19], v[48:51]
    v_mfma_f32_16x16x32_bf16 v[48:51], v[160:163], v[16:19], v[48:51]
    v_mfma_f32_16x16x32_bf16 v[48:51], v[164:167], v[16:19], v[48:51]
    v_mfma_f32_16x16x32_bf16 v[48:51], v[168:171], v[16:19], v[48:51]
    v_mfma_f32_16x16x32_bf16 v[48:51], v[172:175], v[16:19], v[48:51]
    v_mfma_f32_16x16x32_bf16 v[48:51], v[176:179], v[16:19], v[48:51]
    v_mfma_f32_16x16x32_bf16 v[48:51], v[180:183], v[16:19], v[48:51]
    s_lshl_b32 s84, s73, 6
    s_add_u32 s84, s84, 0x27000
    v_lshl_add_u32 v240, v2, 4, s84
    s_mov_b32 exec_lo, 0x10001
    s_mov_b32 exec_hi, 0x10001
    s_nop 2
    ds_write_b128 v240, v[48:51]
    s_mov_b64 exec, -1
    s_mov_b64 exec, 1
    ds_add_u32 v23, v24 offset:60
    s_mov_b64 exec, -1
    s_mov_b32 s97, 0x61a80
    s_mov_b64 exec, 1
Lsp_143:
    ds_read_b32 v25, v23 offset:24
    s_sub_u32 s97, s97, 1
    s_waitcnt lgkmcnt(0)
    v_cmp_gt_u32 vcc, 2, v25
    s_cbranch_vccz Lsd_144
    s_sleep 1
    s_cmp_lg_u32 s97, 0
    s_cbranch_scc1 Lsp_143
Lsd_144:
    s_mov_b64 exec, -1
    s_mov_b32 s79, 0
    s_lshl_b32 s89, s73, 10
    s_add_u32 s89, s89, 0xe000
    s_mov_b32 s90, s88
    s_mov_b32 s97, 7
Ldma_145:
    s_lshl_b32 s91, s79, 12
    s_add_u32 m0, s91, s89
    s_mul_i32 s91, s79, 0x1c000
    s_add_u32 s91, s91, s90
    buffer_load_dwordx4 v6, s[24:27], s91 offen lds
    s_add_u32 s79, s79, 1
    s_sub_u32 s97, s97, 1
    s_cmp_lg_u32 s97, 0
    s_cbranch_scc1 Ldma_145
    s_mov_b32 s97, 0x61a80
    s_mov_b64 exec, 1
Lsp_146:
    ds_read_b32 v25, v23 offset:24
    s_sub_u32 s97, s97, 1
    s_waitcnt lgkmcnt(0)
    v_cmp_gt_u32 vcc, 4, v25
    s_cbranch_vccz Lsd_147
    s_sleep 1
    s_cmp_lg_u32 s97, 0
    s_cbranch_scc1 Lsp_146
Lsd_147:
    s_mov_b64 exec, -1
    ds_write_b128 v36, v[184:187] offset:0
    ds_write_b128 v36, v[188:191] offset:4096
    ds_write_b128 v36, v[192:195] offset:8192
    ds_write_b128 v36, v[196:199] offset:12288
    ds_write_b128 v36, v[200:203] offset:16384
    ds_write_b128 v36, v[204:207] offset:20480
    ds_write_b128 v36, v[208:211] offset:24576
    ds_write_b128 v36, v[212:215] offset:28672
    ds_write_b128 v36, v[216:219] offset:32768
    ds_write_b128 v36, v[220:223] offset:36864
    ds_write_b128 v36, v[224:227] offset:40960
    ds_write_b128 v36, v[228:231] offset:45056
    ds_write_b128 v36, v[232:235] offset:49152
    ds_write_b128 v36, v[236:239] offset:53248
    s_mov_b64 exec, 1
    ds_add_u32 v23, v24 offset:64
    s_mov_b64 exec, -1
    v_and_b32 v240, 3, v0
    v_and_b32 v241, 48, v0
    v_or_b32 v240, v240, v241
    v_lshlrev_b32 v240, 3, v240
    v_and_b32 v241, 4, v0
    v_lshl_add_u32 v240, v241, 4, v240
    v_and_b32 v241, 8, v0
    v_lshl_add_u32 v240, v241, 2, v240
    v_add_u32 v240, 0x27100, v240
    s_lshl_b32 s86, s88, 2
    s_add_u32 s86, s86, 0x1001000
    s_mov_b32 s97, 0x61a80
    s_mov_b64 exec, 1
Lsp_148:
    ds_read_b32 v25, v23 offset:28
    s_sub_u32 s97, s97, 1
    s_waitcnt lgkmcnt(0)
    v_cmp_gt_u32 vcc, 4, v25
    s_cbranch_vccz Lsd_149
    s_sleep 1
    s_cmp_lg_u32 s97, 0
    s_cbranch_scc1 Lsp_148
Lsd_149:
    s_mov_b64 exec, -1
    s_mov_b32 s97, 0x61a80
    s_mov_b64 exec, 1
Lsp_150:
    ds_read_b32 v25, v23 offset:32
    s_sub_u32 s97, s97, 1
    s_waitcnt lgkmcnt(0)
    v_cmp_gt_u32 vcc, 2, v25
    s_cbranch_vccz Lsd_151
    s_sleep 1
    s_cmp_lg_u32 s97, 0
    s_cbranch_scc1 Lsp_150
Lsd_151:
    s_mov_b64 exec, -1
    s_mov_b32 s79, 0
    s_lshl_b32 s89, s73, 10
    s_add_u32 s89, s89, 0x0
    s_add_u32 s90, s88, 0xc4000
    s_mov_b32 s97, 7
Ldma_152:
    s_lshl_b32 s91, s79, 12
    s_add_u32 m0, s91, s89
    s_mul_i32 s91, s79, 0x1c000
    s_add_u32 s91, s91, s90
    buffer_load_dwordx4 v6, s[24:27], s91 offen lds
    s_add_u32 s79, s79, 1
    s_sub_u32 s97, s97, 1
    s_cmp_lg_u32 s97, 0
    s_cbranch_scc1 Ldma_152
    s_cmp_lg_u32 s72, 5
    s_cbranch_scc1 Lcs_153
    s_mov_b32 s97, 0x9c40
Lpoll_154:
    buffer_load_dwordx4 v[244:247], v3, s[60:63], s86 offen sc1
    s_sub_u32 s97, s97, 1
    s_waitcnt vmcnt(0)
    v_xor_b32 v245, v15, v245
    v_xor_b32 v247, v15, v247
    v_or_b32 v245, v245, v247
    v_cmp_ne_u32 vcc, 0, v245
    s_cbranch_vccz Lpd_155
    s_sleep 4
    s_cmp_lg_u32 s97, 0
    s_cbranch_scc1 Lpoll_154
Lpd_155:
    ds_write2_b32 v240, v244, v246 offset0:0 offset1:1
Lcs_153:
    s_waitcnt vmcnt(0)
    s_mov_b64 exec, 1
    ds_add_u32 v23, v24 offset:68
    s_mov_b64 exec, -1
    s_mov_b32 s97, 0x61a80
    s_mov_b64 exec, 1
Lsp_156:
    ds_read_b32 v25, v23 offset:32
    s_sub_u32 s97, s97, 1
    s_waitcnt lgkmcnt(0)
    v_cmp_gt_u32 vcc, 4, v25
    s_cbranch_vccz Lsd_157
    s_sleep 1
    s_cmp_lg_u32 s97, 0
    s_cbranch_scc1 Lsp_156
Lsd_157:
    s_mov_b64 exec, -1
    s_mov_b32 s97, 0x61a80
    s_mov_b64 exec, 1
Lsp_158:
    ds_read_b32 v25, v23 offset:44
    s_sub_u32 s97, s97, 1
    s_waitcnt lgkmcnt(0)
    v_cmp_gt_u32 vcc, 2, v25
    s_cbranch_vccz Lsd_159
    s_sleep 1
    s_cmp_lg_u32 s97, 0
    s_cbranch_scc1 Lsp_158
Lsd_159:
    s_mov_b64 exec, -1
    s_mov_b32 s79, 0
    s_lshl_b32 s89, s73, 10
    s_add_u32 s89, s89, 0x7000
    s_add_u32 s90, s88, 0x80
    s_mov_b32 s97, 7
Ldma_160:
    s_lshl_b32 s91, s79, 12
    s_add_u32 m0, s91, s89
    s_mul_i32 s91, s79, 0x1c000
    s_add_u32 s91, s91, s90
    buffer_load_dwordx4 v6, s[24:27], s91 offen lds
    s_add_u32 s79, s79, 1
    s_sub_u32 s97, s97, 1
    s_cmp_lg_u32 s97, 0
    s_cbranch_scc1 Ldma_160
    s_mov_b32 s97, 0x61a80
    s_mov_b64 exec, 1
Lsp_161:
    ds_read_b32 v25, v23 offset:40
    s_sub_u32 s97, s97, 1
    s_waitcnt lgkmcnt(0)
    v_cmp_gt_u32 vcc, 4, v25
    s_cbranch_vccz Lsd_162
    s_sleep 1
    s_cmp_lg_u32 s97, 0
    s_cbranch_scc1 Lsp_161
Lsd_162:
    s_mov_b64 exec, -1
    s_mov_b32 s79, 0
    s_lshl_b32 s89, s73, 10
    s_add_u32 s89, s89, 0x15000
    s_add_u32 s90, s88, 0xc4080
    s_mov_b32 s97, 7
Ldma_163:
    s_lshl_b32 s91, s79, 12
    s_add_u32 m0, s91, s89
    s_mul_i32 s91, s79, 0x1c000
    s_add_u32 s91, s91, s90
    buffer_load_dwordx4 v6, s[24:27], s91 offen lds
    s_add_u32 s79, s79, 1
    s_sub_u32 s97, s97, 1
    s_cmp_lg_u32 s97, 0
    s_cbranch_scc1 Ldma_163
    v_mov_b32 v40, v6
    s_add_u32 s43, s88, 0xc4080
    v_lshrrev_b32 v6, 5, v0
    v_lshlrev_b32 v6, 6, v6
    v_add_u32 v6, 0x20000, v6
    v_and_b32 v9, 1, v2
    v_mul_u32_u24 v9, 0x3800, v9
    v_lshl_add_u32 v9, v1, 4, v9
    v_lshrrev_b32 v252, 5, v0
    v_lshl_add_u32 v9, v252, 8, v9
    s_lshl_b32 s84, s73, 12
    s_add_u32 s85, s84, 0x23000
    v_add_u32 v28, s85, v3
    s_add_u32 s85, s84, 0x1c000
    v_add_u32 v29, s85, v3
    s_lshl_b32 s84, s95, 10
    s_mul_i32 s86, s0, 0x3800
    s_add_u32 s86, s86, s74
    s_add_u32 s86, s86, 0xfe800
    s_add_u32 s86, s86, s84
    s_lshr_b32 s85, s0, 1
    s_mul_i32 s90, s85, 0x80
    s_add_u32 s90, s90, s74
    s_add_u32 s90, s90, 0xe8800
    s_lshl_b32 s84, s95, 2
    s_add_u32 s87, s90, s84
    s_and_b32 s88, s70, 1
    s_mul_i32 s88, s88, 28
    s_and_b32 s85, s85, 4
    s_mul_i32 s84, s85, 0x80
    s_add_u32 s84, s84, s74
    s_add_u32 s84, s84, 0xe8800
    s_add_u32 s84, s84, s88
    v_min_u32 v38, 6, v1
    v_lshl_add_u32 v38, v38, 2, s84
    v_lshl_add_u32 v38, v2, 7, v38
    v_lshrrev_b32 v240, 5, v0
    v_mul_u32_u24 v240, 3, v240
    s_sub_u32 s84, s0, 1
    v_add_u32 v240, s84, v240
    v_max_i32 v240, 0, v240
    v_min_i32 v240, 15, v240
    v_min_u32 v241, 6, v1
    v_lshlrev_b32 v241, 8, v241
    v_lshl_add_u32 v240, v240, 11, v241
    s_add_u32 s84, s74, 0xf1004
    v_add_u32 v30, s84, v240
    s_lshl_b32 s89, s73, 10
    s_mul_i32 s58, s0, 0x800
    s_add_u32 s58, s58, s74
    s_add_u32 s58, s58, 0xf1000
    v_and_b32 v34, 1, v2
    v_lshlrev_b32 v34, 11, v34
    v_lshl_add_u32 v34, v1, 4, v34
    v_lshrrev_b32 v240, 5, v0
    v_lshl_add_u32 v33, v240, 8, v34
    v_cvt_f32_u32 v35, v240
    v_sub_f32 v35, 1.0, v35
    v_mov_b32 v16, 0x27510
    v_mov_b32 v17, 1
    s_mov_b32 s97, 0x61a80
    s_mov_b64 exec, 1
Lsp_164:
    ds_read_b32 v18, v16 offset:68
    s_sub_u32 s97, s97, 1
    s_waitcnt lgkmcnt(0)
    v_cmp_gt_u32 vcc, 4, v18
    s_cbranch_vccz Lsd_165
    s_sleep 1
    s_cmp_lg_u32 s97, 0
    s_cbranch_scc1 Lsp_164
Lsd_165:
    s_mov_b64 exec, -1
    ds_read_b128 v[96:99], v6 offset:29056
    ds_read_b128 v[100:103], v6 offset:29072
    ds_read_b128 v[104:107], v6 offset:29088
    ds_read_b128 v[108:111], v6 offset:29104
    ds_read_b128 v[112:115], v6 offset:29312
    ds_read_b128 v[116:119], v6 offset:29328
    ds_read_b128 v[120:123], v6 offset:29344
    ds_read_b128 v[124:127], v6 offset:29360
    s_lshl_b32 s84, s73, 2
    v_add_u32 v19, s84, v16
    s_mov_b32 s97, 0x61a80
    s_mov_b64 exec, 1
Lsp_166:
    ds_read_b32 v18, v16 offset:44
    s_sub_u32 s97, s97, 1
    s_waitcnt lgkmcnt(0)
    v_cmp_gt_u32 vcc, 4, v18
    s_cbranch_vccz Lsd_167
    s_sleep 1
    s_cmp_lg_u32 s97, 0
    s_cbranch_scc1 Lsp_166
Lsd_167:
    s_mov_b64 exec, -1
    s_waitcnt vmcnt(0)
    s_mov_b64 exec, 1
    ds_add_u32 v16, v17 offset:72
    s_mov_b64 exec, -1
    s_mov_b32 s97, 0x61a80
    s_mov_b64 exec, 1
Lsp_168:
    ds_read_b32 v18, v19 offset:128
    s_sub_u32 s97, s97, 1
    s_waitcnt lgkmcnt(0)
    v_cmp_gt_u32 vcc, 1, v18
    s_cbranch_vccz Lsd_169
    s_sleep 2
    s_cmp_lg_u32 s97, 0
    s_cbranch_scc1 Lsp_168
Lsd_169:
    s_mov_b64 exec, -1
    buffer_load_dword v31, v30, s[60:63], 0 offen sc1
    s_mov_b32 s97, 0x9c40
Lpoll_170:
    buffer_load_dwordx4 v[64:67], v33, s[60:63], s58 offen offset:0 sc1
    buffer_load_dwordx4 v[68:71], v33, s[60:63], s58 offen offset:512 sc1
    buffer_load_dwordx4 v[72:75], v33, s[60:63], s58 offen offset:1024 sc1
    buffer_load_dwordx4 v[76:79], v34, s[60:63], s58 offen offset:1536 sc1
    s_sub_u32 s97, s97, 1
    s_waitcnt vmcnt(0)
    v_mov_b32 v240, v15
    v_mov_b32 v241, v15
    v_min3_u32 v240, v240, v65, v67
    v_max3_u32 v241, v241, v65, v67
    v_min3_u32 v240, v240, v69, v71
    v_max3_u32 v241, v241, v69, v71
    v_min3_u32 v240, v240, v73, v75
    v_max3_u32 v241, v241, v73, v75
    v_min3_u32 v240, v240, v77, v79
    v_max3_u32 v241, v241, v77, v79
    v_cmp_ne_u32 vcc, v240, v241
    s_cbranch_vccz Lpd_171
    s_cmp_lg_u32 s97, 0
    s_cbranch_scc1 Lpoll_170
Lpd_171:
    v_add_f32 v64, v64, v68
    v_add_f32 v64, v64, v72
    v_fmac_f32 v64, v76, v35
    v_mov_b32 v65, v64
    s_nop 1
    v_permlane32_swap_b32 v64, v65
    v_add_f32 v64, v64, v65
    v_add_f32 v66, v66, v70
    v_add_f32 v66, v66, v74
    v_fmac_f32 v66, v78, v35
    v_mov_b32 v67, v66
    s_nop 1
    v_permlane32_swap_b32 v66, v67
    v_add_f32 v66, v66, v67
    v_mul_f32 v20, 0x3b124925, v64
    v_mul_f32 v247, 0x3b124925, v66
    v_fma_f32 v247, -v20, v20, v247
    v_max_f32 v247, 0, v247
    v_add_f32 v248, 0x3727c5ac, v247
    v_rsq_f32 v248, v248
    v_sub_f32 v20, 0, v20
    v_rcp_f32 v23, v248
    v_mul_f32 v22, v248, v248
    v_mul_f32 v21, 0xc0135761, v248
    v_mul_f32 v22, v22, v248
    v_mul_f32 v22, 0xbdd2d3e8, v22
    s_add_u32 s84, s89, 0x20000
    v_add_u32 v240, s84, v3
    ds_write_b128 v240, v[20:23]
    s_add_u32 s84, s75, 0
    s_mov_b32 s97, 0x9c40
Lrl_173:
    v_subrev_u32 v31, s84, v31
    v_cmp_le_u32 vcc, 4, v31
    s_cbranch_vccz Lrk_172
    s_sub_u32 s97, s97, 1
    s_cmp_eq_u32 s97, 0
    s_cbranch_scc1 Lrk_172
    s_sleep 1
    buffer_load_dword v31, v30, s[60:63], 0 offen sc1
    s_waitcnt vmcnt(0)
    s_branch Lrl_173
Lrk_172:
    s_mov_b64 exec, 1
    ds_add_u32 v19, v17 offset:144
    s_mov_b64 exec, -1
    s_mov_b32 s97, 0x61a80
    s_mov_b64 exec, 1
Lsp_174:
    ds_read_b32 v18, v16 offset:76
    s_sub_u32 s97, s97, 1
    s_waitcnt lgkmcnt(0)
    v_cmp_gt_u32 vcc, 4, v18
    s_cbranch_vccz Lsd_175
    s_sleep 1
    s_cmp_lg_u32 s97, 0
    s_cbranch_scc1 Lsp_174
Lsd_175:
    s_mov_b64 exec, -1
    s_add_u32 s91, s36, 0x0
    buffer_load_dwordx4 v[212:215], v44, s[28:31], s91 offen
    s_add_u32 s91, s37, 0x0
    buffer_load_dwordx4 v[216:219], v44, s[28:31], s91 offen
    s_add_u32 s91, s38, 0x0
    buffer_load_dwordx4 v[220:223], v44, s[28:31], s91 offen
    s_add_u32 s91, s39, 0x0
    buffer_load_dwordx4 v[224:227], v44, s[28:31], s91 offen
    s_add_u32 s91, s40, 0x0
    buffer_load_dwordx4 v[228:231], v44, s[28:31], s91 offen
    s_add_u32 s91, s41, 0x0
    buffer_load_dwordx4 v[232:235], v44, s[28:31], s91 offen
    s_add_u32 s91, s42, 0x0
    buffer_load_dwordx4 v[236:239], v44, s[28:31], s91 offen
    s_add_u32 s91, s36, 0x7000
    buffer_load_dwordx4 v[184:187], v44, s[28:31], s91 offen
    s_add_u32 s91, s37, 0x7000
    buffer_load_dwordx4 v[188:191], v44, s[28:31], s91 offen
    s_add_u32 s91, s38, 0x7000
    buffer_load_dwordx4 v[192:195], v44, s[28:31], s91 offen
    s_add_u32 s91, s39, 0x7000
    buffer_load_dwordx4 v[196:199], v44, s[28:31], s91 offen
    s_add_u32 s91, s40, 0x7000
    buffer_load_dwordx4 v[200:203], v44, s[28:31], s91 offen
    s_add_u32 s91, s41, 0x7000
    buffer_load_dwordx4 v[204:207], v44, s[28:31], s91 offen
    s_add_u32 s91, s42, 0x7000
    buffer_load_dwordx4 v[208:211], v44, s[28:31], s91 offen
    s_mov_b32 s97, 0x61a80
    s_mov_b64 exec, 1
Lsp_176:
    ds_read_b32 v18, v19 offset:128
    s_sub_u32 s97, s97, 1
    s_waitcnt lgkmcnt(0)
    v_cmp_gt_u32 vcc, 2, v18
    s_cbranch_vccz Lsd_177
    s_sleep 1
    s_cmp_lg_u32 s97, 0
    s_cbranch_scc1 Lsp_176
Lsd_177:
    s_mov_b64 exec, -1
    ds_read_b128 v[64:67], v29 offset:0
    ds_read_b128 v[68:71], v29 offset:1024
    ds_read_b128 v[72:75], v29 offset:2048
    ds_read_b128 v[76:79], v29 offset:3072
    s_mov_b64 exec, 1
    ds_add_u32 v19, v17 offset:144
    s_mov_b64 exec, -1
    s_mov_b32 s97, 0x61a80
    s_mov_b64 exec, 1
Lsp_178:
    ds_read_b32 v18, v16 offset:84
    s_sub_u32 s97, s97, 1
    s_waitcnt lgkmcnt(0)
    v_cmp_gt_u32 vcc, 4, v18
    s_cbranch_vccz Lsd_179
    s_sleep 1
    s_cmp_lg_u32 s97, 0
    s_cbranch_scc1 Lsp_178
Lsd_179:
    s_mov_b64 exec, -1
    v_add_u32 v39, 0xffff9000, v36
    s_waitcnt vmcnt(7)
    ds_write_b128 v39, v[212:215] offset:0
    ds_write_b128 v39, v[216:219] offset:4096
    ds_write_b128 v39, v[220:223] offset:8192
    ds_write_b128 v39, v[224:227] offset:12288
    ds_write_b128 v39, v[228:231] offset:16384
    ds_write_b128 v39, v[232:235] offset:20480
    ds_write_b128 v39, v[236:239] offset:24576
    s_waitcnt lgkmcnt(0)
    v_fmac_f32 v64, v96, v20
    v_fmac_f32 v65, v97, v20
    s_add_u32 s91, s36, 0xe000
    buffer_load_dwordx4 v[156:159], v44, s[28:31], s91 offen
    v_fmac_f32 v66, v98, v20
    v_fmac_f32 v67, v99, v20
    v_fmac_f32 v68, v100, v20
    v_fmac_f32 v69, v101, v20
    v_fmac_f32 v70, v102, v20
    v_fmac_f32 v71, v103, v20
    s_add_u32 s91, s37, 0xe000
    buffer_load_dwordx4 v[160:163], v44, s[28:31], s91 offen
    v_fmac_f32 v72, v104, v20
    v_fmac_f32 v73, v105, v20
    v_fmac_f32 v74, v106, v20
    v_fmac_f32 v75, v107, v20
    v_fmac_f32 v76, v108, v20
    v_fmac_f32 v77, v109, v20
    s_add_u32 s91, s38, 0xe000
    buffer_load_dwordx4 v[164:167], v44, s[28:31], s91 offen
    v_fmac_f32 v78, v110, v20
    v_fmac_f32 v79, v111, v20
    v_mul_f32 v48, v64, v64
    v_mul_f32 v49, v65, v65
    v_mul_f32 v50, v66, v66
    v_mul_f32 v51, v67, v67
    s_add_u32 s91, s39, 0xe000
    buffer_load_dwordx4 v[168:171], v44, s[28:31], s91 offen
    v_mul_f32 v52, v68, v68
    v_mul_f32 v53, v69, v69
    v_mul_f32 v54, v70, v70
    v_mul_f32 v55, v71, v71
    v_mul_f32 v56, v72, v72
    v_mul_f32 v57, v73, v73
    s_add_u32 s91, s40, 0xe000
    buffer_load_dwordx4 v[172:175], v44, s[28:31], s91 offen
    v_mul_f32 v58, v74, v74
    v_mul_f32 v59, v75, v75
    v_mul_f32 v60, v76, v76
    v_mul_f32 v61, v77, v77
    v_mul_f32 v62, v78, v78
    v_mul_f32 v63, v79, v79
    s_add_u32 s91, s41, 0xe000
    buffer_load_dwordx4 v[176:179], v44, s[28:31], s91 offen
    v_fma_f32 v48, v48, v22, v21
    v_fma_f32 v49, v49, v22, v21
    v_fma_f32 v50, v50, v22, v21
    v_fma_f32 v51, v51, v22, v21
    v_fma_f32 v52, v52, v22, v21
    v_fma_f32 v53, v53, v22, v21
    s_add_u32 s91, s42, 0xe000
    buffer_load_dwordx4 v[180:183], v44, s[28:31], s91 offen
    v_fma_f32 v54, v54, v22, v21
    v_fma_f32 v55, v55, v22, v21
    v_fma_f32 v56, v56, v22, v21
    v_fma_f32 v57, v57, v22, v21
    v_fma_f32 v58, v58, v22, v21
    v_fma_f32 v59, v59, v22, v21
    v_fma_f32 v60, v60, v22, v21
    v_fma_f32 v61, v61, v22, v21
    v_fma_f32 v62, v62, v22, v21
    v_fma_f32 v63, v63, v22, v21
    v_mul_f32 v48, v48, v64
    v_mul_f32 v49, v49, v65
    v_mul_f32 v50, v50, v66
    v_mul_f32 v51, v51, v67
    v_mul_f32 v52, v52, v68
    v_mul_f32 v53, v53, v69
    v_mul_f32 v54, v54, v70
    v_mul_f32 v55, v55, v71
    v_mul_f32 v56, v56, v72
    v_mul_f32 v57, v57, v73
    v_mul_f32 v58, v58, v74
    v_mul_f32 v59, v59, v75
    v_mul_f32 v60, v60, v76
    v_mul_f32 v61, v61, v77
    v_mul_f32 v62, v62, v78
    v_mul_f32 v63, v63, v79
    v_exp_f32 v48, v48
    v_exp_f32 v49, v49
    v_exp_f32 v50, v50
    v_exp_f32 v51, v51
    v_exp_f32 v52, v52
    v_exp_f32 v53, v53
    v_exp_f32 v54, v54
    v_exp_f32 v55, v55
    v_exp_f32 v56, v56
    v_exp_f32 v57, v57
    v_exp_f32 v58, v58
    v_exp_f32 v59, v59
    v_exp_f32 v60, v60
    v_exp_f32 v61, v61
    v_exp_f32 v62, v62
    v_exp_f32 v63, v63
    v_fma_f32 v48, v48, v23, v23
    v_fma_f32 v49, v49, v23, v23
    v_fma_f32 v50, v50, v23, v23
    v_fma_f32 v51, v51, v23, v23
    v_fma_f32 v52, v52, v23, v23
    v_fma_f32 v53, v53, v23, v23
    v_fma_f32 v54, v54, v23, v23
    v_fma_f32 v55, v55, v23, v23
    v_fma_f32 v56, v56, v23, v23
    v_fma_f32 v57, v57, v23, v23
    v_fma_f32 v58, v58, v23, v23
    v_fma_f32 v59, v59, v23, v23
    v_fma_f32 v60, v60, v23, v23
    v_fma_f32 v61, v61, v23, v23
    v_fma_f32 v62, v62, v23, v23
    v_fma_f32 v63, v63, v23, v23
    v_rcp_f32 v48, v48
    v_rcp_f32 v49, v49
    v_rcp_f32 v50, v50
    v_rcp_f32 v51, v51
    v_rcp_f32 v52, v52
    v_rcp_f32 v53, v53
    v_rcp_f32 v54, v54
    v_rcp_f32 v55, v55
    v_rcp_f32 v56, v56
    v_rcp_f32 v57, v57
    v_rcp_f32 v58, v58
    v_rcp_f32 v59, v59
    v_rcp_f32 v60, v60
    v_rcp_f32 v61, v61
    v_rcp_f32 v62, v62
    v_rcp_f32 v63, v63
    v_mul_f32 v64, v64, v48
    v_mul_f32 v65, v65, v49
    v_mul_f32 v66, v66, v50
    v_mul_f32 v67, v67, v51
    v_mul_f32 v68, v68, v52
    v_mul_f32 v69, v69, v53
    v_mul_f32 v70, v70, v54
    v_mul_f32 v71, v71, v55
    v_mul_f32 v72, v72, v56
    v_mul_f32 v73, v73, v57
    v_mul_f32 v74, v74, v58
    v_mul_f32 v75, v75, v59
    v_mul_f32 v76, v76, v60
    v_mul_f32 v77, v77, v61
    v_mul_f32 v78, v78, v62
    v_mul_f32 v79, v79, v63
    v_cvt_pk_bf16_f32 v240, v64, v65
    v_cvt_pk_bf16_f32 v241, v66, v67
    v_cvt_pk_bf16_f32 v242, v68, v69
    v_cvt_pk_bf16_f32 v243, v70, v71
    v_cvt_pk_bf16_f32 v244, v72, v73
    v_cvt_pk_bf16_f32 v245, v74, v75
    v_cvt_pk_bf16_f32 v246, v76, v77
    v_cvt_pk_bf16_f32 v247, v78, v79
    buffer_store_dwordx4 v[240:243], v9, s[60:63], s86 offen sc1
    buffer_store_dwordx4 v[244:247], v9, s[60:63], s86 offen offset:512 sc1
    v_add_u32 v39, 0xfffeb000, v36
    s_waitcnt vmcnt(9)
    ds_write_b128 v39, v[184:187] offset:0
    ds_write_b128 v39, v[188:191] offset:4096
    ds_write_b128 v39, v[192:195] offset:8192
    ds_write_b128 v39, v[196:199] offset:12288
    ds_write_b128 v39, v[200:203] offset:16384
    ds_write_b128 v39, v[204:207] offset:20480
    ds_write_b128 v39, v[208:211] offset:24576
    s_add_u32 s86, s86, 0x38000
    s_mov_b64 exec, 1
    ds_add_u32 v16, v17 offset:108
    s_mov_b64 exec, -1
    v_add_u32 v32, 0, v15
    s_waitcnt vmcnt(0)
    s_cmp_eq_u32 s77, 1
    s_cbranch_scc0 Lsl_180
    s_mov_b64 exec, 1
    buffer_store_dword v32, off, s[60:63], s87
    s_mov_b64 exec, -1
    s_branch Lse_181
Lsl_180:
    s_mov_b64 exec, 1
    buffer_store_dword v32, off, s[60:63], s87 sc1
    s_mov_b64 exec, -1
Lse_181:
    s_add_u32 s91, s36, 0x15000
    buffer_load_dwordx4 v[128:131], v44, s[28:31], s91 offen
    s_add_u32 s91, s37, 0x15000
    buffer_load_dwordx4 v[132:135], v44, s[28:31], s91 offen
    s_add_u32 s91, s38, 0x15000
    buffer_load_dwordx4 v[136:139], v44, s[28:31], s91 offen
    s_add_u32 s91, s39, 0x15000
    buffer_load_dwordx4 v[140:143], v44, s[28:31], s91 offen
    s_add_u32 s91, s40, 0x15000
    buffer_load_dwordx4 v[144:147], v44, s[28:31], s91 offen
    s_add_u32 s91, s41, 0x15000
    buffer_load_dwordx4 v[148:151], v44, s[28:31], s91 offen
    s_add_u32 s91, s42, 0x15000
    buffer_load_dwordx4 v[152:155], v44, s[28:31], s91 offen
    s_mov_b32 s97, 0x61a80
    s_mov_b64 exec, 1
Lsp_182:
    ds_read_b32 v18, v19 offset:128
    s_sub_u32 s97, s97, 1
    s_waitcnt lgkmcnt(0)
    v_cmp_gt_u32 vcc, 3, v18
    s_cbranch_vccz Lsd_183
    s_sleep 1
    s_cmp_lg_u32 s97, 0
    s_cbranch_scc1 Lsp_182
Lsd_183:
    s_mov_b64 exec, -1
    ds_read_b128 v[64:67], v29 offset:0
    ds_read_b128 v[68:71], v29 offset:1024
    ds_read_b128 v[72:75], v29 offset:2048
    ds_read_b128 v[76:79], v29 offset:3072
    s_mov_b32 s97, 0x61a80
    s_mov_b64 exec, 1
Lsp_184:
    ds_read_b32 v18, v16 offset:92
    s_sub_u32 s97, s97, 1
    s_waitcnt lgkmcnt(0)
    v_cmp_gt_u32 vcc, 4, v18
    s_cbranch_vccz Lsd_185
    s_sleep 1
    s_cmp_lg_u32 s97, 0
    s_cbranch_scc1 Lsp_184
Lsd_185:
    s_mov_b64 exec, -1
    v_add_u32 v39, 0xffff2000, v36
    ds_write_b128 v39, v[156:159] offset:0
    ds_write_b128 v39, v[160:163] offset:4096
    ds_write_b128 v39, v[164:167] offset:8192
    ds_write_b128 v39, v[168:171] offset:12288
    ds_write_b128 v39, v[172:175] offset:16384
    ds_write_b128 v39, v[176:179] offset:20480
    ds_write_b128 v39, v[180:183] offset:24576
    s_waitcnt lgkmcnt(0)
    v_fmac_f32 v64, v112, v20
    v_fmac_f32 v65, v113, v20
    v_fmac_f32 v66, v114, v20
    v_fmac_f32 v67, v115, v20
    v_fmac_f32 v68, v116, v20
    v_fmac_f32 v69, v117, v20
    v_fmac_f32 v70, v118, v20
    v_fmac_f32 v71, v119, v20
    v_fmac_f32 v72, v120, v20
    v_fmac_f32 v73, v121, v20
    v_fmac_f32 v74, v122, v20
    v_fmac_f32 v75, v123, v20
    v_fmac_f32 v76, v124, v20
    v_fmac_f32 v77, v125, v20
    v_fmac_f32 v78, v126, v20
    v_fmac_f32 v79, v127, v20
    v_mul_f32 v48, v64, v64
    v_mul_f32 v49, v65, v65
    v_mul_f32 v50, v66, v66
    v_mul_f32 v51, v67, v67
    v_mul_f32 v52, v68, v68
    v_mul_f32 v53, v69, v69
    v_mul_f32 v54, v70, v70
    v_mul_f32 v55, v71, v71
    v_mul_f32 v56, v72, v72
    v_mul_f32 v57, v73, v73
    v_mul_f32 v58, v74, v74
    v_mul_f32 v59, v75, v75
    v_mul_f32 v60, v76, v76
    v_mul_f32 v61, v77, v77
    v_mul_f32 v62, v78, v78
    v_mul_f32 v63, v79, v79
    v_fma_f32 v48, v48, v22, v21
    v_fma_f32 v49, v49, v22, v21
    v_fma_f32 v50, v50, v22, v21
    v_fma_f32 v51, v51, v22, v21
    v_fma_f32 v52, v52, v22, v21
    v_fma_f32 v53, v53, v22, v21
    v_fma_f32 v54, v54, v22, v21
    v_fma_f32 v55, v55, v22, v21
    v_fma_f32 v56, v56, v22, v21
    v_fma_f32 v57, v57, v22, v21
    v_fma_f32 v58, v58, v22, v21
    v_fma_f32 v59, v59, v22, v21
    v_fma_f32 v60, v60, v22, v21
    v_fma_f32 v61, v61, v22, v21
    v_fma_f32 v62, v62, v22, v21
    v_fma_f32 v63, v63, v22, v21
    v_mul_f32 v48, v48, v64
    v_mul_f32 v49, v49, v65
    v_mul_f32 v50, v50, v66
    v_mul_f32 v51, v51, v67
    v_mul_f32 v52, v52, v68
    v_mul_f32 v53, v53, v69
    v_mul_f32 v54, v54, v70
    v_mul_f32 v55, v55, v71
    v_mul_f32 v56, v56, v72
    v_mul_f32 v57, v57, v73
    v_mul_f32 v58, v58, v74
    v_mul_f32 v59, v59, v75
    v_mul_f32 v60, v60, v76
    v_mul_f32 v61, v61, v77
    v_mul_f32 v62, v62, v78
    v_mul_f32 v63, v63, v79
    v_exp_f32 v48, v48
    v_exp_f32 v49, v49
    v_exp_f32 v50, v50
    v_exp_f32 v51, v51
    v_exp_f32 v52, v52
    v_exp_f32 v53, v53
    v_exp_f32 v54, v54
    v_exp_f32 v55, v55
    v_exp_f32 v56, v56
    v_exp_f32 v57, v57
    v_exp_f32 v58, v58
    v_exp_f32 v59, v59
    v_exp_f32 v60, v60
    v_exp_f32 v61, v61
    v_exp_f32 v62, v62
    v_exp_f32 v63, v63
    v_fma_f32 v48, v48, v23, v23
    v_fma_f32 v49, v49, v23, v23
    v_fma_f32 v50, v50, v23, v23
    v_fma_f32 v51, v51, v23, v23
    v_fma_f32 v52, v52, v23, v23
    v_fma_f32 v53, v53, v23, v23
    v_fma_f32 v54, v54, v23, v23
    v_fma_f32 v55, v55, v23, v23
    v_fma_f32 v56, v56, v23, v23
    v_fma_f32 v57, v57, v23, v23
    v_fma_f32 v58, v58, v23, v23
    v_fma_f32 v59, v59, v23, v23
    v_fma_f32 v60, v60, v23, v23
    v_fma_f32 v61, v61, v23, v23
    v_fma_f32 v62, v62, v23, v23
    v_fma_f32 v63, v63, v23, v23
    v_rcp_f32 v48, v48
    v_rcp_f32 v49, v49
    v_rcp_f32 v50, v50
    v_rcp_f32 v51, v51
    v_rcp_f32 v52, v52
    v_rcp_f32 v53, v53
    v_rcp_f32 v54, v54
    v_rcp_f32 v55, v55
    v_rcp_f32 v56, v56
    v_rcp_f32 v57, v57
    v_rcp_f32 v58, v58
    v_rcp_f32 v59, v59
    v_rcp_f32 v60, v60
    v_rcp_f32 v61, v61
    v_rcp_f32 v62, v62
    v_rcp_f32 v63, v63
    v_mul_f32 v64, v64, v48
    v_mul_f32 v65, v65, v49
    v_mul_f32 v66, v66, v50
    v_mul_f32 v67, v67, v51
    v_mul_f32 v68, v68, v52
    v_mul_f32 v69, v69, v53
    v_mul_f32 v70, v70, v54
    v_mul_f32 v71, v71, v55
    v_mul_f32 v72, v72, v56
    v_mul_f32 v73, v73, v57
    v_mul_f32 v74, v74, v58
    v_mul_f32 v75, v75, v59
    v_mul_f32 v76, v76, v60
    v_mul_f32 v77, v77, v61
    v_mul_f32 v78, v78, v62
    v_mul_f32 v79, v79, v63
    v_cvt_pk_bf16_f32 v240, v64, v65
    v_cvt_pk_bf16_f32 v241, v66, v67
    v_cvt_pk_bf16_f32 v242, v68, v69
    v_cvt_pk_bf16_f32 v243, v70, v71
    v_cvt_pk_bf16_f32 v244, v72, v73
    v_cvt_pk_bf16_f32 v245, v74, v75
    v_cvt_pk_bf16_f32 v246, v76, v77
    v_cvt_pk_bf16_f32 v247, v78, v79
    buffer_store_dwordx4 v[240:243], v9, s[60:63], s86 offen sc1
    buffer_store_dwordx4 v[244:247], v9, s[60:63], s86 offen offset:512 sc1
    v_add_u32 v39, 0x0, v36
    s_waitcnt vmcnt(2)
    ds_write_b128 v39, v[128:131] offset:0
    ds_write_b128 v39, v[132:135] offset:4096
    ds_write_b128 v39, v[136:139] offset:8192
    ds_write_b128 v39, v[140:143] offset:12288
    ds_write_b128 v39, v[144:147] offset:16384
    ds_write_b128 v39, v[148:151] offset:20480
    ds_write_b128 v39, v[152:155] offset:24576
    s_mov_b64 exec, 1
    ds_add_u32 v16, v17 offset:104
    s_mov_b64 exec, -1
    v_add_u32 v32, 1, v15
    s_waitcnt vmcnt(0)
    s_cmp_eq_u32 s77, 1
    s_cbranch_scc0 Lsl_186
    s_mov_b64 exec, 1
    buffer_store_dword v32, off, s[60:63], s87
    s_mov_b64 exec, -1
    s_branch Lse_187
Lsl_186:
    s_mov_b64 exec, 1
    buffer_store_dword v32, off, s[60:63], s87 sc1
    s_mov_b64 exec, -1
Lse_187:
    s_mov_b32 s97, 0x61a80
    s_mov_b64 exec, 1
Lsp_188:
    ds_read_b32 v18, v19 offset:128
    s_sub_u32 s97, s97, 1
    s_waitcnt lgkmcnt(0)
    v_cmp_gt_u32 vcc, 4, v18
    s_cbranch_vccz Lsd_189
    s_sleep 1
    s_cmp_lg_u32 s97, 0
    s_cbranch_scc1 Lsp_188
Lsd_189:
    s_mov_b64 exec, -1
    v_add_u32 v32, 2, v15
    s_cmp_eq_u32 s77, 1
    s_cbranch_scc0 Lsl_190
    s_mov_b64 exec, 1
    buffer_store_dword v32, off, s[60:63], s87
    s_mov_b64 exec, -1
    s_branch Lse_191
Lsl_190:
    s_mov_b64 exec, 1
    buffer_store_dword v32, off, s[60:63], s87 sc1
    s_mov_b64 exec, -1
Lse_191:
    buffer_load_dword v31, v38, s[60:63], 0 offen sc1
    s_add_u32 s84, s75, 2
    s_waitcnt vmcnt(0)
    s_mov_b32 s97, 0x9c40
Lrl_193:
    v_subrev_u32 v31, s84, v31
    v_cmp_le_u32 vcc, 4, v31
    s_cbranch_vccz Lrk_192
    s_sub_u32 s97, s97, 1
    s_cmp_eq_u32 s97, 0
    s_cbranch_scc1 Lrk_192
    s_sleep 1
    buffer_load_dword v31, v38, s[60:63], 0 offen sc1
    s_waitcnt vmcnt(0)
    s_branch Lrl_193
Lrk_192:
    s_mov_b64 exec, 1
    ds_add_u32 v19, v17 offset:144
    s_mov_b64 exec, -1
    s_waitcnt lgkmcnt(0)
    s_endpgm
L_spare2a:
    s_waitcnt vmcnt(0)
    s_cmp_eq_u32 s77, 1
    s_cbranch_scc0 Lsl_194
    s_mov_b64 exec, 1
    buffer_store_dword v15, off, s[60:63], s59
    buffer_store_dword v15, off, s[60:63], s59 offset:128
    s_mov_b64 exec, -1
    s_branch Lse_195
Lsl_194:
    s_mov_b64 exec, 1
    buffer_store_dword v15, off, s[60:63], s59 sc1
    buffer_store_dword v15, off, s[60:63], s59 offset:128 sc1
    s_mov_b64 exec, -1
Lse_195:
    s_cmp_lg_u32 s2, 0xff
    s_cbranch_scc1 Lep_196
    s_cmp_lg_u32 s72, 0
    s_cbranch_scc1 Lep_196
    v_lshrrev_b32 v240, 3, v0
    v_lshlrev_b32 v240, 21, v240
    v_and_b32 v241, 7, v0
    v_lshl_add_u32 v240, v241, 7, v240
    s_mov_b32 s84, 0xfd800
    s_mov_b32 s97, 0x9c40
Lpoll_197:
    buffer_load_dword v244, v240, s[60:63], s84 offen offset:0 sc1
    buffer_load_dword v245, v240, s[60:63], s84 offen offset:1024 sc1
    buffer_load_dword v246, v240, s[60:63], s84 offen offset:2048 sc1
    buffer_load_dword v247, v240, s[60:63], s84 offen offset:3072 sc1
    s_waitcnt vmcnt(0)
    v_subrev_u32 v244, s75, v244
    v_subrev_u32 v245, s75, v245
    v_subrev_u32 v246, s75, v246
    v_subrev_u32 v247, s75, v247
    v_max_u32 v244, v244, v245
    v_max3_u32 v244, v244, v246, v247
    v_cmp_le_u32 vcc, 16, v244
    s_cbranch_vccz Lpd_198
    s_sleep 2
    s_sub_u32 s97, s97, 1
    s_cmp_lg_u32 s97, 0
    s_cbranch_scc1 Lpoll_197
Lpd_198:
    s_mov_b32 s84, 0x1000000
    s_mov_b64 exec, 1
    buffer_store_dword v15, off, s[60:63], s84 sc1
    s_mov_b64 exec, -1
Lep_196:
    s_waitcnt vmcnt(0)
    s_barrier
L_spare2:
    s_sub_u32 s84, s69, 28
    s_lshl_b32 s85, s72, 2
    s_add_u32 s84, s84, s85
    s_lshl_b32 s84, s84, 13
    v_lshl_add_u32 v248, v0, 7, s84
    v_mov_b32 v249, 0x40000000
    v_lshlrev_b32 v250, 1, v248
    v_cmp_gt_u32 vcc, 0x44000, v250
    s_nop 1
    v_cndmask_b32 v252, v249, v250, vcc
    s_mov_b32 s84, 0x0
    buffer_load_dword v254, v250, s[24:27], s84 offen
    s_add_u32 s84, s84, 0x80000
    buffer_load_dword v254, v252, s[24:27], s84 offen
    s_barrier
    s_cmp_lg_u32 s69, 31
    s_cbranch_scc1 Lrl_199
    s_and_b32 s84, s72, 1
    s_lshl_b32 s85, s84, 13
    s_add_u32 s85, s85, 0x1001000
    s_cmp_lt_u32 s72, 6
    s_cselect_b32 s84, 0x40000000, s85
    v_lshlrev_b32 v253, 7, v0
    buffer_load_dword v254, v253, s[60:63], s84 offen sc1
Lrl_199:
    s_sub_u32 s84, s69, 28
    s_lshl_b32 s84, s84, 3
    s_add_u32 s84, s84, s68
    s_lshl_b32 s85, s72, 5
    s_add_u32 s84, s84, s85
    s_lshl_b32 s84, s84, 13
    v_lshlrev_b32 v253, 7, v0
    buffer_load_dword v254, v253, s[28:31], s84 offen
    s_mov_b32 s84, 0xc4000
    buffer_load_dword v254, v250, s[24:27], s84 offen
    s_add_u32 s84, s84, 0x80000
    buffer_load_dword v254, v252, s[24:27], s84 offen
    s_barrier
    s_cmp_lg_u32 s69, 31
    s_cbranch_scc1 Lrl_200
    s_and_b32 s84, s72, 1
    s_lshl_b32 s85, s84, 13
    s_add_u32 s85, s85, 0x1001000
    s_cmp_lt_u32 s72, 6
    s_cselect_b32 s84, 0x40000000, s85
    v_lshlrev_b32 v253, 7, v0
    buffer_load_dword v254, v253, s[60:63], s84 offen sc1
Lrl_200:
    s_mov_b32 s84, 0x80
    buffer_load_dword v254, v250, s[24:27], s84 offen
    s_add_u32 s84, s84, 0x80000
    buffer_load_dword v254, v252, s[24:27], s84 offen
    s_barrier
    s_mov_b32 s84, 0xc4080
    buffer_load_dword v254, v250, s[24:27], s84 offen
    s_add_u32 s84, s84, 0x80000
    buffer_load_dword v254, v252, s[24:27], s84 offen
    s_barrier
    s_sub_u32 s85, s69, 28
    s_lshl_b32 s85, s85, 3
    s_add_u32 s85, s85, s72
    v_lshlrev_b32 v250, 7, v0
    s_add_u32 s86, s85, 0
    s_mul_i32 s87, s86, 0x93
    s_lshr_b32 s87, s87, 10
    s_mul_i32 s84, s87, 0xe000
    s_lshl_b32 s86, s86, 13
    s_add_u32 s84, s84, s86
    buffer_load_dword v254, v250, s[28:31], s84 offen
    s_add_u32 s86, s85, 32
    s_mul_i32 s87, s86, 0x93
    s_lshr_b32 s87, s87, 10
    s_mul_i32 s84, s87, 0xe000
    s_lshl_b32 s86, s86, 13
    s_add_u32 s84, s84, s86
    buffer_load_dword v254, v250, s[28:31], s84 offen
    s_add_u32 s86, s85, 64
    s_mul_i32 s87, s86, 0x93
    s_lshr_b32 s87, s87, 10
    s_mul_i32 s84, s87, 0xe000
    s_lshl_b32 s86, s86, 13
    s_add_u32 s84, s84, s86
    buffer_load_dword v254, v250, s[28:31], s84 offen
    s_add_u32 s86, s85, 96
    s_mul_i32 s87, s86, 0x93
    s_lshr_b32 s87, s87, 10
    s_mul_i32 s84, s87, 0xe000
    s_lshl_b32 s86, s86, 13
    s_add_u32 s84, s84, s86
    buffer_load_dword v254, v250, s[28:31], s84 offen
    s_barrier
    s_add_u32 s86, s85, 0
    s_mul_i32 s87, s86, 0x93
    s_lshr_b32 s87, s87, 10
    s_mul_i32 s84, s87, 0xe000
    s_lshl_b32 s86, s86, 13
    s_add_u32 s84, s84, s86
    s_add_u32 s84, s84, 0xe000
    buffer_load_dword v254, v250, s[28:31], s84 offen
    s_add_u32 s86, s85, 32
    s_mul_i32 s87, s86, 0x93
    s_lshr_b32 s87, s87, 10
    s_mul_i32 s84, s87, 0xe000
    s_lshl_b32 s86, s86, 13
    s_add_u32 s84, s84, s86
    s_add_u32 s84, s84, 0xe000
    buffer_load_dword v254, v250, s[28:31], s84 offen
    s_add_u32 s86, s85, 64
    s_mul_i32 s87, s86, 0x93
    s_lshr_b32 s87, s87, 10
    s_mul_i32 s84, s87, 0xe000
    s_lshl_b32 s86, s86, 13
    s_add_u32 s84, s84, s86
    s_add_u32 s84, s84, 0xe000
    buffer_load_dword v254, v250, s[28:31], s84 offen
    s_add_u32 s86, s85, 96
    s_mul_i32 s87, s86, 0x93
    s_lshr_b32 s87, s87, 10
    s_mul_i32 s84, s87, 0xe000
    s_lshl_b32 s86, s86, 13
    s_add_u32 s84, s84, s86
    s_add_u32 s84, s84, 0xe000
    buffer_load_dword v254, v250, s[28:31], s84 offen
    s_waitcnt vmcnt(0)
L_end:
    s_endpgm
L_codeend:
.section .rodata,"a"
.p2align 6
.amdhsa_kernel sequential_preLN__sliding_block__mixer_s_mlp__prompt_kernel
  .amdhsa_next_free_vgpr 256
  .amdhsa_next_free_sgpr 102
  .amdhsa_accum_offset 256
  .amdhsa_group_segment_fixed_size 0
  .amdhsa_kernarg_size 88
  .amdhsa_user_sgpr_count 2
  .amdhsa_user_sgpr_kernarg_segment_ptr 1
  .amdhsa_system_sgpr_workgroup_id_x 1
.end_amdhsa_kernel
```
